```python
import torch

def _softmax(x, axis=-1):
    return torch.softmax(x, dim=axis)
def _gelu(x):
    return torch.nn.functional.gelu(x, approximate="tanh")
def _silu(x):
    return torch.nn.functional.silu(x)
def _sigmoid(x):
    return torch.sigmoid(x)
def _layernorm(x, axis=-1, eps=1e-5):
    m = x.mean(dim=axis, keepdim=True)
    v = x.var(dim=axis, keepdim=True, unbiased=False)
    return (x - m) / torch.sqrt(v + eps)
def _scatter_add(tgt, idx, src, axis=0):
    return tgt.clone().index_add_(axis, idx, src)
def _segment_sum(src, seg, n):
    out = torch.zeros((n,) + src.shape[1:], dtype=src.dtype)
    return out.index_add_(0, seg, src)
def _pad(x, pw):
    flat = tuple(v for pair in reversed(pw) for v in pair)
    return torch.nn.functional.pad(x, flat)

kernel_name = 'standalone__modern_conv_block_replknet__vision'

def setup_inputs():

    _w = (lambda a: (lambda t: t.to(torch.bfloat16) if t.is_floating_point() else t)(torch.as_tensor(a)))
    H = W = 224
    C = 192
    K = 3
    return {
        "x": _w((lambda *s: torch.randn(*s, dtype=torch.bfloat16) * 0.05)(1, H, W, C)),
        "dw_large": _w((lambda *s: torch.randn(*s, dtype=torch.bfloat16) * 0.4)(K, K, C) * (1.0 / K)),
        "dw_small": _w((lambda *s: torch.randn(*s, dtype=torch.bfloat16) * 0.4)(5, 5, C) * 0.2),
        "w1": _w((lambda *s: torch.randn(*s, dtype=torch.bfloat16) * 0.4)(C, 4 * C) * (C ** -0.5)),
        "w2": _w((lambda *s: torch.randn(*s, dtype=torch.bfloat16) * 0.1)(4 * C, C) * ((4 * C) ** -0.5)),
    }

def reference(x, dw_large, dw_small, w1, w2):
    B, H, W, C = x.shape
    Kl = dw_large.shape[0]
    pl = (Kl - 1) // 2
    xpl = _pad(x, ((0,0),(pl,pl),(pl,pl),(0,0)))
    out = torch.zeros_like(x)
    for i in range(Kl):
        for j in range(Kl):
            out = out + xpl[:, i:i+H, j:j+W, :] * dw_large[i, j][None, None, None, :]
    Ks = dw_small.shape[0]
    ps = (Ks - 1) // 2
    xps = _pad(x, ((0,0),(ps,ps),(ps,ps),(0,0)))
    for i in range(Ks):
        for j in range(Ks):
            out = out + xps[:, i:i+H, j:j+W, :] * dw_small[i, j][None, None, None, :]
    h = _layernorm(out, axis=-1)
    h = _gelu(torch.einsum('bhwc,ce->bhwe', h, w1))
    h = torch.einsum('bhwe,ec->bhwc', h, w2)
    return x + h
```

```asm
; @launch grid=(256,1,1) block=(256,1,1) lds=163328
.amdgcn_target "amdgcn-amd-amdhsa--gfx950"
.text
.globl standalone__modern_conv_block_replknet__vision_kernel
.p2align 12
.p2align 8
.type standalone__modern_conv_block_replknet__vision_kernel,@function
standalone__modern_conv_block_replknet__vision_kernel:
    s_cmp_ge_u32 s2, 256
    s_cbranch_scc1 L_end
    s_load_dwordx2 s[20:21], s[0:1], 16
    s_load_dwordx2 s[24:25], s[0:1], 8
    s_load_dwordx2 s[4:5], s[0:1], 0
    s_load_dwordx2 s[8:9], s[0:1], 24
    s_load_dwordx2 s[12:13], s[0:1], 32
    s_load_dwordx2 s[16:17], s[0:1], 40
    s_load_dwordx4 s[60:63], s[0:1], 48
    s_getpc_b64 s[98:99]
L_pc:
    s_lshr_b32 s55, s2, 3
    s_lshl_b32 s55, s55, 11
    v_and_b32 v121, 31, v0
    v_lshl_add_u32 v121, v121, 6, s55
    v_min_u32 v121, L_end-L_pc, v121
    s_mov_b32 exec_lo, -1
    s_mov_b32 exec_hi, 0
    global_load_dword v120, v121, s[98:99]
    s_mov_b64 exec, -1
    v_lshrrev_b32_e64 v121, 6, v0
    v_and_b32 v134, 63, v0
    v_readfirstlane_b32 s28, v121
    s_and_b32 s33, s2, 3
    s_bfe_u32 s34, s2, 0x20003
    s_lshl_b32 s33, s33, 2
    s_add_u32 s33, s33, s34
    s_bfe_u32 s34, s2, 0x10002
    s_lshr_b32 s35, s2, 5
    s_lshl_b32 s34, s34, 3
    s_add_u32 s34, s34, s35
    s_mul_i32 s31, s33, 14
    s_mul_i32 s32, s34, 14
    s_mul_i32 s33, s31, 384
    s_mul_i32 s96, s32, 86016
    s_add_u32 s43, s33, s96
    s_sub_u32 s31, s31, 2
    s_sub_u32 s32, s32, 2
    s_sub_u32 s97, s96, 172032
    s_cselect_b32 s97, 2147418112, s97
    s_movk_i32 s34, 384
    s_movk_i32 s35, 224
    s_mov_b32 s33, 86016
    v_and_b32 v117, 7, v0
    v_mov_b32 v118, 2147418112
    v_bfe_u32 v121, v0, 3, 4
    v_lshrrev_b32 v122, 7, v0
    v_add_u32 v123, s31, v121
    v_cmp_gt_u32 vcc, s35, v123
    v_mul_u32_u24_e64 v188, s33, v122
    v_mad_u32_u24 v188, v123, s34, v188
    v_lshl_add_u32 v188, v117, 4, v188
    v_cndmask_b32 v188, v118, v188, vcc
    v_mul_u32_u24 v119, 5264, v117
    v_mad_u32_u24 v121, v122, 18, v121
    v_lshl_add_u32 v208, v121, 3, v119
    v_bfe_u32 v121, v0, 3, 1
    v_lshrrev_b32_e64 v122, 4, v0
    v_mad_u32_u24 v123, v122, 18, v121
    v_lshl_add_u32 v191, v123, 3, v119
    v_add3_u32 v121, v121, s31, 16
    v_add_u32_e64 v122, s32, v122
    v_max_u32_e64 v123, v121, v122
    v_cmp_gt_u32 vcc, s35, v123
    v_mul_u32_u24_e64 v121, s34, v121
    v_lshl_add_u32 v190, v117, 4, v121
    v_mad_u32_u24 v189, v122, s33, v190
    v_cndmask_b32 v189, v118, v189, vcc
    v_cmp_gt_u32 s[46:47], s33, v121
    v_bfe_u32 v121, v0, 4, 1
    v_add3_u32 v122, v121, s32, 16
    v_mad_u32_u24 v190, v122, s33, v190
    v_lshrrev_b32 v122, 5, v0
    v_lshl_add_u32 v190, v122, 7, v190
    v_cmp_gt_u32 vcc, 3, v122
    s_and_b64 vcc, vcc, s[46:47]
    v_mul_u32_u24 v122, 42112, v122
    v_cndmask_b32 v190, v118, v190, vcc
    v_mul_u32_u24 v121, 144, v121
    v_and_b32_e64 v123, 8, v0
    v_add3_u32 v121, v121, v122, v123
    v_add_u32_e64 v192, v121, v119
    v_lshlrev_b32_e64 v104, 4, v0
    v_cmp_lt_u32 vcc, 119, v0
    v_add_u32 v122, -120, v0
    s_movk_i32 s35, 784
    v_cndmask_b32 v122, v0, v122, vcc
    v_cndmask_b32 v121, 0, 1, vcc
    v_mul_u32_u24 v123, 2731, v122
    v_lshrrev_b32_e64 v123, 16, v123
    v_mul_i32_i24 v107, -24, v123
    v_add_u32_e64 v122, v122, v107
    v_lshl_add_u32 v107, v121, 3, v123
    v_mul_u32_u24_e64 v107, s35, v107
    v_lshl_add_u32 v107, v122, 5, v107
    v_add_u32 v107, 128816, v107
    v_add_u32_e64 v123, -1, v123
    v_cmp_gt_u32 s[46:47], 3, v123
    v_mad_u32_u24 v121, v121, 3, v123
    v_lshlrev_b32 v122, 4, v122
    v_mad_i32_i24 v121, v121, s34, v122
    s_and_b64 vcc, vcc, s[46:47]
    v_add_u32 v122, 1152, v121
    v_add_u32 v121, -1152, v121
    v_cndmask_b32 v106, v118, v122, s[46:47]
    v_cndmask_b32 v105, v118, v121, vcc
    s_movk_i32 s35, 7680
    s_mov_b32 s22, 9600
    s_mov_b32 s23, 0x20000
    s_mov_b32 s26, 3456
    s_mov_b32 s27, 0x20000
    s_mov_b32 s6, 19267584
    s_mov_b32 s7, 0x20000
    s_mov_b32 s10, 294912
    s_mov_b32 s11, 0x20000
    s_mov_b32 s14, 294912
    s_mov_b32 s15, 0x20000
    s_mov_b32 s18, 19267584
    s_mov_b32 s19, 0x20000
    s_add_u32 s48, s96, 172032
    s_add_u32 s49, s96, 344064
    s_add_u32 s50, s96, 516096
    s_add_u32 s51, s96, 688128
    s_add_u32 s52, s96, 860160
    s_add_u32 s53, s96, 1032192
    s_add_u32 s54, s96, 1204224
    s_lshr_b32 s29, s28, 1
    s_and_b32 s30, s28, 1
    s_mov_b32 s36, 0x44e944e9
    s_mov_b32 s37, 0xbef00000
    s_mov_b32 s101, 0xb780b780
    s_mov_b32 s44, 0x05040100
    s_mov_b32 s45, 0x07060302
    s_mul_i32 s41, s28, 6144
    s_bfe_u32 s38, s2, 0x20003
    s_and_b32 s3, s2, 7
    s_lshr_b32 s55, s2, 5
    s_lshl_b32 s55, s55, 3
    s_add_u32 s3, s3, s55
    s_mul_i32 s39, s28, 73728
    s_mul_i32 s55, s38, 384
    s_add_u32 s39, s39, s55
    s_mul_i32 s40, s28, 6144
    s_mul_i32 s55, s38, 73728
    s_add_u32 s40, s40, s55
    s_waitcnt lgkmcnt(0)
    buffer_load_dwordx4 v[80:83], v104, s[20:23], 0 offen
    buffer_load_dwordx4 v[92:95], v105, s[24:27], 0 offen
    buffer_load_dwordx4 v[84:87], v104, s[20:23], 0 offen offset:3840
    buffer_load_dwordx4 v[96:99], v106, s[24:27], 0 offen
    buffer_load_dwordx4 v[88:91], v104, s[20:23], s35 offen
    buffer_load_dwordx4 v[184:187], v190, s[4:7], 0 offen
    v_mov_b64 v[124:125], 0
    v_mov_b64_e64 v[126:127], 0
    v_lshlrev_b32_e64 v121, 4, v0
    v_add_u32 v121, 126464, v121
    v_mul_u32_u24 v122, 5264, v134
    v_cmp_gt_u32 vcc, 147, v0
    v_mfma_f32_32x32x16_bf16 v[16:31], v[124:127], v[124:127], 0
    v_mfma_f32_32x32x16_bf16 v[32:47], v[124:127], v[124:127], 0
    v_mfma_f32_32x32x16_bf16 v[48:63], v[124:127], v[124:127], 0
    v_mfma_f32_32x32x16_bf16 v[64:79], v[124:127], v[124:127], 0
    s_and_saveexec_b64 s[46:47], vcc
    ds_write_b128 v121, v[124:127] offset:0
    ds_write_b128 v121, v[124:127] offset:6272
    ds_write_b128 v121, v[124:127] offset:12544
    ds_write_b128 v121, v[124:127] offset:18816
    ds_write_b128 v121, v[124:127] offset:25088
    ds_write_b128 v121, v[124:127] offset:31360
    s_mov_b32 exec_lo, 0xffffff
    s_mov_b32 exec_hi, 0x0
    ds_write_b128 v122, v[124:127] offset:5184
    s_mov_b64 exec, -1
    buffer_load_dwordx4 v[144:147], v188, s[4:7], s97 offen offset:0
    buffer_load_dwordx4 v[148:151], v188, s[4:7], s96 offen offset:0
    s_mov_b32 s20, s60
    s_mov_b32 s21, s61
    s_mov_b32 s22, 256
    buffer_load_dwordx4 v[152:155], v188, s[4:7], s48 offen offset:0
    s_mov_b32 s23, 0x20000
    s_mov_b32 s24, s62
    s_mov_b32 s25, s63
    s_mov_b32 s26, 3538944
    s_mov_b32 s27, 0x20000
    v_and_b32 v128, 15, v134
    v_lshrrev_b32 v129, 4, v134
    v_bfe_u32 v130, v134, 2, 2
    v_and_b32 v131, 3, v134
    v_lshrrev_b32 v132, 5, v134
    v_and_b32_e64 v133, 1, v129
    buffer_load_dwordx4 v[156:159], v188, s[4:7], s49 offen offset:0
    s_lshl_b32 s33, s28, 6
    s_add_u32 s33, s33, 126464
    s_movk_i32 s34, 784
    v_lshlrev_b32 v121, 2, v129
    v_sub_u32 v121, v121, v130
    v_add_u32_e64 v121, 3, v121
    v_lshl_add_u32 v122, v131, 2, s33
    v_mad_u32_u24 v108, v121, s34, v122
    v_cmp_eq_u32 vcc, 1, v132
    v_add_u32 v109, 1568, v108
    v_add_u32 v110, 12544, v108
    buffer_load_dwordx4 v[160:163], v188, s[4:7], s50 offen offset:0
    v_add_u32 v111, 14112, v108
    v_add_u32 v112, 18816, v108
    v_add_u32 v113, 20384, v108
    v_cndmask_b32 v112, v122, v112, vcc
    v_cndmask_b32 v113, v122, v113, vcc
    v_mul_u32_u24 v210, 0x5555, v131
    v_lshrrev_b32 v121, 1, v130
    v_xor_b32 v121, v121, v130
    v_lshlrev_b32_e64 v136, 2, v121
    v_mul_u32_u24 v121, 144, v136
    v_lshl_add_u32 v121, v131, 5, v121
    buffer_load_dwordx4 v[164:167], v188, s[4:7], s51 offen offset:0
    v_lshl_add_u32 v121, v129, 4, v121
    s_mul_i32 s33, s28, 10528
    v_add_u32_e64 v209, s33, v121
    v_bfe_u32 v121, v134, 3, 2
    v_lshl_add_u32 v121, v121, 2, v131
    v_bfe_u32 v122, v134, 2, 1
    v_lshl_add_u32 v121, v122, 4, v121
    v_lshlrev_b32 v122, 3, v132
    v_sub_u32 v121, v121, v122
    v_and_b32 v122, 1, v134
    v_lshlrev_b32 v122, 4, v122
    buffer_load_dwordx4 v[168:171], v188, s[4:7], s52 offen offset:0
    v_mov_b32 v123, 0x3f80
    v_lshlrev_b32 v122, v122, v123
    v_lshrrev_b32 v121, 1, v121
    v_cmp_eq_u32 s[56:57], 0, v121
    v_cmp_eq_u32 s[58:59], 1, v121
    v_cmp_eq_u32 s[98:99], 2, v121
    v_cmp_eq_u32 s[46:47], 3, v121
    v_cndmask_b32 v226, 0, v122, s[56:57]
    v_cndmask_b32 v227, 0, v122, s[58:59]
    v_cndmask_b32 v228, 0, v122, s[98:99]
    v_cndmask_b32 v229, 0, v122, s[46:47]
    buffer_load_dwordx4 v[172:175], v188, s[4:7], s53 offen offset:0
    v_cmp_eq_u32 s[56:57], 8, v121
    v_cmp_eq_u32 s[58:59], 9, v121
    v_cmp_eq_u32 s[98:99], 10, v121
    v_cmp_eq_u32 s[46:47], 11, v121
    v_cndmask_b32 v230, 0, v122, s[56:57]
    v_cndmask_b32 v231, 0, v122, s[58:59]
    v_cndmask_b32 v232, 0, v122, s[98:99]
    v_cndmask_b32 v233, 0, v122, s[46:47]
    v_lshlrev_b32 v219, 4, v134
    v_add_u32 v219, 151040, v219
    v_lshl_add_u32 v137, v131, 2, v129
    buffer_load_dwordx4 v[176:179], v188, s[4:7], s54 offen offset:0
    v_mad_u32_u24 v137, v136, 14, v137
    v_lshrrev_b32 v121, 2, v136
    v_and_b32 v121, 2, v121
    v_sub_u32 v137, v137, v121
    s_lshl_b32 s33, s28, 10
    s_movk_i32 s34, 12288
    v_and_b32 v135, 4, v136
    v_lshlrev_b32 v135, 4, v135
    v_add_u32 v121, 0, v137
    v_lshrrev_b32 v123, 5, v121
    v_mul_u32_u24 v123, s34, v123
    buffer_load_dwordx4 v[180:183], v189, s[4:7], 0 offen offset:0
    v_and_b32 v122, 16, v121
    v_lshl_add_u32 v123, v122, 4, v123
    v_and_b32 v122, 3, v121
    v_lshl_add_u32 v123, v122, 6, v123
    v_and_b32_e64 v122, 12, v121
    v_cmp_gt_u32 vcc, 240, v0
    s_and_saveexec_b64 s[46:47], vcc
    s_waitcnt vmcnt(14)
    v_perm_b32 v100, v92, v80, s44
    v_perm_b32 v101, v92, v80, s45
    v_perm_b32 v102, v93, v81, s44
    v_perm_b32 v103, v93, v81, s45
    ds_write_b128 v107, v[100:103] offset:0
    v_perm_b32 v140, v94, v82, s44
    v_perm_b32 v141, v94, v82, s45
    v_perm_b32 v142, v95, v83, s44
    v_perm_b32 v143, v95, v83, s45
    ds_write_b128 v107, v[140:143] offset:16
    s_waitcnt vmcnt(12)
    v_perm_b32 v100, v96, v84, s44
    v_perm_b32 v101, v96, v84, s45
    v_perm_b32 v102, v97, v85, s44
    v_perm_b32 v103, v97, v85, s45
    ds_write_b128 v107, v[100:103] offset:12544
    v_perm_b32 v140, v98, v86, s44
    v_perm_b32 v141, v98, v86, s45
    v_perm_b32 v142, v99, v87, s44
    v_perm_b32 v143, v99, v87, s45
    ds_write_b128 v107, v[140:143] offset:12560
    v_cmp_gt_u32 vcc, 120, v0
    s_and_saveexec_b64 s[46:47], vcc
    s_waitcnt vmcnt(11)
    v_perm_b32 v100, 0, v88, s44
    v_perm_b32 v101, 0, v88, s45
    v_perm_b32 v102, 0, v89, s44
    v_perm_b32 v103, 0, v89, s45
    ds_write_b128 v107, v[100:103] offset:25088
    v_perm_b32 v140, 0, v90, s44
    v_perm_b32 v141, 0, v90, s45
    v_perm_b32 v142, 0, v91, s44
    v_perm_b32 v143, 0, v91, s45
    ds_write_b128 v107, v[140:143] offset:25104
    s_mov_b64 exec, -1
    buffer_load_dwordx4 a[144:147], v188, s[4:7], s97 offen offset:128
    s_waitcnt lgkmcnt(0)
    s_barrier
    ds_read2_b32 a[0:1], v108 offset0:0 offset1:196
    ds_read2_b32 a[2:3], v109 offset0:0 offset1:196
    ds_read2_b32 a[4:5], v110 offset0:0 offset1:196
    ds_read2_b32 a[6:7], v111 offset0:0 offset1:196
    ds_read2_b32 a[8:9], v112 offset0:0 offset1:196
    ds_read2_b32 a[10:11], v113 offset0:0 offset1:196
    s_mov_b64 exec, 0
    s_cmp_eq_u32 s28, 0
    s_cbranch_scc1 L_pg1
    s_cmp_eq_u32 s28, 1
    s_cbranch_scc1 L_pg2
    s_cmp_eq_u32 s28, 2
    s_cbranch_scc1 L_pg3
    s_branch L_pg4
L_wu0:
    s_mov_b64 exec, -1
    buffer_load_dwordx4 a[148:151], v188, s[4:7], s96 offen offset:128
    v_lshl_add_u32 v123, v122, 2, v123
    v_xad_u32 v212, v123, v135, s33
    s_mov_b32 exec_lo, 0x0
    s_mov_b32 exec_hi, 0x88888888
    v_and_b32 v123, 0x7f, v212
    v_add_u32 v212, 86016, v123
    s_mov_b64 exec, -1
    v_add_u32_e64 v121, 14, v137
    s_mov_b32 exec_lo, 0x8000800
    s_mov_b32 exec_hi, 0x8000800
    v_add_u32 v121, 194, v129
    s_mov_b64 exec, -1
    v_lshrrev_b32 v123, 5, v121
    v_mul_u32_u24_e64 v123, s34, v123
    ds_read2_b32 a[12:13], v108 offset0:4 offset1:200
    ds_read2_b32 a[14:15], v109 offset0:4 offset1:200
    ds_read2_b32 a[16:17], v110 offset0:4 offset1:200
    ds_read2_b32 a[18:19], v111 offset0:4 offset1:200
    ds_read2_b32 a[20:21], v112 offset0:4 offset1:200
    ds_read2_b32 a[22:23], v113 offset0:4 offset1:200
    v_and_b32 v122, 16, v121
    v_lshl_add_u32 v123, v122, 4, v123
    v_and_b32 v122, 3, v121
    v_lshl_add_u32 v123, v122, 6, v123
    v_and_b32 v122, 12, v121
    v_lshl_add_u32 v123, v122, 2, v123
    v_xad_u32 v213, v123, v135, s33
    s_mov_b32 exec_lo, 0x0
    s_mov_b32 exec_hi, 0x88888888
    v_and_b32 v123, 0x7f, v213
    v_add_u32 v213, 86016, v123
    s_mov_b64 exec, -1
    v_add_u32_e64 v121, 28, v137
    s_mov_b32 exec_lo, 0x800080
    s_mov_b32 exec_hi, 0x800080
    v_add_u32 v121, 192, v129
    s_mov_b64 exec, -1
    ds_read2_b32 a[24:25], v108 offset0:8 offset1:204
    ds_read2_b32 a[26:27], v109 offset0:8 offset1:204
    ds_read2_b32 a[28:29], v110 offset0:8 offset1:204
    ds_read2_b32 a[30:31], v111 offset0:8 offset1:204
    ds_read2_b32 a[32:33], v112 offset0:8 offset1:204
    ds_read2_b32 a[34:35], v113 offset0:8 offset1:204
    v_lshrrev_b32 v123, 5, v121
    v_mul_u32_u24 v123, s34, v123
    v_and_b32 v122, 16, v121
    v_lshl_add_u32 v123, v122, 4, v123
    v_and_b32 v122, 3, v121
    v_lshl_add_u32 v123, v122, 6, v123
    v_and_b32 v122, 12, v121
    v_lshl_add_u32 v123, v122, 2, v123
    v_xad_u32 v214, v123, v135, s33
    s_mov_b32 exec_lo, 0xf000f00
    s_mov_b32 exec_hi, 0x8f888f88
    v_and_b32 v123, 0x7f, v214
    v_add_u32 v214, 86016, v123
    s_mov_b64 exec, -1
    ds_read2_b32 a[36:37], v108 offset0:12 offset1:208
    ds_read2_b32 a[38:39], v109 offset0:12 offset1:208
    ds_read2_b32 a[40:41], v110 offset0:12 offset1:208
    ds_read2_b32 a[42:43], v111 offset0:12 offset1:208
    ds_read2_b32 a[44:45], v112 offset0:12 offset1:208
    ds_read2_b32 a[46:47], v113 offset0:12 offset1:208
    buffer_load_dwordx4 a[152:155], v188, s[4:7], s48 offen offset:128
    v_add_u32_e64 v121, 42, v137
    s_mov_b32 exec_lo, 0xf000f0
    s_mov_b32 exec_hi, 0xf000f0
    v_add_u32 v121, -2, v121
    s_mov_b64 exec, -1
    v_lshrrev_b32 v123, 5, v121
    v_mul_u32_u24 v123, s34, v123
    v_and_b32 v122, 16, v121
    v_lshl_add_u32 v123, v122, 4, v123
    v_and_b32 v122, 3, v121
    v_lshl_add_u32 v123, v122, 6, v123
    v_add_u32 v108, 256, v108
    v_add_u32 v109, 256, v109
    v_add_u32 v110, 256, v110
    v_add_u32 v111, 256, v111
    v_add_u32 v112, 256, v112
    v_add_u32 v113, 256, v113
    buffer_load_dwordx4 a[156:159], v188, s[4:7], s49 offen offset:128
    v_and_b32_e64 v122, 12, v121
    v_lshl_add_u32 v123, v122, 2, v123
    v_xad_u32 v215, v123, v135, s33
    s_mov_b32 exec_lo, 0xf000f00
    s_mov_b32 exec_hi, 0x8f888f88
    v_and_b32 v123, 0x7f, v215
    v_add_u32 v215, 86016, v123
    s_mov_b64 exec, -1
    v_lshlrev_b32 v121, 6, v131
    v_lshl_add_u32 v121, v130, 4, v121
    v_lshl_add_u32 v122, v129, 8, v121
    s_mul_i32 s33, s29, 36864
    v_add_u32_e64 v220, s33, v122
    s_xor_b32 s33, s28, 1
    s_lshl_b32 s33, s33, 6
    ds_read2_b32 a[48:49], v108 offset0:0 offset1:196
    ds_read2_b32 a[50:51], v109 offset0:0 offset1:196
    ds_read2_b32 a[52:53], v110 offset0:0 offset1:196
    ds_read2_b32 a[54:55], v111 offset0:0 offset1:196
    ds_read2_b32 a[56:57], v112 offset0:0 offset1:196
    ds_read2_b32 a[58:59], v113 offset0:0 offset1:196
    s_add_u32 s33, s33, 73728
    v_lshl_add_u32 v221, v134, 9, s33
    s_mul_i32 s33, s30, 63168
    s_mul_i32 s34, s29, 1008
    s_add_u32 s33, s33, s34
    s_add_u32 s33, s33, 304
    v_mul_u32_u24 v123, 5264, v132
    v_add_u32 v123, s33, v123
    v_and_b32 v137, 31, v134
    s_mul_i32 s35, s29, 7
    v_add_u32 v121, 64, v137
    v_mul_u32_u24 v122, 4682, v121
    v_lshrrev_b32 v122, 16, v122
    v_lshl_add_u32 v121, v122, 2, v121
    ds_read2_b32 a[60:61], v108 offset0:4 offset1:200
    ds_read2_b32 a[62:63], v109 offset0:4 offset1:200
    ds_read2_b32 a[64:65], v110 offset0:4 offset1:200
    ds_read2_b32 a[66:67], v111 offset0:4 offset1:200
    ds_read2_b32 a[68:69], v112 offset0:4 offset1:200
    ds_read2_b32 a[70:71], v113 offset0:4 offset1:200
    v_lshl_add_u32 v218, v121, 3, v123
    v_add_lshl_u32 v122, v122, s35, 4
    v_and_b32 v122, 64, v122
    v_xor_b32 v239, v122, v220
    v_add_u32 v121, 32, v137
    v_mul_u32_u24 v122, 4682, v121
    v_lshrrev_b32 v122, 16, v122
    v_lshl_add_u32 v121, v122, 2, v121
    v_lshl_add_u32 v217, v121, 3, v123
    v_add_lshl_u32 v122, v122, s35, 4
    v_and_b32 v122, 64, v122
    v_xor_b32 v238, v122, v220
    v_add_u32_e64 v121, 0, v137
    v_mul_u32_u24 v122, 4682, v121
    ds_read2_b32 a[72:73], v108 offset0:8 offset1:204
    ds_read2_b32 a[74:75], v109 offset0:8 offset1:204
    ds_read2_b32 a[76:77], v110 offset0:8 offset1:204
    ds_read2_b32 a[78:79], v111 offset0:8 offset1:204
    ds_read2_b32 a[80:81], v112 offset0:8 offset1:204
    ds_read2_b32 a[82:83], v113 offset0:8 offset1:204
    buffer_load_dwordx4 a[160:163], v188, s[4:7], s50 offen offset:128
    v_lshrrev_b32 v122, 16, v122
    v_lshl_add_u32 v121, v122, 2, v121
    v_lshl_add_u32 v216, v121, 3, v123
    v_add_lshl_u32 v122, v122, s35, 4
    v_and_b32 v122, 64, v122
    v_xor_b32 v220, v122, v220
    v_and_b32 v138, 2, v130
    v_lshlrev_b32 v139, 7, v130
    s_lshl_b32 s33, s30, 1
    v_add_u32 v121, s33, v133
    v_add_u32 v122, v138, v132
    v_xor_b32_e64 v121, v121, v122
    v_lshl_add_u32 v123, v131, 3, v139
    v_lshl_add_u32 v121, v121, 5, v123
    ds_read2_b32 a[84:85], v108 offset0:12 offset1:208
    ds_read2_b32 a[86:87], v109 offset0:12 offset1:208
    ds_read2_b32 a[88:89], v110 offset0:12 offset1:208
    ds_read2_b32 a[90:91], v111 offset0:12 offset1:208
    ds_read2_b32 a[92:93], v112 offset0:12 offset1:208
    ds_read2_b32 a[94:95], v113 offset0:12 offset1:208
    v_lshl_add_u32 v121, v132, 10, v121
    v_add_u32 v1, 101888, v121
    v_lshrrev_b32 v121, 3, v134
    v_and_b32 v122, 2, v121
    v_bfe_u32 v123, v134, 1, 2
L_pg1:
    s_cbranch_execz L_wu0
    v_xor_b32 v122, v122, v123
    v_and_b32 v123, 1, v134
    v_lshlrev_b32 v123, 4, v123
    v_lshl_add_u32 v122, v122, 5, v123
    v_mul_u32_u24 v123, 1536, v121
    v_add_u32 v13, v122, v123
    v_xor_b32 v14, 32, v13
    v_lshlrev_b32 v123, 5, v132
    v_xor_b32 v122, v122, v123
    v_add_u32 v108, 256, v108
    v_add_u32 v109, 256, v109
    v_add_u32 v110, 256, v110
    v_add_u32 v111, 256, v111
    v_add_u32 v112, 256, v112
    v_add_u32 v113, 256, v113
    v_mul_u32_u24 v123, 384, v121
    v_add_u32 v15, v122, v123
    v_and_b32 v140, 12, v0
    v_and_b32 v141, 3, v0
    v_lshlrev_b32 v140, 5, v140
    v_lshl_add_u32 v143, v141, 3, v140
    v_and_b32 v141, 8, v0
    v_and_b32 v142, 16, v0
    v_lshlrev_b32 v142, 1, v142
    v_lshl_add_u32 v141, v141, 3, v142
    s_lshl_b32 s33, s28, 5
    v_bfe_u32 v140, v0, 4, 2
    v_lshl_add_u32 v140, v140, 10, v143
    v_add_u32 v140, 101888, v140
    v_xad_u32 v2, v141, s33, v140
    ds_read2_b32 a[96:97], v108 offset0:0 offset1:196
    ds_read2_b32 a[98:99], v109 offset0:0 offset1:196
    ds_read2_b32 a[100:101], v110 offset0:0 offset1:196
    ds_read2_b32 a[102:103], v111 offset0:0 offset1:196
    ds_read2_b32 a[104:105], v112 offset0:0 offset1:196
    ds_read2_b32 a[106:107], v113 offset0:0 offset1:196
    v_bfe_u32 v140, v0, 5, 1
    v_mul_u32_u24 v140, 3072, v140
    v_lshl_add_u32 v142, v142, 4, v143
    v_add_u32_e64 v142, v142, v140
    s_mul_i32 s33, s28, 3
    s_lshl_b32 s34, s33, 8
    s_lshl_b32 s35, s33, 5
    s_or_b32 s34, s34, s35
    s_and_b32 s34, s34, 0xc60
    v_xad_u32 v6, v141, s34, v142
    s_add_u32 s33, s33, 1
    s_lshl_b32 s34, s33, 8
    s_lshl_b32 s35, s33, 5
    s_or_b32 s34, s34, s35
    ds_read2_b32 a[108:109], v108 offset0:4 offset1:200
    ds_read2_b32 a[110:111], v109 offset0:4 offset1:200
    ds_read2_b32 a[112:113], v110 offset0:4 offset1:200
    ds_read2_b32 a[114:115], v111 offset0:4 offset1:200
    ds_read2_b32 a[116:117], v112 offset0:4 offset1:200
    ds_read2_b32 a[118:119], v113 offset0:4 offset1:200
    s_and_b32 s34, s34, 0xc60
    v_xad_u32 v7, v141, s34, v142
    s_add_u32 s33, s33, 1
    s_lshl_b32 s34, s33, 8
    s_lshl_b32 s35, s33, 5
    s_or_b32 s34, s34, s35
    s_and_b32 s34, s34, 0xc60
    v_xad_u32 v8, v141, s34, v142
    v_and_b32 v140, 12, v0
    v_lshlrev_b32 v140, 5, v140
    v_and_b32 v141, 16, v0
    v_add_u32 v140, v140, v141
    v_and_b32_e64 v141, 2, v0
    v_lshl_add_u32 v140, v141, 2, v140
    ds_read2_b32 a[120:121], v108 offset0:8 offset1:204
    ds_read2_b32 a[122:123], v109 offset0:8 offset1:204
    ds_read2_b32 a[124:125], v110 offset0:8 offset1:204
    ds_read2_b32 a[126:127], v111 offset0:8 offset1:204
    ds_read2_b32 a[128:129], v112 offset0:8 offset1:204
    ds_read2_b32 a[130:131], v113 offset0:8 offset1:204
    v_and_b32 v141, 32, v0
    v_lshl_add_u32 v140, v141, 4, v140
    v_and_b32 v142, 1, v0
    v_lshlrev_b32 v142, 5, v142
    v_xor_b32 v141, v141, v142
    v_and_b32 v142, 8, v0
    v_lshl_add_u32 v141, v142, 3, v141
    v_add_u32 v140, v140, v141
    s_mul_i32 s34, s30, 1088
    v_xor_b32 v3, s34, v140
    s_add_u32 s34, s34, 1024
    v_xor_b32_e64 v5, s34, v140
    s_mul_i32 s34, s30, 1984
    s_add_u32 s34, s34, 64
    ds_read2_b32 a[132:133], v108 offset0:12 offset1:208
    ds_read2_b32 a[134:135], v109 offset0:12 offset1:208
    ds_read2_b32 a[136:137], v110 offset0:12 offset1:208
    ds_read2_b32 a[138:139], v111 offset0:12 offset1:208
    ds_read2_b32 a[140:141], v112 offset0:12 offset1:208
    ds_read2_b32 a[142:143], v113 offset0:12 offset1:208
    v_xor_b32 v4, s34, v140
    v_and_b32 v140, 63, v0
    s_mul_i32 s33, s29, 12288
    s_add_u32 s33, s33, 49152
    v_lshl_add_u32 v9, v140, 4, s33
    s_lshl_b32 s34, s30, 11
    v_add_u32 v10, s34, v9
    v_lshlrev_b32 v140, 4, v140
    v_add_u32 v11, 159232, v140
    s_lshl_b32 s33, s29, 10
    s_lshl_b32 s34, s30, 3
    s_add_u32 s33, s33, s34
    v_add_u32_e64 v12, s33, v11
    v_mov_b64_e64 v[200:201], 0
    v_mov_b64_e64 v[202:203], 0
    buffer_load_dwordx4 a[164:167], v188, s[4:7], s51 offen offset:128
    v_cmp_gt_u32 vcc, 96, v0
    s_and_saveexec_b64 s[46:47], vcc
    s_waitcnt vmcnt(16)
    ds_write_b64 v192, v[184:185] offset:2432
    ds_write_b64 v192, v[186:187] offset:5024
    s_mov_b64 exec, -1
    s_waitcnt vmcnt(15)
    ds_write_b64 v208, v[144:145] offset:0
    ds_write_b64 v208, v[146:147] offset:2592
    s_waitcnt vmcnt(14)
    ds_write_b64 v208, v[148:149] offset:288
    buffer_load_dwordx4 a[168:171], v188, s[4:7], s52 offen offset:128
    v_mfma_f32_32x32x16_bf16 v[80:95], v[200:203], v[200:203], 0
    s_nop 0
    ds_write_b64 v208, v[150:151] offset:2880
    s_waitcnt vmcnt(14)
    ds_write_b64 v208, v[152:153] offset:576
    ds_write_b64 v208, v[154:155] offset:3168
    s_waitcnt vmcnt(13)
    ds_write_b64 v208, v[156:157] offset:864
    ds_write_b64 v208, v[158:159] offset:3456
    buffer_load_dwordx4 a[172:175], v188, s[4:7], s53 offen offset:128
    v_mfma_f32_32x32x16_bf16 v[96:111], v[200:203], v[200:203], 0
    s_waitcnt vmcnt(13)
    ds_write_b64 v208, v[160:161] offset:1152
    ds_write_b64 v208, v[162:163] offset:3744
    s_waitcnt vmcnt(12)
    ds_write_b64 v208, v[164:165] offset:1440
    ds_write_b64 v208, v[166:167] offset:4032
    s_waitcnt vmcnt(11)
    ds_write_b64 v208, v[168:169] offset:1728
    buffer_load_dwordx4 a[176:179], v188, s[4:7], s54 offen offset:128
    v_mfma_f32_32x32x16_bf16 v[112:127], v[200:203], v[200:203], 0
    ds_write_b64 v208, v[170:171] offset:4320
    s_waitcnt vmcnt(11)
    ds_write_b64 v208, v[172:173] offset:2016
    ds_write_b64 v208, v[174:175] offset:4608
    s_waitcnt vmcnt(10)
    ds_write_b64 v208, v[176:177] offset:2304
    ds_write_b64 v208, v[178:179] offset:4896
    buffer_load_dwordx4 a[180:183], v189, s[4:7], 0 offen offset:128
    v_mfma_f32_32x32x16_bf16 v[128:143], v[200:203], v[200:203], 0
    s_waitcnt vmcnt(10)
    ds_write_b64 v191, v[180:181] offset:128
    ds_write_b64 v191, v[182:183] offset:2720
    s_waitcnt lgkmcnt(0)
    s_barrier
    ds_read_b128 a[224:227], v209 offset:0
    ds_read_b128 a[228:231], v209 offset:144
    ds_read_b128 a[232:235], v209 offset:288
    ds_read_b128 a[236:239], v209 offset:432
    ds_read_b128 a[240:243], v209 offset:576
    ds_read_b128 a[244:247], v209 offset:720
    ds_read_b128 a[248:251], v209 offset:864
    ds_read_b128 a[252:255], v209 offset:1008
    s_mov_b64 exec, 0
    s_cmp_eq_u32 s28, 0
    s_cbranch_scc1 L_pg5
    s_cmp_eq_u32 s28, 1
    s_cbranch_scc1 L_pg6
    s_cmp_eq_u32 s28, 2
    s_cbranch_scc1 L_pg7
    s_branch L_pg8
L_wu1:
    s_mov_b64 exec, -1
    buffer_load_dwordx4 a[184:187], v188, s[4:7], s97 offen offset:256
    buffer_load_dwordx4 a[188:191], v188, s[4:7], s96 offen offset:256
    s_waitcnt lgkmcnt(6)
    v_smfmac_f32_16x16x64_bf16 v[16:19], a[0:3], a[224:231], v210
    s_waitcnt lgkmcnt(5)
    ds_read_b128 v[144:147], v209 offset:2592
    v_smfmac_f32_16x16x64_bf16 v[20:23], a[0:3], a[228:235], v210
    s_waitcnt lgkmcnt(5)
    ds_read_b128 v[148:151], v209 offset:2736
    v_smfmac_f32_16x16x64_bf16 v[24:27], a[0:3], a[232:239], v210
    s_waitcnt lgkmcnt(3)
    ds_read_b128 v[152:155], v209 offset:2880
    v_smfmac_f32_16x16x64_bf16 v[28:31], a[0:3], a[236:243], v210
    s_nop 0
    ds_read_b128 v[156:159], v209 offset:3024
    v_smfmac_f32_16x16x64_bf16 v[16:19], a[4:7], a[232:239], v210
    ds_read_b128 v[160:163], v209 offset:3168
    v_smfmac_f32_16x16x64_bf16 v[20:23], a[4:7], a[236:243], v210
    ds_read_b128 v[164:167], v209 offset:3312
    v_smfmac_f32_16x16x64_bf16 v[24:27], a[4:7], a[240:247], v210
    ds_read_b128 v[168:171], v209 offset:3456
    v_smfmac_f32_16x16x64_bf16 v[28:31], a[4:7], a[244:251], v210
    ds_read_b128 v[172:175], v209 offset:3600
    v_smfmac_f32_16x16x64_bf16 v[16:19], a[8:11], a[236:243], v210
    buffer_load_dwordx4 a[192:195], v188, s[4:7], s48 offen offset:256
    v_smfmac_f32_16x16x64_bf16 v[20:23], a[8:11], a[240:247], v210
    s_nop 0
    buffer_load_dwordx4 a[196:199], v188, s[4:7], s49 offen offset:256
    v_smfmac_f32_16x16x64_bf16 v[24:27], a[8:11], a[244:251], v210
    s_waitcnt lgkmcnt(3)
    buffer_load_dwordx4 a[200:203], v188, s[4:7], s50 offen offset:256
    v_smfmac_f32_16x16x64_bf16 v[28:31], a[8:11], a[248:255], v210
    s_waitcnt lgkmcnt(0)
    buffer_load_dwordx4 a[204:207], v188, s[4:7], s51 offen offset:256
    v_smfmac_f32_16x16x64_bf16 v[32:35], a[12:15], v[144:151], v210
    ds_read_b128 a[224:227], v209 offset:5264
    v_smfmac_f32_16x16x64_bf16 v[36:39], a[12:15], v[148:155], v210
    s_nop 0
    ds_read_b128 a[228:231], v209 offset:5408
    v_smfmac_f32_16x16x64_bf16 v[40:43], a[12:15], v[152:159], v210
    ds_read_b128 a[232:235], v209 offset:5552
    v_smfmac_f32_16x16x64_bf16 v[44:47], a[12:15], v[156:163], v210
    ds_read_b128 a[236:239], v209 offset:5696
    v_smfmac_f32_16x16x64_bf16 v[32:35], a[16:19], v[152:159], v210
    ds_read_b128 a[240:243], v209 offset:5840
    v_smfmac_f32_16x16x64_bf16 v[36:39], a[16:19], v[156:163], v210
    ds_read_b128 a[244:247], v209 offset:5984
    v_smfmac_f32_16x16x64_bf16 v[40:43], a[16:19], v[160:167], v210
    ds_read_b128 a[248:251], v209 offset:6128
    v_smfmac_f32_16x16x64_bf16 v[44:47], a[16:19], v[164:171], v210
    ds_read_b128 a[252:255], v209 offset:6272
    v_smfmac_f32_16x16x64_bf16 v[32:35], a[20:23], v[156:163], v210
    v_smfmac_f32_16x16x64_bf16 v[36:39], a[20:23], v[160:167], v210
    v_smfmac_f32_16x16x64_bf16 v[40:43], a[20:23], v[164:171], v210
    s_nop 0
    v_smfmac_f32_16x16x64_bf16 v[44:47], a[20:23], v[168:175], v210
    s_waitcnt lgkmcnt(0)
    v_smfmac_f32_16x16x64_bf16 v[48:51], a[24:27], a[224:231], v210
    ds_read_b128 v[144:147], v209 offset:7856
    v_smfmac_f32_16x16x64_bf16 v[52:55], a[24:27], a[228:235], v210
    ds_read_b128 v[148:151], v209 offset:8000
    v_smfmac_f32_16x16x64_bf16 v[56:59], a[24:27], a[232:239], v210
    ds_read_b128 v[152:155], v209 offset:8144
    v_smfmac_f32_16x16x64_bf16 v[60:63], a[24:27], a[236:243], v210
    ds_read_b128 v[156:159], v209 offset:8288
    v_smfmac_f32_16x16x64_bf16 v[48:51], a[28:31], a[232:239], v210
    ds_read_b128 v[160:163], v209 offset:8432
    v_smfmac_f32_16x16x64_bf16 v[52:55], a[28:31], a[236:243], v210
    ds_read_b128 v[164:167], v209 offset:8576
    v_smfmac_f32_16x16x64_bf16 v[56:59], a[28:31], a[240:247], v210
    ds_read_b128 v[168:171], v209 offset:8720
    v_smfmac_f32_16x16x64_bf16 v[60:63], a[28:31], a[244:251], v210
    ds_read_b128 v[172:175], v209 offset:8864
    v_smfmac_f32_16x16x64_bf16 v[48:51], a[32:35], a[236:243], v210
    v_smfmac_f32_16x16x64_bf16 v[52:55], a[32:35], a[240:247], v210
    v_smfmac_f32_16x16x64_bf16 v[56:59], a[32:35], a[244:251], v210
    v_smfmac_f32_16x16x64_bf16 v[60:63], a[32:35], a[248:255], v210
    s_waitcnt lgkmcnt(0)
    v_smfmac_f32_16x16x64_bf16 v[64:67], a[36:39], v[144:151], v210
    s_waitcnt vmcnt(15)
    ds_write_b64 v208, a[144:145] offset:42112
    v_smfmac_f32_16x16x64_bf16 v[68:71], a[36:39], v[148:155], v210
    ds_write_b64 v208, a[146:147] offset:44704
    v_smfmac_f32_16x16x64_bf16 v[72:75], a[36:39], v[152:159], v210
    s_waitcnt vmcnt(14)
    ds_write_b64 v208, a[148:149] offset:42400
    v_smfmac_f32_16x16x64_bf16 v[76:79], a[36:39], v[156:163], v210
    ds_write_b64 v208, a[150:151] offset:44992
    v_smfmac_f32_16x16x64_bf16 v[64:67], a[40:43], v[152:159], v210
    s_waitcnt vmcnt(13)
    ds_write_b64 v208, a[152:153] offset:42688
    v_smfmac_f32_16x16x64_bf16 v[68:71], a[40:43], v[156:163], v210
    ds_write_b64 v208, a[154:155] offset:45280
    v_smfmac_f32_16x16x64_bf16 v[72:75], a[40:43], v[160:167], v210
    s_waitcnt vmcnt(12)
    ds_write_b64 v208, a[156:157] offset:42976
    v_smfmac_f32_16x16x64_bf16 v[76:79], a[40:43], v[164:171], v210
    ds_write_b64 v208, a[158:159] offset:45568
    v_smfmac_f32_16x16x64_bf16 v[64:67], a[44:47], v[156:163], v210
    s_waitcnt vmcnt(11)
    ds_write_b64 v208, a[160:161] offset:43264
    v_smfmac_f32_16x16x64_bf16 v[68:71], a[44:47], v[160:167], v210
    ds_write_b64 v208, a[162:163] offset:45856
    v_smfmac_f32_16x16x64_bf16 v[72:75], a[44:47], v[164:171], v210
    s_waitcnt vmcnt(10)
    ds_write_b64 v208, a[164:165] offset:43552
    v_smfmac_f32_16x16x64_bf16 v[76:79], a[44:47], v[168:175], v210
    s_nop 0
    ds_write_b64 v208, a[166:167] offset:46144
    buffer_load_dwordx4 a[208:211], v188, s[4:7], s52 offen offset:256
    buffer_load_dwordx4 a[212:215], v188, s[4:7], s53 offen offset:256
    s_waitcnt vmcnt(11)
    ds_write_b64 v208, a[168:169] offset:43840
    ds_write_b64 v208, a[170:171] offset:46432
    v_mov_b64 v[240:241], v[16:17]
    v_pk_mul_f32 v[248:249], v[16:17], v[16:17]
    v_mov_b64 v[242:243], v[20:21]
    v_pk_mul_f32 v[250:251], v[20:21], v[20:21]
    v_mov_b64 v[244:245], v[24:25]
    v_pk_mul_f32 v[252:253], v[24:25], v[24:25]
    v_mov_b64 v[246:247], v[28:29]
    v_pk_mul_f32 v[254:255], v[28:29], v[28:29]
    v_pk_add_f32 v[240:241], v[240:241], v[18:19]
    v_pk_fma_f32 v[248:249], v[18:19], v[18:19], v[248:249]
    v_pk_add_f32 v[242:243], v[242:243], v[22:23]
    v_pk_fma_f32 v[250:251], v[22:23], v[22:23], v[250:251]
    v_pk_add_f32 v[244:245], v[244:245], v[26:27]
    v_pk_fma_f32 v[252:253], v[26:27], v[26:27], v[252:253]
    s_waitcnt vmcnt(10)
    ds_write_b64 v208, a[172:173] offset:44128
    ds_write_b64 v208, a[174:175] offset:46720
    v_pk_add_f32 v[246:247], v[246:247], v[30:31]
    v_pk_fma_f32 v[254:255], v[30:31], v[30:31], v[254:255]
    v_pk_add_f32 v[240:241], v[240:241], v[32:33]
    v_pk_fma_f32 v[248:249], v[32:33], v[32:33], v[248:249]
    v_pk_add_f32 v[242:243], v[242:243], v[36:37]
    v_pk_fma_f32 v[250:251], v[36:37], v[36:37], v[250:251]
    v_pk_add_f32 v[244:245], v[244:245], v[40:41]
    v_pk_fma_f32 v[252:253], v[40:41], v[40:41], v[252:253]
    v_pk_add_f32 v[246:247], v[246:247], v[44:45]
    v_pk_fma_f32 v[254:255], v[44:45], v[44:45], v[254:255]
    v_pk_add_f32 v[240:241], v[240:241], v[34:35]
    v_pk_fma_f32 v[248:249], v[34:35], v[34:35], v[248:249]
    v_pk_add_f32 v[242:243], v[242:243], v[38:39]
    v_pk_fma_f32 v[250:251], v[38:39], v[38:39], v[250:251]
    s_waitcnt vmcnt(9)
    ds_write_b64 v208, a[176:177] offset:44416
    ds_write_b64 v208, a[178:179] offset:47008
    v_pk_add_f32 v[244:245], v[244:245], v[42:43]
    v_pk_fma_f32 v[252:253], v[42:43], v[42:43], v[252:253]
    v_pk_add_f32 v[246:247], v[246:247], v[46:47]
    v_pk_fma_f32 v[254:255], v[46:47], v[46:47], v[254:255]
    v_pk_add_f32 v[240:241], v[240:241], v[48:49]
    v_pk_fma_f32 v[248:249], v[48:49], v[48:49], v[248:249]
    v_pk_add_f32 v[242:243], v[242:243], v[52:53]
    v_pk_fma_f32 v[250:251], v[52:53], v[52:53], v[250:251]
    v_pk_add_f32 v[244:245], v[244:245], v[56:57]
    v_pk_fma_f32 v[252:253], v[56:57], v[56:57], v[252:253]
    v_pk_add_f32 v[246:247], v[246:247], v[60:61]
    v_pk_fma_f32 v[254:255], v[60:61], v[60:61], v[254:255]
    v_pk_add_f32 v[240:241], v[240:241], v[50:51]
    v_pk_fma_f32 v[248:249], v[50:51], v[50:51], v[248:249]
    s_waitcnt vmcnt(8)
    ds_write_b64 v191, a[180:181] offset:42240
    ds_write_b64 v191, a[182:183] offset:44832
    v_pk_add_f32 v[242:243], v[242:243], v[54:55]
    v_pk_fma_f32 v[250:251], v[54:55], v[54:55], v[250:251]
    v_pk_add_f32 v[244:245], v[244:245], v[58:59]
    v_pk_fma_f32 v[252:253], v[58:59], v[58:59], v[252:253]
    v_pk_add_f32 v[246:247], v[246:247], v[62:63]
    v_pk_fma_f32 v[254:255], v[62:63], v[62:63], v[254:255]
    v_pk_add_f32 v[240:241], v[240:241], v[64:65]
    v_pk_fma_f32 v[248:249], v[64:65], v[64:65], v[248:249]
    v_pk_add_f32 v[242:243], v[242:243], v[68:69]
    v_pk_fma_f32 v[250:251], v[68:69], v[68:69], v[250:251]
    v_pk_add_f32 v[244:245], v[244:245], v[72:73]
    v_pk_fma_f32 v[252:253], v[72:73], v[72:73], v[252:253]
    v_pk_add_f32 v[246:247], v[246:247], v[76:77]
    v_pk_fma_f32 v[254:255], v[76:77], v[76:77], v[254:255]
    v_add_u32 v208, 84224, v208
    v_add_u32 v225, 84224, v191
    buffer_load_dwordx4 a[216:219], v188, s[4:7], s54 offen offset:256
    buffer_load_dwordx4 a[220:223], v189, s[4:7], 0 offen offset:256
    s_waitcnt lgkmcnt(0)
    s_barrier
    ds_read_b128 a[224:227], v209 offset:42112
    ds_read_b128 a[228:231], v209 offset:42256
    ds_read_b128 a[232:235], v209 offset:42400
    ds_read_b128 a[236:239], v209 offset:42544
    ds_read_b128 a[240:243], v209 offset:42688
    ds_read_b128 a[244:247], v209 offset:42832
    ds_read_b128 a[248:251], v209 offset:42976
    ds_read_b128 a[252:255], v209 offset:43120
    s_mov_b64 exec, 0
    s_cmp_eq_u32 s28, 0
    s_cbranch_scc1 L_pg9
    s_cmp_eq_u32 s28, 1
    s_cbranch_scc1 L_pg10
    s_cmp_eq_u32 s28, 2
    s_cbranch_scc1 L_pg11
    s_branch L_pg12
L_wu2:
    s_mov_b64 exec, -1
    v_pk_add_f32 v[240:241], v[240:241], v[66:67]
    v_pk_fma_f32 v[248:249], v[66:67], v[66:67], v[248:249]
    v_pk_add_f32 v[242:243], v[242:243], v[70:71]
    v_pk_fma_f32 v[250:251], v[70:71], v[70:71], v[250:251]
    v_pk_add_f32 v[244:245], v[244:245], v[74:75]
    v_pk_fma_f32 v[252:253], v[74:75], v[74:75], v[252:253]
    v_pk_add_f32 v[246:247], v[246:247], v[78:79]
    v_pk_fma_f32 v[254:255], v[78:79], v[78:79], v[254:255]
    s_waitcnt lgkmcnt(6)
    s_nop 0
    v_smfmac_f32_16x16x64_bf16 v[80:83], a[48:51], a[224:231], v210
    s_waitcnt lgkmcnt(5)
    ds_read_b128 a[0:3], v209 offset:44704
    v_smfmac_f32_16x16x64_bf16 v[84:87], a[48:51], a[228:235], v210
    s_waitcnt lgkmcnt(5)
    ds_read_b128 a[4:7], v209 offset:44848
    v_smfmac_f32_16x16x64_bf16 v[88:91], a[48:51], a[232:239], v210
    s_waitcnt lgkmcnt(3)
    ds_read_b128 a[8:11], v209 offset:44992
    v_smfmac_f32_16x16x64_bf16 v[92:95], a[48:51], a[236:243], v210
    ds_read_b128 a[12:15], v209 offset:45136
    v_smfmac_f32_16x16x64_bf16 v[80:83], a[52:55], a[232:239], v210
    ds_read_b128 a[16:19], v209 offset:45280
    v_smfmac_f32_16x16x64_bf16 v[84:87], a[52:55], a[236:243], v210
    ds_read_b128 a[20:23], v209 offset:45424
    v_smfmac_f32_16x16x64_bf16 v[88:91], a[52:55], a[240:247], v210
    ds_read_b128 a[24:27], v209 offset:45568
    v_smfmac_f32_16x16x64_bf16 v[92:95], a[52:55], a[244:251], v210
    ds_read_b128 a[28:31], v209 offset:45712
    v_smfmac_f32_16x16x64_bf16 v[80:83], a[56:59], a[236:243], v210
    ds_read_b64 a[144:145], v216 offset:0
    v_smfmac_f32_16x16x64_bf16 v[84:87], a[56:59], a[240:247], v210
    ds_read_b64 a[146:147], v216 offset:2592
    v_smfmac_f32_16x16x64_bf16 v[88:91], a[56:59], a[244:251], v210
    s_waitcnt lgkmcnt(5)
    ds_read_b64 a[148:149], v216 offset:10528
    v_smfmac_f32_16x16x64_bf16 v[92:95], a[56:59], a[248:255], v210
    s_waitcnt lgkmcnt(3)
    ds_read_b64 a[150:151], v216 offset:13120
    v_smfmac_f32_16x16x64_bf16 v[96:99], a[60:63], a[0:7], v210
    ds_read_b128 a[224:227], v209 offset:47376
    v_smfmac_f32_16x16x64_bf16 v[100:103], a[60:63], a[4:11], v210
    ds_read_b128 a[228:231], v209 offset:47520
    v_smfmac_f32_16x16x64_bf16 v[104:107], a[60:63], a[8:15], v210
    ds_read_b128 a[232:235], v209 offset:47664
    v_smfmac_f32_16x16x64_bf16 v[108:111], a[60:63], a[12:19], v210
    ds_read_b128 a[236:239], v209 offset:47808
    v_smfmac_f32_16x16x64_bf16 v[96:99], a[64:67], a[8:15], v210
    ds_read_b128 a[240:243], v209 offset:47952
    v_smfmac_f32_16x16x64_bf16 v[100:103], a[64:67], a[12:19], v210
    ds_read_b128 a[244:247], v209 offset:48096
    v_smfmac_f32_16x16x64_bf16 v[104:107], a[64:67], a[16:23], v210
    ds_read_b128 a[248:251], v209 offset:48240
    v_smfmac_f32_16x16x64_bf16 v[108:111], a[64:67], a[20:27], v210
    ds_read_b128 a[252:255], v209 offset:48384
    v_smfmac_f32_16x16x64_bf16 v[96:99], a[68:71], a[12:19], v210
    ds_read_b64 a[152:153], v217 offset:0
    v_smfmac_f32_16x16x64_bf16 v[100:103], a[68:71], a[16:23], v210
    ds_read_b64 a[154:155], v217 offset:2592
    v_smfmac_f32_16x16x64_bf16 v[104:107], a[68:71], a[20:27], v210
    s_nop 0
    ds_read_b64 a[156:157], v217 offset:10528
    v_smfmac_f32_16x16x64_bf16 v[108:111], a[68:71], a[24:31], v210
    s_waitcnt lgkmcnt(3)
    ds_read_b64 a[158:159], v217 offset:13120
    v_smfmac_f32_16x16x64_bf16 v[112:115], a[72:75], a[224:231], v210
    ds_read_b128 a[0:3], v209 offset:49968
    v_smfmac_f32_16x16x64_bf16 v[116:119], a[72:75], a[228:235], v210
    ds_read_b128 a[4:7], v209 offset:50112
    v_smfmac_f32_16x16x64_bf16 v[120:123], a[72:75], a[232:239], v210
    ds_read_b128 a[8:11], v209 offset:50256
    v_smfmac_f32_16x16x64_bf16 v[124:127], a[72:75], a[236:243], v210
    ds_read_b128 a[12:15], v209 offset:50400
    v_smfmac_f32_16x16x64_bf16 v[112:115], a[76:79], a[232:239], v210
    ds_read_b128 a[16:19], v209 offset:50544
    v_smfmac_f32_16x16x64_bf16 v[116:119], a[76:79], a[236:243], v210
    ds_read_b128 a[20:23], v209 offset:50688
    v_smfmac_f32_16x16x64_bf16 v[120:123], a[76:79], a[240:247], v210
    ds_read_b128 a[24:27], v209 offset:50832
    v_smfmac_f32_16x16x64_bf16 v[124:127], a[76:79], a[244:251], v210
    ds_read_b128 a[28:31], v209 offset:50976
    v_smfmac_f32_16x16x64_bf16 v[112:115], a[80:83], a[236:243], v210
    ds_read_b64 a[160:161], v218 offset:0
    v_smfmac_f32_16x16x64_bf16 v[116:119], a[80:83], a[240:247], v210
    ds_read_b64 a[162:163], v218 offset:2592
    v_smfmac_f32_16x16x64_bf16 v[120:123], a[80:83], a[244:251], v210
    s_nop 0
    ds_read_b64 a[164:165], v218 offset:10528
    v_smfmac_f32_16x16x64_bf16 v[124:127], a[80:83], a[248:255], v210
    s_waitcnt lgkmcnt(3)
    ds_read_b64 a[166:167], v218 offset:13120
    v_smfmac_f32_16x16x64_bf16 v[128:131], a[84:87], a[0:7], v210
    s_waitcnt vmcnt(9)
    ds_write_b64 v208, a[184:185] offset:0
    v_smfmac_f32_16x16x64_bf16 v[132:135], a[84:87], a[4:11], v210
    ds_write_b64 v208, a[186:187] offset:2592
    v_smfmac_f32_16x16x64_bf16 v[136:139], a[84:87], a[8:15], v210
    s_waitcnt vmcnt(8)
    ds_write_b64 v208, a[188:189] offset:288
    v_smfmac_f32_16x16x64_bf16 v[140:143], a[84:87], a[12:19], v210
    ds_write_b64 v208, a[190:191] offset:2880
    v_smfmac_f32_16x16x64_bf16 v[128:131], a[88:91], a[8:15], v210
    s_waitcnt vmcnt(7)
    ds_write_b64 v208, a[192:193] offset:576
    v_smfmac_f32_16x16x64_bf16 v[132:135], a[88:91], a[12:19], v210
    ds_write_b64 v208, a[194:195] offset:3168
    v_smfmac_f32_16x16x64_bf16 v[136:139], a[88:91], a[16:23], v210
    s_waitcnt vmcnt(6)
    ds_write_b64 v208, a[196:197] offset:864
    v_smfmac_f32_16x16x64_bf16 v[140:143], a[88:91], a[20:27], v210
    ds_write_b64 v208, a[198:199] offset:3456
    v_smfmac_f32_16x16x64_bf16 v[128:131], a[92:95], a[12:19], v210
    s_waitcnt vmcnt(5)
    ds_write_b64 v208, a[200:201] offset:1152
    v_smfmac_f32_16x16x64_bf16 v[132:135], a[92:95], a[16:23], v210
    s_nop 0
    ds_write_b64 v208, a[202:203] offset:3744
    v_smfmac_f32_16x16x64_bf16 v[136:139], a[92:95], a[20:27], v210
    s_waitcnt vmcnt(4)
    ds_write_b64 v208, a[204:205] offset:1440
    v_smfmac_f32_16x16x64_bf16 v[140:143], a[92:95], a[24:31], v210
    ds_write_b64 v208, a[206:207] offset:4032
    v_add_u32 v209, 84224, v209
    v_mov_b64 v[234:235], 0
    v_mov_b64 v[236:237], 0
    s_waitcnt vmcnt(3)
    ds_write_b64 v208, a[208:209] offset:1728
    v_mfma_f32_32x32x16_bf16 v[144:159], v[234:237], v[234:237], 0
    ds_write_b64 v208, a[210:211] offset:4320
    s_waitcnt vmcnt(2)
    ds_write_b64 v208, a[212:213] offset:2016
    v_mfma_f32_32x32x16_bf16 v[160:175], v[234:237], v[234:237], 0
    ds_write_b64 v208, a[214:215] offset:4608
    s_waitcnt vmcnt(1)
    ds_write_b64 v208, a[216:217] offset:2304
    v_mfma_f32_32x32x16_bf16 v[176:191], v[234:237], v[234:237], 0
    s_add_u32 m0, s41, 126464
    ds_write_b64 v208, a[218:219] offset:4896
    s_waitcnt vmcnt(0)
    ds_write_b64 v225, a[220:221] offset:128
    v_mfma_f32_32x32x16_bf16 v[192:207], v[234:237], v[234:237], 0
    s_add_u32 s42, s39, 0
    ds_write_b64 v225, a[222:223] offset:2720
    buffer_load_dwordx4 v13, s[8:11], s42 offen lds
    v_pk_add_f32 v[240:241], v[240:241], v[80:81]
    v_pk_fma_f32 v[248:249], v[80:81], v[80:81], v[248:249]
    v_pk_add_f32 v[242:243], v[242:243], v[84:85]
    v_pk_fma_f32 v[250:251], v[84:85], v[84:85], v[250:251]
    v_pk_add_f32 v[244:245], v[244:245], v[88:89]
    v_pk_fma_f32 v[252:253], v[88:89], v[88:89], v[252:253]
    v_pk_add_f32 v[246:247], v[246:247], v[92:93]
    v_pk_fma_f32 v[254:255], v[92:93], v[92:93], v[254:255]
    v_pk_add_f32 v[240:241], v[240:241], v[82:83]
    s_add_u32 m0, s41, 127488
    s_add_u32 s42, s39, 12288
    buffer_load_dwordx4 v14, s[8:11], s42 offen lds
    v_pk_fma_f32 v[248:249], v[82:83], v[82:83], v[248:249]
    v_pk_add_f32 v[242:243], v[242:243], v[86:87]
    v_pk_fma_f32 v[250:251], v[86:87], v[86:87], v[250:251]
    v_pk_add_f32 v[244:245], v[244:245], v[90:91]
    v_pk_fma_f32 v[252:253], v[90:91], v[90:91], v[252:253]
    v_pk_add_f32 v[246:247], v[246:247], v[94:95]
    v_pk_fma_f32 v[254:255], v[94:95], v[94:95], v[254:255]
    v_pk_add_f32 v[240:241], v[240:241], v[96:97]
    v_pk_fma_f32 v[248:249], v[96:97], v[96:97], v[248:249]
    s_add_u32 m0, s41, 128512
    s_add_u32 s42, s39, 24576
    buffer_load_dwordx4 v13, s[8:11], s42 offen lds
    v_pk_add_f32 v[242:243], v[242:243], v[100:101]
    v_pk_fma_f32 v[250:251], v[100:101], v[100:101], v[250:251]
    v_pk_add_f32 v[244:245], v[244:245], v[104:105]
    v_pk_fma_f32 v[252:253], v[104:105], v[104:105], v[252:253]
    v_pk_add_f32 v[246:247], v[246:247], v[108:109]
    v_pk_fma_f32 v[254:255], v[108:109], v[108:109], v[254:255]
    v_pk_add_f32 v[240:241], v[240:241], v[98:99]
    v_pk_fma_f32 v[248:249], v[98:99], v[98:99], v[248:249]
    v_pk_add_f32 v[242:243], v[242:243], v[102:103]
    v_pk_fma_f32 v[250:251], v[102:103], v[102:103], v[250:251]
    s_add_u32 m0, s41, 129536
    s_add_u32 s42, s39, 36864
    buffer_load_dwordx4 v14, s[8:11], s42 offen lds
    v_pk_add_f32 v[244:245], v[244:245], v[106:107]
    v_pk_fma_f32 v[252:253], v[106:107], v[106:107], v[252:253]
    v_pk_add_f32 v[246:247], v[246:247], v[110:111]
    v_pk_fma_f32 v[254:255], v[110:111], v[110:111], v[254:255]
    v_pk_add_f32 v[240:241], v[240:241], v[112:113]
    v_pk_fma_f32 v[248:249], v[112:113], v[112:113], v[248:249]
    v_pk_add_f32 v[242:243], v[242:243], v[116:117]
    v_pk_fma_f32 v[250:251], v[116:117], v[116:117], v[250:251]
    v_pk_add_f32 v[244:245], v[244:245], v[120:121]
    s_add_u32 m0, s41, 130560
    s_add_u32 s42, s39, 49152
    buffer_load_dwordx4 v13, s[8:11], s42 offen lds
    v_pk_fma_f32 v[252:253], v[120:121], v[120:121], v[252:253]
    v_pk_add_f32 v[246:247], v[246:247], v[124:125]
    v_pk_fma_f32 v[254:255], v[124:125], v[124:125], v[254:255]
    v_pk_add_f32 v[240:241], v[240:241], v[114:115]
    v_pk_fma_f32 v[248:249], v[114:115], v[114:115], v[248:249]
    v_pk_add_f32 v[242:243], v[242:243], v[118:119]
    v_pk_fma_f32 v[250:251], v[118:119], v[118:119], v[250:251]
    v_pk_add_f32 v[244:245], v[244:245], v[122:123]
L_pg2:
    s_cbranch_execz L_wu0
    v_pk_fma_f32 v[252:253], v[122:123], v[122:123], v[252:253]
    s_add_u32 m0, s41, 131584
    s_add_u32 s42, s39, 61440
    buffer_load_dwordx4 v14, s[8:11], s42 offen lds
    v_pk_add_f32 v[246:247], v[246:247], v[126:127]
    v_pk_fma_f32 v[254:255], v[126:127], v[126:127], v[254:255]
    v_pk_add_f32 v[240:241], v[240:241], v[128:129]
    v_pk_fma_f32 v[248:249], v[128:129], v[128:129], v[248:249]
    v_pk_add_f32 v[242:243], v[242:243], v[132:133]
    v_pk_fma_f32 v[250:251], v[132:133], v[132:133], v[250:251]
    v_pk_add_f32 v[244:245], v[244:245], v[136:137]
    v_pk_fma_f32 v[252:253], v[136:137], v[136:137], v[252:253]
    v_pk_add_f32 v[246:247], v[246:247], v[140:141]
    v_pk_fma_f32 v[254:255], v[140:141], v[140:141], v[254:255]
    s_add_u32 s39, s39, 128
    s_add_u32 s100, s100, 128
    s_lshr_b32 s33, s2, 3
    s_mul_i32 s34, s33, 9216
    v_min_u32 v211, 143, v0
    v_lshlrev_b32_e64 v211, 6, v211
    buffer_load_dword a40, v211, s[8:11], s34 offen
    buffer_load_dword a41, v211, s[12:15], s34 offen
    s_waitcnt lgkmcnt(0)
    s_barrier
    ds_read_b128 a[0:3], v209 offset:0
    ds_read_b128 a[4:7], v209 offset:144
    ds_read_b128 a[8:11], v209 offset:288
    ds_read_b128 a[12:15], v209 offset:432
    ds_read_b128 a[16:19], v209 offset:576
    ds_read_b128 a[20:23], v209 offset:720
    ds_read_b128 a[24:27], v209 offset:864
    ds_read_b128 a[28:31], v209 offset:1008
    v_pk_add_f32 v[240:241], v[240:241], v[130:131]
    v_pk_fma_f32 v[248:249], v[130:131], v[130:131], v[248:249]
    v_pk_add_f32 v[242:243], v[242:243], v[134:135]
    v_pk_fma_f32 v[250:251], v[134:135], v[134:135], v[250:251]
    v_pk_add_f32 v[244:245], v[244:245], v[138:139]
    v_pk_fma_f32 v[252:253], v[138:139], v[138:139], v[252:253]
    v_pk_add_f32 v[246:247], v[246:247], v[142:143]
    v_pk_fma_f32 v[254:255], v[142:143], v[142:143], v[254:255]
    s_waitcnt lgkmcnt(6)
    s_nop 0
    v_smfmac_f32_16x16x64_bf16 v[144:147], a[96:99], a[0:7], v210
    s_waitcnt lgkmcnt(5)
    ds_read_b128 a[48:51], v209 offset:2592
    v_smfmac_f32_16x16x64_bf16 v[148:151], a[96:99], a[4:11], v210
    s_waitcnt lgkmcnt(5)
    ds_read_b128 a[52:55], v209 offset:2736
    v_smfmac_f32_16x16x64_bf16 v[152:155], a[96:99], a[8:15], v210
    s_waitcnt lgkmcnt(3)
    ds_read_b128 a[56:59], v209 offset:2880
    v_smfmac_f32_16x16x64_bf16 v[156:159], a[96:99], a[12:19], v210
    ds_read_b128 a[60:63], v209 offset:3024
    v_smfmac_f32_16x16x64_bf16 v[144:147], a[100:103], a[8:15], v210
    ds_read_b128 a[64:67], v209 offset:3168
    v_smfmac_f32_16x16x64_bf16 v[148:151], a[100:103], a[12:19], v210
    ds_read_b128 a[68:71], v209 offset:3312
    v_smfmac_f32_16x16x64_bf16 v[152:155], a[100:103], a[16:23], v210
    s_nop 0
    ds_read_b128 a[72:75], v209 offset:3456
    v_smfmac_f32_16x16x64_bf16 v[156:159], a[100:103], a[20:27], v210
    ds_read_b128 a[76:79], v209 offset:3600
    v_smfmac_f32_16x16x64_bf16 v[144:147], a[104:107], a[12:19], v210
    ds_read_b64 a[216:217], v216 offset:21056
    v_smfmac_f32_16x16x64_bf16 v[148:151], a[104:107], a[16:23], v210
    s_nop 0
    ds_read_b64 a[218:219], v216 offset:23648
    v_smfmac_f32_16x16x64_bf16 v[152:155], a[104:107], a[20:27], v210
    s_waitcnt lgkmcnt(5)
    ds_read_b64 a[220:221], v216 offset:31584
    v_smfmac_f32_16x16x64_bf16 v[156:159], a[104:107], a[24:31], v210
    s_waitcnt lgkmcnt(3)
    ds_read_b64 a[222:223], v216 offset:34176
    v_smfmac_f32_16x16x64_bf16 v[160:163], a[108:111], a[48:55], v210
    ds_read_b128 a[0:3], v209 offset:5264
    v_smfmac_f32_16x16x64_bf16 v[164:167], a[108:111], a[52:59], v210
    s_nop 0
    ds_read_b128 a[4:7], v209 offset:5408
    v_smfmac_f32_16x16x64_bf16 v[168:171], a[108:111], a[56:63], v210
    ds_read_b128 a[8:11], v209 offset:5552
    v_smfmac_f32_16x16x64_bf16 v[172:175], a[108:111], a[60:67], v210
    ds_read_b128 a[12:15], v209 offset:5696
    v_smfmac_f32_16x16x64_bf16 v[160:163], a[112:115], a[56:63], v210
    ds_read_b128 a[16:19], v209 offset:5840
    v_smfmac_f32_16x16x64_bf16 v[164:167], a[112:115], a[60:67], v210
    ds_read_b128 a[20:23], v209 offset:5984
    v_smfmac_f32_16x16x64_bf16 v[168:171], a[112:115], a[64:71], v210
    ds_read_b128 a[24:27], v209 offset:6128
    v_smfmac_f32_16x16x64_bf16 v[172:175], a[112:115], a[68:75], v210
    ds_read_b128 a[28:31], v209 offset:6272
    v_smfmac_f32_16x16x64_bf16 v[160:163], a[116:119], a[60:67], v210
    ds_read_b64 a[224:225], v217 offset:21056
    v_smfmac_f32_16x16x64_bf16 v[164:167], a[116:119], a[64:71], v210
    ds_read_b64 a[226:227], v217 offset:23648
    v_smfmac_f32_16x16x64_bf16 v[168:171], a[116:119], a[68:75], v210
    ds_read_b64 a[228:229], v217 offset:31584
    v_smfmac_f32_16x16x64_bf16 v[172:175], a[116:119], a[72:79], v210
    s_waitcnt lgkmcnt(3)
    ds_read_b64 a[230:231], v217 offset:34176
    v_smfmac_f32_16x16x64_bf16 v[176:179], a[120:123], a[0:7], v210
    s_nop 0
    ds_read_b128 a[48:51], v209 offset:7856
    v_smfmac_f32_16x16x64_bf16 v[180:183], a[120:123], a[4:11], v210
    ds_read_b128 a[52:55], v209 offset:8000
    v_smfmac_f32_16x16x64_bf16 v[184:187], a[120:123], a[8:15], v210
    ds_read_b128 a[56:59], v209 offset:8144
    v_smfmac_f32_16x16x64_bf16 v[188:191], a[120:123], a[12:19], v210
    ds_read_b128 a[60:63], v209 offset:8288
    v_smfmac_f32_16x16x64_bf16 v[176:179], a[124:127], a[8:15], v210
    ds_read_b128 a[64:67], v209 offset:8432
    v_smfmac_f32_16x16x64_bf16 v[180:183], a[124:127], a[12:19], v210
    ds_read_b128 a[68:71], v209 offset:8576
    v_smfmac_f32_16x16x64_bf16 v[184:187], a[124:127], a[16:23], v210
    ds_read_b128 a[72:75], v209 offset:8720
    v_smfmac_f32_16x16x64_bf16 v[188:191], a[124:127], a[20:27], v210
    ds_read_b128 a[76:79], v209 offset:8864
    v_smfmac_f32_16x16x64_bf16 v[176:179], a[128:131], a[12:19], v210
    ds_read_b64 a[232:233], v218 offset:21056
    v_smfmac_f32_16x16x64_bf16 v[180:183], a[128:131], a[16:23], v210
    ds_read_b64 a[234:235], v218 offset:23648
    v_smfmac_f32_16x16x64_bf16 v[184:187], a[128:131], a[20:27], v210
    ds_read_b64 a[236:237], v218 offset:31584
    v_smfmac_f32_16x16x64_bf16 v[188:191], a[128:131], a[24:31], v210
    s_waitcnt lgkmcnt(3)
    ds_read_b64 a[238:239], v218 offset:34176
    v_smfmac_f32_16x16x64_bf16 v[192:195], a[132:135], a[48:55], v210
    s_nop 0
    ds_read_b64 a[240:241], v216 offset:42112
    v_smfmac_f32_16x16x64_bf16 v[196:199], a[132:135], a[52:59], v210
    ds_read_b64 a[242:243], v216 offset:44704
    v_smfmac_f32_16x16x64_bf16 v[200:203], a[132:135], a[56:63], v210
    ds_read_b64 a[244:245], v216 offset:52640
    v_smfmac_f32_16x16x64_bf16 v[204:207], a[132:135], a[60:67], v210
    ds_read_b64 a[246:247], v216 offset:55232
    v_smfmac_f32_16x16x64_bf16 v[192:195], a[136:139], a[56:63], v210
    ds_read_b64 a[248:249], v217 offset:42112
    v_smfmac_f32_16x16x64_bf16 v[196:199], a[136:139], a[60:67], v210
    ds_read_b64 a[250:251], v217 offset:44704
    v_smfmac_f32_16x16x64_bf16 v[200:203], a[136:139], a[64:71], v210
    ds_read_b64 a[252:253], v217 offset:52640
    v_smfmac_f32_16x16x64_bf16 v[204:207], a[136:139], a[68:75], v210
    ds_read_b64 a[254:255], v217 offset:55232
    v_smfmac_f32_16x16x64_bf16 v[192:195], a[140:143], a[60:67], v210
    ds_read_b64 a[88:89], v218 offset:42112
    v_smfmac_f32_16x16x64_bf16 v[196:199], a[140:143], a[64:71], v210
    s_nop 0
    ds_read_b64 a[90:91], v218 offset:44704
    v_smfmac_f32_16x16x64_bf16 v[200:203], a[140:143], a[68:75], v210
    s_add_u32 m0, s41, 101888
    ds_read_b64 a[92:93], v218 offset:52640
    v_smfmac_f32_16x16x64_bf16 v[204:207], a[140:143], a[72:79], v210
    s_add_u32 s42, s39, 0
    ds_read_b64 a[94:95], v218 offset:55232
    v_pk_add_f32 v[240:241], v[240:241], v[144:145]
    v_pk_fma_f32 v[248:249], v[144:145], v[144:145], v[248:249]
    v_pk_add_f32 v[242:243], v[242:243], v[148:149]
    v_pk_fma_f32 v[250:251], v[148:149], v[148:149], v[250:251]
    v_pk_add_f32 v[244:245], v[244:245], v[152:153]
    v_pk_fma_f32 v[252:253], v[152:153], v[152:153], v[252:253]
    v_pk_add_f32 v[246:247], v[246:247], v[156:157]
    v_pk_fma_f32 v[254:255], v[156:157], v[156:157], v[254:255]
    v_pk_add_f32 v[240:241], v[240:241], v[146:147]
    v_pk_fma_f32 v[248:249], v[146:147], v[146:147], v[248:249]
    v_pk_add_f32 v[242:243], v[242:243], v[150:151]
    v_pk_fma_f32 v[250:251], v[150:151], v[150:151], v[250:251]
    v_pk_add_f32 v[244:245], v[244:245], v[154:155]
    v_pk_fma_f32 v[252:253], v[154:155], v[154:155], v[252:253]
    v_pk_add_f32 v[246:247], v[246:247], v[158:159]
    v_pk_fma_f32 v[254:255], v[158:159], v[158:159], v[254:255]
    v_pk_add_f32 v[240:241], v[240:241], v[160:161]
    v_pk_fma_f32 v[248:249], v[160:161], v[160:161], v[248:249]
    v_pk_add_f32 v[242:243], v[242:243], v[164:165]
    v_pk_fma_f32 v[250:251], v[164:165], v[164:165], v[250:251]
    v_pk_add_f32 v[244:245], v[244:245], v[168:169]
    v_pk_fma_f32 v[252:253], v[168:169], v[168:169], v[252:253]
    v_pk_add_f32 v[246:247], v[246:247], v[172:173]
    v_pk_fma_f32 v[254:255], v[172:173], v[172:173], v[254:255]
    v_pk_add_f32 v[240:241], v[240:241], v[162:163]
    v_pk_fma_f32 v[248:249], v[162:163], v[162:163], v[248:249]
    v_pk_add_f32 v[242:243], v[242:243], v[166:167]
    v_pk_fma_f32 v[250:251], v[166:167], v[166:167], v[250:251]
    v_pk_add_f32 v[244:245], v[244:245], v[170:171]
    v_pk_fma_f32 v[252:253], v[170:171], v[170:171], v[252:253]
    v_pk_add_f32 v[246:247], v[246:247], v[174:175]
    v_pk_fma_f32 v[254:255], v[174:175], v[174:175], v[254:255]
    v_pk_add_f32 v[240:241], v[240:241], v[176:177]
    v_pk_fma_f32 v[248:249], v[176:177], v[176:177], v[248:249]
    v_pk_add_f32 v[242:243], v[242:243], v[180:181]
    v_pk_fma_f32 v[250:251], v[180:181], v[180:181], v[250:251]
    v_pk_add_f32 v[244:245], v[244:245], v[184:185]
    v_pk_fma_f32 v[252:253], v[184:185], v[184:185], v[252:253]
    v_pk_add_f32 v[246:247], v[246:247], v[188:189]
    v_pk_fma_f32 v[254:255], v[188:189], v[188:189], v[254:255]
    v_pk_add_f32 v[240:241], v[240:241], v[178:179]
    v_pk_fma_f32 v[248:249], v[178:179], v[178:179], v[248:249]
    v_pk_add_f32 v[242:243], v[242:243], v[182:183]
    v_pk_fma_f32 v[250:251], v[182:183], v[182:183], v[250:251]
    v_pk_add_f32 v[244:245], v[244:245], v[186:187]
    v_pk_fma_f32 v[252:253], v[186:187], v[186:187], v[252:253]
    v_pk_add_f32 v[246:247], v[246:247], v[190:191]
    v_pk_fma_f32 v[254:255], v[190:191], v[190:191], v[254:255]
    v_pk_add_f32 v[240:241], v[240:241], v[192:193]
    v_pk_fma_f32 v[248:249], v[192:193], v[192:193], v[248:249]
    v_pk_add_f32 v[242:243], v[242:243], v[196:197]
    v_pk_fma_f32 v[250:251], v[196:197], v[196:197], v[250:251]
    v_pk_add_f32 v[244:245], v[244:245], v[200:201]
    v_pk_fma_f32 v[252:253], v[200:201], v[200:201], v[252:253]
    v_pk_add_f32 v[246:247], v[246:247], v[204:205]
    v_pk_fma_f32 v[254:255], v[204:205], v[204:205], v[254:255]
    v_pk_add_f32 v[240:241], v[240:241], v[194:195]
    v_pk_fma_f32 v[248:249], v[194:195], v[194:195], v[248:249]
    v_pk_add_f32 v[242:243], v[242:243], v[198:199]
    v_pk_fma_f32 v[250:251], v[198:199], v[198:199], v[250:251]
    v_pk_add_f32 v[244:245], v[244:245], v[202:203]
    v_pk_fma_f32 v[252:253], v[202:203], v[202:203], v[252:253]
    v_pk_add_f32 v[246:247], v[246:247], v[206:207]
    v_pk_fma_f32 v[254:255], v[206:207], v[206:207], v[254:255]
    s_lshl_b32 s33, s28, 11
    v_add_u32 v223, s33, v219
    v_add_f32 v240, v240, v241
    v_add_f32 v241, v248, v249
    v_add_f32 v242, v242, v243
    v_add_f32 v243, v250, v251
    v_add_f32 v244, v244, v245
    v_add_f32 v245, v252, v253
    v_add_f32 v246, v246, v247
    v_add_f32 v247, v254, v255
    ds_write_b128 v223, v[240:243] offset:0
    ds_write_b128 v223, v[244:247] offset:1024
    s_waitcnt lgkmcnt(0)
    s_barrier
    ds_read_b128 v[240:243], v219 offset:0
    ds_read_b128 v[244:247], v219 offset:2048
    ds_read_b128 v[248:251], v219 offset:4096
    ds_read_b128 v[252:255], v219 offset:6144
    ds_read_b128 v[208:211], v219 offset:1024
    ds_read_b128 v[234:237], v219 offset:3072
    ds_read_b128 v[222:225], v219 offset:5120
    ds_read_b128 v[216:219], v219 offset:7168
    buffer_load_dwordx4 v13, s[8:11], s42 offen lds
    s_add_u32 m0, s41, 102912
    s_add_u32 s42, s39, 12288
    buffer_load_dwordx4 v14, s[8:11], s42 offen lds
    s_add_u32 m0, s41, 103936
    s_add_u32 s42, s39, 24576
    buffer_load_dwordx4 v13, s[8:11], s42 offen lds
    s_add_u32 m0, s41, 104960
    s_add_u32 s42, s39, 36864
    buffer_load_dwordx4 v14, s[8:11], s42 offen lds
    s_add_u32 m0, s41, 105984
    s_add_u32 s42, s39, 49152
    buffer_load_dwordx4 v13, s[8:11], s42 offen lds
    s_add_u32 m0, s41, 107008
    s_add_u32 s42, s39, 61440
    buffer_load_dwordx4 v14, s[8:11], s42 offen lds
    s_mov_b64 exec, 0
    s_cmp_eq_u32 s28, 0
    s_cbranch_scc1 L_pg13
    s_cmp_eq_u32 s28, 1
    s_cbranch_scc1 L_wu3
    s_cmp_eq_u32 s28, 2
    s_cbranch_scc1 L_wu3
    s_branch L_wu3
L_wu3:
    s_mov_b64 exec, -1
    s_mov_b32 s56, 0x3baaaaab
    s_mov_b32 s57, 0x3baaaaab
    s_waitcnt lgkmcnt(6)
    v_pk_add_f32 v[240:241], v[240:241], v[244:245]
    v_pk_add_f32 v[242:243], v[242:243], v[246:247]
    s_waitcnt lgkmcnt(4)
    v_pk_add_f32 v[248:249], v[248:249], v[252:253]
    v_pk_add_f32 v[250:251], v[250:251], v[254:255]
    v_pk_add_f32 v[240:241], v[240:241], v[248:249]
    v_pk_add_f32 v[242:243], v[242:243], v[250:251]
    s_waitcnt lgkmcnt(2)
    v_pk_add_f32 v[208:209], v[208:209], v[234:235]
    v_pk_add_f32 v[210:211], v[210:211], v[236:237]
    s_waitcnt lgkmcnt(0)
    v_pk_add_f32 v[222:223], v[222:223], v[216:217]
    v_pk_add_f32 v[224:225], v[224:225], v[218:219]
    v_pk_add_f32 v[208:209], v[208:209], v[222:223]
    v_pk_add_f32 v[210:211], v[210:211], v[224:225]
    v_mov_b32 v254, 0
    v_mov_b32 v255, 0x3727c5ac
    v_pk_fma_f32 v[240:241], v[240:241], s[56:57], v[254:255]
    v_pk_fma_f32 v[242:243], v[242:243], s[56:57], v[254:255]
    v_pk_fma_f32 v[208:209], v[208:209], s[56:57], v[254:255]
    v_pk_fma_f32 v[210:211], v[210:211], s[56:57], v[254:255]
    v_fma_f32 v241, -v240, v240, v241
    v_fma_f32 v243, -v242, v242, v243
    v_fma_f32 v209, -v208, v208, v209
    v_fma_f32 v211, -v210, v210, v211
    v_max_f32 v241, v255, v241
    v_max_f32 v243, v255, v243
    v_max_f32 v209, v255, v209
    v_max_f32 v211, v255, v211
    v_rsq_f32 v241, v241
    v_rsq_f32 v243, v243
    v_rsq_f32 v209, v209
    v_rsq_f32 v211, v211
    v_mul_f32 v241, s37, v241
    v_mul_f32 v243, s37, v243
    v_mul_f32 v209, s37, v209
    v_mul_f32 v211, s37, v211
    v_mul_f32 v240, -v240, v241
    v_mul_f32 v242, -v242, v243
    v_mul_f32 v208, -v208, v209
    v_mul_f32 v210, -v210, v211
    v_pk_fma_f32 v[16:17], v[16:17], v[240:241], v[240:241] op_sel:[0,1,0] op_sel_hi:[1,1,0]
    v_pk_fma_f32 v[18:19], v[18:19], v[240:241], v[240:241] op_sel:[0,1,0] op_sel_hi:[1,1,0]
    v_pk_fma_f32 v[32:33], v[32:33], v[240:241], v[240:241] op_sel:[0,1,0] op_sel_hi:[1,1,0]
    v_pk_fma_f32 v[34:35], v[34:35], v[240:241], v[240:241] op_sel:[0,1,0] op_sel_hi:[1,1,0]
    v_cvt_pk_bf16_f32 v244, v16, v17
    v_cvt_pk_bf16_f32 v245, v18, v19
    v_cvt_pk_bf16_f32 v246, v32, v33
    v_cvt_pk_bf16_f32 v247, v34, v35
    v_pk_fma_f32 v[20:21], v[20:21], v[242:243], v[242:243] op_sel:[0,1,0] op_sel_hi:[1,1,0]
    v_pk_fma_f32 v[22:23], v[22:23], v[242:243], v[242:243] op_sel:[0,1,0] op_sel_hi:[1,1,0]
    v_pk_fma_f32 v[36:37], v[36:37], v[242:243], v[242:243] op_sel:[0,1,0] op_sel_hi:[1,1,0]
    v_pk_fma_f32 v[38:39], v[38:39], v[242:243], v[242:243] op_sel:[0,1,0] op_sel_hi:[1,1,0]
    v_cvt_pk_bf16_f32 v248, v20, v21
    v_cvt_pk_bf16_f32 v249, v22, v23
    v_cvt_pk_bf16_f32 v250, v36, v37
    v_cvt_pk_bf16_f32 v251, v38, v39
    ds_write_b128 v212, v[244:247] offset:0
    ds_write_b128 v213, v[248:251] offset:0
    v_pk_fma_f32 v[24:25], v[24:25], v[208:209], v[208:209] op_sel:[0,1,0] op_sel_hi:[1,1,0]
    v_pk_fma_f32 v[26:27], v[26:27], v[208:209], v[208:209] op_sel:[0,1,0] op_sel_hi:[1,1,0]
    v_pk_fma_f32 v[40:41], v[40:41], v[208:209], v[208:209] op_sel:[0,1,0] op_sel_hi:[1,1,0]
    v_pk_fma_f32 v[42:43], v[42:43], v[208:209], v[208:209] op_sel:[0,1,0] op_sel_hi:[1,1,0]
    v_cvt_pk_bf16_f32 v244, v24, v25
    v_cvt_pk_bf16_f32 v245, v26, v27
    v_cvt_pk_bf16_f32 v246, v40, v41
    v_cvt_pk_bf16_f32 v247, v42, v43
    v_pk_fma_f32 v[28:29], v[28:29], v[210:211], v[210:211] op_sel:[0,1,0] op_sel_hi:[1,1,0]
    v_pk_fma_f32 v[30:31], v[30:31], v[210:211], v[210:211] op_sel:[0,1,0] op_sel_hi:[1,1,0]
    v_pk_fma_f32 v[44:45], v[44:45], v[210:211], v[210:211] op_sel:[0,1,0] op_sel_hi:[1,1,0]
    v_pk_fma_f32 v[46:47], v[46:47], v[210:211], v[210:211] op_sel:[0,1,0] op_sel_hi:[1,1,0]
    v_cvt_pk_bf16_f32 v248, v28, v29
    v_cvt_pk_bf16_f32 v249, v30, v31
    v_cvt_pk_bf16_f32 v250, v44, v45
    v_cvt_pk_bf16_f32 v251, v46, v47
    ds_write_b128 v214, v[244:247] offset:0
    ds_write_b128 v215, v[248:251] offset:0
    v_pk_fma_f32 v[48:49], v[48:49], v[240:241], v[240:241] op_sel:[0,1,0] op_sel_hi:[1,1,0]
    v_pk_fma_f32 v[50:51], v[50:51], v[240:241], v[240:241] op_sel:[0,1,0] op_sel_hi:[1,1,0]
    v_pk_fma_f32 v[64:65], v[64:65], v[240:241], v[240:241] op_sel:[0,1,0] op_sel_hi:[1,1,0]
    v_pk_fma_f32 v[66:67], v[66:67], v[240:241], v[240:241] op_sel:[0,1,0] op_sel_hi:[1,1,0]
    v_cvt_pk_bf16_f32 v244, v48, v49
    v_cvt_pk_bf16_f32 v245, v50, v51
    v_cvt_pk_bf16_f32 v246, v64, v65
    v_cvt_pk_bf16_f32 v247, v66, v67
    v_pk_fma_f32 v[52:53], v[52:53], v[242:243], v[242:243] op_sel:[0,1,0] op_sel_hi:[1,1,0]
    v_pk_fma_f32 v[54:55], v[54:55], v[242:243], v[242:243] op_sel:[0,1,0] op_sel_hi:[1,1,0]
    v_pk_fma_f32 v[68:69], v[68:69], v[242:243], v[242:243] op_sel:[0,1,0] op_sel_hi:[1,1,0]
    v_pk_fma_f32 v[70:71], v[70:71], v[242:243], v[242:243] op_sel:[0,1,0] op_sel_hi:[1,1,0]
    v_cvt_pk_bf16_f32 v248, v52, v53
    v_cvt_pk_bf16_f32 v249, v54, v55
    v_cvt_pk_bf16_f32 v250, v68, v69
    v_cvt_pk_bf16_f32 v251, v70, v71
    ds_write_b128 v212, v[244:247] offset:512
    ds_write_b128 v213, v[248:251] offset:512
    v_pk_fma_f32 v[56:57], v[56:57], v[208:209], v[208:209] op_sel:[0,1,0] op_sel_hi:[1,1,0]
    v_pk_fma_f32 v[58:59], v[58:59], v[208:209], v[208:209] op_sel:[0,1,0] op_sel_hi:[1,1,0]
    v_pk_fma_f32 v[72:73], v[72:73], v[208:209], v[208:209] op_sel:[0,1,0] op_sel_hi:[1,1,0]
    v_pk_fma_f32 v[74:75], v[74:75], v[208:209], v[208:209] op_sel:[0,1,0] op_sel_hi:[1,1,0]
    v_cvt_pk_bf16_f32 v244, v56, v57
    v_cvt_pk_bf16_f32 v245, v58, v59
    v_cvt_pk_bf16_f32 v246, v72, v73
    v_cvt_pk_bf16_f32 v247, v74, v75
    v_pk_fma_f32 v[60:61], v[60:61], v[210:211], v[210:211] op_sel:[0,1,0] op_sel_hi:[1,1,0]
    v_pk_fma_f32 v[62:63], v[62:63], v[210:211], v[210:211] op_sel:[0,1,0] op_sel_hi:[1,1,0]
    v_pk_fma_f32 v[76:77], v[76:77], v[210:211], v[210:211] op_sel:[0,1,0] op_sel_hi:[1,1,0]
    v_pk_fma_f32 v[78:79], v[78:79], v[210:211], v[210:211] op_sel:[0,1,0] op_sel_hi:[1,1,0]
    v_cvt_pk_bf16_f32 v248, v60, v61
    v_cvt_pk_bf16_f32 v249, v62, v63
    v_cvt_pk_bf16_f32 v250, v76, v77
    v_cvt_pk_bf16_f32 v251, v78, v79
    ds_write_b128 v214, v[244:247] offset:512
    ds_write_b128 v215, v[248:251] offset:512
    v_pk_fma_f32 v[80:81], v[80:81], v[240:241], v[240:241] op_sel:[0,1,0] op_sel_hi:[1,1,0]
    v_pk_fma_f32 v[82:83], v[82:83], v[240:241], v[240:241] op_sel:[0,1,0] op_sel_hi:[1,1,0]
    v_pk_fma_f32 v[96:97], v[96:97], v[240:241], v[240:241] op_sel:[0,1,0] op_sel_hi:[1,1,0]
    v_pk_fma_f32 v[98:99], v[98:99], v[240:241], v[240:241] op_sel:[0,1,0] op_sel_hi:[1,1,0]
    v_cvt_pk_bf16_f32 v244, v80, v81
    v_cvt_pk_bf16_f32 v245, v82, v83
    v_cvt_pk_bf16_f32 v246, v96, v97
    v_cvt_pk_bf16_f32 v247, v98, v99
    v_pk_fma_f32 v[84:85], v[84:85], v[242:243], v[242:243] op_sel:[0,1,0] op_sel_hi:[1,1,0]
    v_pk_fma_f32 v[86:87], v[86:87], v[242:243], v[242:243] op_sel:[0,1,0] op_sel_hi:[1,1,0]
    v_pk_fma_f32 v[100:101], v[100:101], v[242:243], v[242:243] op_sel:[0,1,0] op_sel_hi:[1,1,0]
    v_pk_fma_f32 v[102:103], v[102:103], v[242:243], v[242:243] op_sel:[0,1,0] op_sel_hi:[1,1,0]
    v_cvt_pk_bf16_f32 v248, v84, v85
    v_cvt_pk_bf16_f32 v249, v86, v87
    v_cvt_pk_bf16_f32 v250, v100, v101
    v_cvt_pk_bf16_f32 v251, v102, v103
    ds_write_b128 v212, v[244:247] offset:4096
    ds_write_b128 v213, v[248:251] offset:4096
    v_pk_fma_f32 v[88:89], v[88:89], v[208:209], v[208:209] op_sel:[0,1,0] op_sel_hi:[1,1,0]
    v_pk_fma_f32 v[90:91], v[90:91], v[208:209], v[208:209] op_sel:[0,1,0] op_sel_hi:[1,1,0]
    v_pk_fma_f32 v[104:105], v[104:105], v[208:209], v[208:209] op_sel:[0,1,0] op_sel_hi:[1,1,0]
    v_pk_fma_f32 v[106:107], v[106:107], v[208:209], v[208:209] op_sel:[0,1,0] op_sel_hi:[1,1,0]
    v_cvt_pk_bf16_f32 v244, v88, v89
    v_cvt_pk_bf16_f32 v245, v90, v91
    v_cvt_pk_bf16_f32 v246, v104, v105
    v_cvt_pk_bf16_f32 v247, v106, v107
    v_pk_fma_f32 v[92:93], v[92:93], v[210:211], v[210:211] op_sel:[0,1,0] op_sel_hi:[1,1,0]
    v_pk_fma_f32 v[94:95], v[94:95], v[210:211], v[210:211] op_sel:[0,1,0] op_sel_hi:[1,1,0]
    v_pk_fma_f32 v[108:109], v[108:109], v[210:211], v[210:211] op_sel:[0,1,0] op_sel_hi:[1,1,0]
    v_pk_fma_f32 v[110:111], v[110:111], v[210:211], v[210:211] op_sel:[0,1,0] op_sel_hi:[1,1,0]
    v_cvt_pk_bf16_f32 v248, v92, v93
    v_cvt_pk_bf16_f32 v249, v94, v95
    v_cvt_pk_bf16_f32 v250, v108, v109
    v_cvt_pk_bf16_f32 v251, v110, v111
    ds_write_b128 v214, v[244:247] offset:4096
    ds_write_b128 v215, v[248:251] offset:4096
    v_pk_fma_f32 v[112:113], v[112:113], v[240:241], v[240:241] op_sel:[0,1,0] op_sel_hi:[1,1,0]
    v_pk_fma_f32 v[114:115], v[114:115], v[240:241], v[240:241] op_sel:[0,1,0] op_sel_hi:[1,1,0]
    v_pk_fma_f32 v[128:129], v[128:129], v[240:241], v[240:241] op_sel:[0,1,0] op_sel_hi:[1,1,0]
    v_pk_fma_f32 v[130:131], v[130:131], v[240:241], v[240:241] op_sel:[0,1,0] op_sel_hi:[1,1,0]
    v_cvt_pk_bf16_f32 v244, v112, v113
    v_cvt_pk_bf16_f32 v245, v114, v115
    v_cvt_pk_bf16_f32 v246, v128, v129
    v_cvt_pk_bf16_f32 v247, v130, v131
    v_pk_fma_f32 v[116:117], v[116:117], v[242:243], v[242:243] op_sel:[0,1,0] op_sel_hi:[1,1,0]
    v_pk_fma_f32 v[118:119], v[118:119], v[242:243], v[242:243] op_sel:[0,1,0] op_sel_hi:[1,1,0]
    v_pk_fma_f32 v[132:133], v[132:133], v[242:243], v[242:243] op_sel:[0,1,0] op_sel_hi:[1,1,0]
    v_pk_fma_f32 v[134:135], v[134:135], v[242:243], v[242:243] op_sel:[0,1,0] op_sel_hi:[1,1,0]
    v_cvt_pk_bf16_f32 v248, v116, v117
    v_cvt_pk_bf16_f32 v249, v118, v119
    v_cvt_pk_bf16_f32 v250, v132, v133
    v_cvt_pk_bf16_f32 v251, v134, v135
    ds_write_b128 v212, v[244:247] offset:4608
    ds_write_b128 v213, v[248:251] offset:4608
    v_pk_fma_f32 v[120:121], v[120:121], v[208:209], v[208:209] op_sel:[0,1,0] op_sel_hi:[1,1,0]
    v_pk_fma_f32 v[122:123], v[122:123], v[208:209], v[208:209] op_sel:[0,1,0] op_sel_hi:[1,1,0]
    v_pk_fma_f32 v[136:137], v[136:137], v[208:209], v[208:209] op_sel:[0,1,0] op_sel_hi:[1,1,0]
    v_pk_fma_f32 v[138:139], v[138:139], v[208:209], v[208:209] op_sel:[0,1,0] op_sel_hi:[1,1,0]
    v_cvt_pk_bf16_f32 v244, v120, v121
    v_cvt_pk_bf16_f32 v245, v122, v123
    v_cvt_pk_bf16_f32 v246, v136, v137
    v_cvt_pk_bf16_f32 v247, v138, v139
    v_pk_fma_f32 v[124:125], v[124:125], v[210:211], v[210:211] op_sel:[0,1,0] op_sel_hi:[1,1,0]
    v_pk_fma_f32 v[126:127], v[126:127], v[210:211], v[210:211] op_sel:[0,1,0] op_sel_hi:[1,1,0]
    v_pk_fma_f32 v[140:141], v[140:141], v[210:211], v[210:211] op_sel:[0,1,0] op_sel_hi:[1,1,0]
    v_pk_fma_f32 v[142:143], v[142:143], v[210:211], v[210:211] op_sel:[0,1,0] op_sel_hi:[1,1,0]
    v_cvt_pk_bf16_f32 v248, v124, v125
    v_cvt_pk_bf16_f32 v249, v126, v127
    v_cvt_pk_bf16_f32 v250, v140, v141
    v_cvt_pk_bf16_f32 v251, v142, v143
    ds_write_b128 v214, v[244:247] offset:4608
    ds_write_b128 v215, v[248:251] offset:4608
    v_pk_fma_f32 v[144:145], v[144:145], v[240:241], v[240:241] op_sel:[0,1,0] op_sel_hi:[1,1,0]
    v_pk_fma_f32 v[146:147], v[146:147], v[240:241], v[240:241] op_sel:[0,1,0] op_sel_hi:[1,1,0]
    v_pk_fma_f32 v[160:161], v[160:161], v[240:241], v[240:241] op_sel:[0,1,0] op_sel_hi:[1,1,0]
    v_pk_fma_f32 v[162:163], v[162:163], v[240:241], v[240:241] op_sel:[0,1,0] op_sel_hi:[1,1,0]
    v_cvt_pk_bf16_f32 v244, v144, v145
    v_cvt_pk_bf16_f32 v245, v146, v147
    v_cvt_pk_bf16_f32 v246, v160, v161
    v_cvt_pk_bf16_f32 v247, v162, v163
    v_pk_fma_f32 v[148:149], v[148:149], v[242:243], v[242:243] op_sel:[0,1,0] op_sel_hi:[1,1,0]
    v_pk_fma_f32 v[150:151], v[150:151], v[242:243], v[242:243] op_sel:[0,1,0] op_sel_hi:[1,1,0]
    v_pk_fma_f32 v[164:165], v[164:165], v[242:243], v[242:243] op_sel:[0,1,0] op_sel_hi:[1,1,0]
    v_pk_fma_f32 v[166:167], v[166:167], v[242:243], v[242:243] op_sel:[0,1,0] op_sel_hi:[1,1,0]
    v_cvt_pk_bf16_f32 v248, v148, v149
    v_cvt_pk_bf16_f32 v249, v150, v151
    v_cvt_pk_bf16_f32 v250, v164, v165
    v_cvt_pk_bf16_f32 v251, v166, v167
    ds_write_b128 v212, v[244:247] offset:8192
    ds_write_b128 v213, v[248:251] offset:8192
    v_pk_fma_f32 v[152:153], v[152:153], v[208:209], v[208:209] op_sel:[0,1,0] op_sel_hi:[1,1,0]
    v_pk_fma_f32 v[154:155], v[154:155], v[208:209], v[208:209] op_sel:[0,1,0] op_sel_hi:[1,1,0]
    v_pk_fma_f32 v[168:169], v[168:169], v[208:209], v[208:209] op_sel:[0,1,0] op_sel_hi:[1,1,0]
    v_pk_fma_f32 v[170:171], v[170:171], v[208:209], v[208:209] op_sel:[0,1,0] op_sel_hi:[1,1,0]
    v_cvt_pk_bf16_f32 v244, v152, v153
    v_cvt_pk_bf16_f32 v245, v154, v155
    v_cvt_pk_bf16_f32 v246, v168, v169
    v_cvt_pk_bf16_f32 v247, v170, v171
    v_pk_fma_f32 v[156:157], v[156:157], v[210:211], v[210:211] op_sel:[0,1,0] op_sel_hi:[1,1,0]
    v_pk_fma_f32 v[158:159], v[158:159], v[210:211], v[210:211] op_sel:[0,1,0] op_sel_hi:[1,1,0]
    v_pk_fma_f32 v[172:173], v[172:173], v[210:211], v[210:211] op_sel:[0,1,0] op_sel_hi:[1,1,0]
    v_pk_fma_f32 v[174:175], v[174:175], v[210:211], v[210:211] op_sel:[0,1,0] op_sel_hi:[1,1,0]
    v_cvt_pk_bf16_f32 v248, v156, v157
    v_cvt_pk_bf16_f32 v249, v158, v159
    v_cvt_pk_bf16_f32 v250, v172, v173
    v_cvt_pk_bf16_f32 v251, v174, v175
    ds_write_b128 v214, v[244:247] offset:8192
    ds_write_b128 v215, v[248:251] offset:8192
    v_pk_fma_f32 v[176:177], v[176:177], v[240:241], v[240:241] op_sel:[0,1,0] op_sel_hi:[1,1,0]
    v_pk_fma_f32 v[178:179], v[178:179], v[240:241], v[240:241] op_sel:[0,1,0] op_sel_hi:[1,1,0]
    v_pk_fma_f32 v[192:193], v[192:193], v[240:241], v[240:241] op_sel:[0,1,0] op_sel_hi:[1,1,0]
    v_pk_fma_f32 v[194:195], v[194:195], v[240:241], v[240:241] op_sel:[0,1,0] op_sel_hi:[1,1,0]
    v_cvt_pk_bf16_f32 v244, v176, v177
    v_cvt_pk_bf16_f32 v245, v178, v179
    v_cvt_pk_bf16_f32 v246, v192, v193
    v_cvt_pk_bf16_f32 v247, v194, v195
    v_pk_fma_f32 v[180:181], v[180:181], v[242:243], v[242:243] op_sel:[0,1,0] op_sel_hi:[1,1,0]
    v_pk_fma_f32 v[182:183], v[182:183], v[242:243], v[242:243] op_sel:[0,1,0] op_sel_hi:[1,1,0]
    v_pk_fma_f32 v[196:197], v[196:197], v[242:243], v[242:243] op_sel:[0,1,0] op_sel_hi:[1,1,0]
    v_pk_fma_f32 v[198:199], v[198:199], v[242:243], v[242:243] op_sel:[0,1,0] op_sel_hi:[1,1,0]
    v_cvt_pk_bf16_f32 v248, v180, v181
    v_cvt_pk_bf16_f32 v249, v182, v183
    v_cvt_pk_bf16_f32 v250, v196, v197
    v_cvt_pk_bf16_f32 v251, v198, v199
    ds_write_b128 v212, v[244:247] offset:8704
    ds_write_b128 v213, v[248:251] offset:8704
    v_pk_fma_f32 v[184:185], v[184:185], v[208:209], v[208:209] op_sel:[0,1,0] op_sel_hi:[1,1,0]
    v_pk_fma_f32 v[186:187], v[186:187], v[208:209], v[208:209] op_sel:[0,1,0] op_sel_hi:[1,1,0]
    v_pk_fma_f32 v[200:201], v[200:201], v[208:209], v[208:209] op_sel:[0,1,0] op_sel_hi:[1,1,0]
    v_pk_fma_f32 v[202:203], v[202:203], v[208:209], v[208:209] op_sel:[0,1,0] op_sel_hi:[1,1,0]
    v_cvt_pk_bf16_f32 v244, v184, v185
    v_cvt_pk_bf16_f32 v245, v186, v187
    v_cvt_pk_bf16_f32 v246, v200, v201
    v_cvt_pk_bf16_f32 v247, v202, v203
    v_pk_fma_f32 v[188:189], v[188:189], v[210:211], v[210:211] op_sel:[0,1,0] op_sel_hi:[1,1,0]
    v_pk_fma_f32 v[190:191], v[190:191], v[210:211], v[210:211] op_sel:[0,1,0] op_sel_hi:[1,1,0]
    v_pk_fma_f32 v[204:205], v[204:205], v[210:211], v[210:211] op_sel:[0,1,0] op_sel_hi:[1,1,0]
    v_pk_fma_f32 v[206:207], v[206:207], v[210:211], v[210:211] op_sel:[0,1,0] op_sel_hi:[1,1,0]
    v_cvt_pk_bf16_f32 v248, v188, v189
    v_cvt_pk_bf16_f32 v249, v190, v191
    v_cvt_pk_bf16_f32 v250, v204, v205
    v_cvt_pk_bf16_f32 v251, v206, v207
    v_mfma_f32_32x32x16_bf16 v[144:159], v[226:229], a[88:91], 0
    ds_write_b128 v214, v[244:247] offset:8704
    ds_write_b128 v215, v[248:251] offset:8704
    v_mfma_f32_32x32x16_bf16 v[144:159], v[230:233], a[92:95], v[144:159]
    s_add_u32 s39, s39, 128
    s_add_u32 s100, s100, 128
    s_waitcnt vmcnt(8) lgkmcnt(0)
    s_barrier
    ds_read_b128 a[0:3], v220 offset:0
    ds_read_b64_tr_b16 a[168:169], v1 offset:24576
    ds_read_b64_tr_b16 a[170:171], v1 offset:25088
    ds_read_b128 a[4:7], v220 offset:1024
    ds_read_b64_tr_b16 a[172:173], v1 offset:26624
    ds_read_b64_tr_b16 a[174:175], v1 offset:27136
    ds_read_b128 a[8:11], v220 offset:2048
    ds_read_b64_tr_b16 a[176:177], v1 offset:28672
    ds_read_b64_tr_b16 a[178:179], v1 offset:29184
    ds_read_b128 a[12:15], v220 offset:3072
    ds_read_b64_tr_b16 a[180:181], v1 offset:30720
L_pg3:
    s_cbranch_execz L_wu0
    ds_read_b64_tr_b16 a[182:183], v1 offset:31232
    ds_read_b128 a[16:19], v220 offset:4096
    ds_read_b64_tr_b16 a[184:185], v1 offset:32768
    ds_read_b64_tr_b16 a[186:187], v1 offset:33280
    v_mfma_f32_32x32x16_bf16 v[16:31], v[226:229], a[144:147], 0
    s_waitcnt lgkmcnt(12)
    ds_read_b128 a[20:23], v220 offset:5120
    ds_read_b64_tr_b16 a[188:189], v1 offset:34816
    ds_read_b64_tr_b16 a[190:191], v1 offset:35328
    v_add_u32 v254, 22528, v13
    v_add_u32 v14, 11264, v14
    v_add_u32 v255, 22528, v14
    s_add_u32 s100, s39, 49152
    v_add_u32 v240, 128, v15
    v_mfma_f32_32x32x16_bf16 v[172:187], a[168:171], a[0:3], 0
    s_waitcnt lgkmcnt(12)
    ds_read_b128 a[24:27], v220 offset:6144
    ds_read_b64_tr_b16 a[192:193], v1 offset:36864
    ds_read_b64_tr_b16 a[194:195], v1 offset:37376
    v_add_u32 v241, 256, v15
    v_and_b32 v252, 63, v0
    v_cmp_gt_u32 vcc, 24, v252
    v_lshlrev_b32_e64 v252, 4, v252
    v_mov_b32 v251, 2147418112
    v_mfma_f32_32x32x16_bf16 v[172:187], a[172:175], a[4:7], v[172:187]
    s_waitcnt lgkmcnt(6)
    ds_read_b128 a[28:31], v220 offset:7168
    ds_read_b64_tr_b16 a[196:197], v1 offset:38912
    ds_read_b64_tr_b16 a[198:199], v1 offset:39424
    s_mul_i32 s33, s3, 6144
    s_mul_i32 s34, s38, 1536
    s_add_u32 s33, s33, s34
    s_mul_i32 s34, s28, 384
    s_add_u32 s42, s33, s34
    v_mfma_f32_32x32x16_bf16 v[172:187], a[176:179], a[8:11], v[172:187]
    ds_read_b128 a[32:35], v220 offset:8192
    ds_read_b64_tr_b16 a[200:201], v1 offset:40960
    ds_read_b64_tr_b16 a[202:203], v1 offset:41472
    v_cndmask_b32 v252, v251, v252, vcc
    v_cmp_eq_u32 vcc, 0, v0
    s_lshl_b32 s33, s3, 2
    v_mov_b32_e64 v250, s33
    v_cndmask_b32 v250, v251, v250, vcc
    v_mfma_f32_32x32x16_bf16 v[172:187], a[180:183], a[12:15], v[172:187]
    ds_read_b128 a[36:39], v220 offset:9216
    ds_read_b64_tr_b16 a[204:205], v1 offset:43008
    ds_read_b64_tr_b16 a[206:207], v1 offset:43520
    v_mfma_f32_32x32x16_bf16 v[172:187], a[184:187], a[16:19], v[172:187]
    s_waitcnt lgkmcnt(6)
    s_waitcnt vmcnt(6)
    ds_read_b128 a[40:43], v220 offset:10240
    ds_read_b64_tr_b16 a[208:209], v1 offset:45056
    ds_read_b64_tr_b16 a[210:211], v1 offset:45568
    v_mfma_f32_32x32x16_bf16 v[172:187], a[188:191], a[20:23], v[172:187]
    ds_read_b128 a[44:47], v220 offset:11264
    ds_read_b64_tr_b16 a[212:213], v1 offset:47104
    ds_read_b64_tr_b16 a[214:215], v1 offset:47616
    v_mfma_f32_32x32x16_bf16 v[172:187], a[192:195], a[24:27], v[172:187]
    s_nop 0
    ds_read_b128 v[244:247], v221
    ds_read_b128 a[48:51], v238 offset:12288
    v_mfma_f32_32x32x16_bf16 v[172:187], a[196:199], a[28:31], v[172:187]
    s_waitcnt lgkmcnt(5)
    ds_read_b128 a[52:55], v238 offset:13312
    v_mfma_f32_32x32x16_bf16 v[172:187], a[200:203], a[32:35], v[172:187]
    s_nop 0
    ds_read_b128 a[56:59], v238 offset:14336
    v_mfma_f32_32x32x16_bf16 v[172:187], a[204:207], a[36:39], v[172:187]
    s_waitcnt lgkmcnt(2)
    buffer_store_dwordx4 v[244:247], v252, s[24:27], s42 offen sc1
    ds_read_b128 a[60:63], v238 offset:15360
    v_mfma_f32_32x32x16_bf16 v[172:187], a[208:211], a[40:43], v[172:187]
    ds_read_b128 a[64:67], v238 offset:16384
    ds_read_b128 a[68:71], v238 offset:17408
    ds_read_b128 a[72:75], v238 offset:18432
    ds_read_b128 a[76:79], v238 offset:19456
    v_mfma_f32_32x32x16_bf16 v[172:187], a[212:215], a[44:47], v[172:187]
    ds_read_b128 a[80:83], v238 offset:20480
    ds_read_b128 a[84:87], v238 offset:21504
    ds_read_b128 a[88:91], v238 offset:22528
    ds_read_b128 a[92:95], v238 offset:23552
    v_mfma_f32_32x32x16_bf16 v[188:203], a[168:171], a[48:51], 0
    s_waitcnt lgkmcnt(8)
    ds_read_b128 a[96:99], v239 offset:24576
    ds_read_b128 a[100:103], v239 offset:25600
    ds_read_b128 a[104:107], v239 offset:26624
    ds_read_b128 a[108:111], v239 offset:27648
    v_mfma_f32_32x32x16_bf16 v[188:203], a[172:175], a[52:55], v[188:203]
    s_nop 0
    ds_read_b128 a[112:115], v239 offset:28672
    ds_read_b128 a[116:119], v239 offset:29696
    ds_read_b128 a[120:123], v239 offset:30720
    ds_read_b128 a[124:127], v239 offset:31744
    v_cvt_pk_f16_f32 v218, v172, v173
    v_cvt_pk_f16_f32 v220, v174, v175
    v_pk_fma_f16 v219, v218, v218, s36
    v_pk_fma_f16 v221, v220, v220, s36
    v_pk_mul_f16 v219, v219, v218
    v_pk_mul_f16 v221, v221, v220
    v_mfma_f32_32x32x16_bf16 v[188:203], a[176:179], a[56:59], v[188:203]
    ds_read_b128 a[128:131], v239 offset:32768
    ds_read_b128 a[132:135], v239 offset:33792
    ds_read_b128 a[136:139], v239 offset:34816
    ds_read_b128 a[140:143], v239 offset:35840
    v_exp_f16 v218, v219
    v_exp_f16 v220, v221
    v_exp_f16_sdwa v218, v219 dst_sel:WORD_1 dst_unused:UNUSED_PRESERVE src0_sel:WORD_1
    v_mfma_f32_32x32x16_bf16 v[188:203], a[180:183], a[60:63], v[188:203]
    s_waitcnt lgkmcnt(15)
    v_exp_f16_sdwa v220, v221 dst_sel:WORD_1 dst_unused:UNUSED_PRESERVE src0_sel:WORD_1
    v_pk_fma_f16 v218, v218, s101, s101
    v_pk_fma_f16 v220, v220, s101, s101
    v_rcp_f16 v219, v218
    v_rcp_f16_e64 v221, v220
    v_rcp_f16_sdwa v218, v218 dst_sel:WORD_0 dst_unused:UNUSED_PAD src0_sel:WORD_1
    v_mfma_f32_32x32x16_bf16 v[188:203], a[184:187], a[64:67], v[188:203]
    v_rcp_f16_sdwa v220, v220 dst_sel:WORD_0 dst_unused:UNUSED_PAD src0_sel:WORD_1
    v_fma_mix_f32 v219, v172, v219, 0 op_sel_hi:[0,1,0]
    v_fma_mix_f32 v221, v174, v221, 0 op_sel_hi:[0,1,0]
    v_fma_mix_f32 v218, v173, v218, 0 op_sel_hi:[0,1,0]
    v_fma_mix_f32 v220, v175, v220, 0 op_sel_hi:[0,1,0]
    v_cvt_pk_bf16_f32 v208, v219, v218
    v_cvt_pk_bf16_f32 v209, v221, v220
    v_cvt_pk_f16_f32 v222, v176, v177
    v_cvt_pk_f16_f32 v224, v178, v179
    v_pk_fma_f16 v223, v222, v222, s36
    v_mfma_f32_32x32x16_bf16 v[188:203], a[188:191], a[68:71], v[188:203]
    s_waitcnt vmcnt(1) lgkmcnt(0)
    s_barrier
    v_pk_fma_f16 v225, v224, v224, s36
    v_pk_mul_f16 v223, v223, v222
    v_pk_mul_f16 v225, v225, v224
    v_exp_f16 v222, v223
    v_exp_f16 v224, v225
    v_exp_f16_sdwa v222, v223 dst_sel:WORD_1 dst_unused:UNUSED_PRESERVE src0_sel:WORD_1
    v_mfma_f32_32x32x16_bf16 v[188:203], a[192:195], a[72:75], v[188:203]
    s_add_u32 m0, s41, 0
    v_exp_f16_sdwa v224, v225 dst_sel:WORD_1 dst_unused:UNUSED_PRESERVE src0_sel:WORD_1
    v_pk_fma_f16 v222, v222, s101, s101
    v_pk_fma_f16 v224, v224, s101, s101
    v_rcp_f16 v223, v222
    v_rcp_f16_e64 v225, v224
    v_rcp_f16_sdwa v222, v222 dst_sel:WORD_0 dst_unused:UNUSED_PAD src0_sel:WORD_1
    v_mfma_f32_32x32x16_bf16 v[188:203], a[196:199], a[76:79], v[188:203]
    buffer_load_dwordx4 v15, s[12:15], s40 offen offset:0  lds
    v_rcp_f16_sdwa v224, v224 dst_sel:WORD_0 dst_unused:UNUSED_PAD src0_sel:WORD_1
    v_fma_mix_f32 v223, v176, v223, 0 op_sel_hi:[0,1,0]
    v_fma_mix_f32 v225, v178, v225, 0 op_sel_hi:[0,1,0]
    v_fma_mix_f32 v222, v177, v222, 0 op_sel_hi:[0,1,0]
    v_fma_mix_f32 v224, v179, v224, 0 op_sel_hi:[0,1,0]
    v_cvt_pk_bf16_f32 v210, v223, v222
    v_cvt_pk_bf16_f32 v211, v225, v224
    v_cvt_pk_f16_f32 v218, v180, v181
    v_mfma_f32_32x32x16_bf16 v[16:31], v[230:233], a[148:151], v[16:31]
    ds_write_b128 v10, v[208:211] offset:0
    v_cvt_pk_f16_f32 v220, v182, v183
    v_pk_fma_f16 v219, v218, v218, s36
    v_pk_fma_f16 v221, v220, v220, s36
    v_pk_mul_f16 v219, v219, v218
    v_pk_mul_f16 v221, v221, v220
    v_mfma_f32_32x32x16_bf16 v[188:203], a[200:203], a[80:83], v[188:203]
    v_exp_f16 v218, v219
    v_exp_f16 v220, v221
    v_exp_f16_sdwa v218, v219 dst_sel:WORD_1 dst_unused:UNUSED_PRESERVE src0_sel:WORD_1
    v_exp_f16_sdwa v220, v221 dst_sel:WORD_1 dst_unused:UNUSED_PRESERVE src0_sel:WORD_1
    v_pk_fma_f16 v218, v218, s101, s101
    v_pk_fma_f16 v220, v220, s101, s101
    v_mfma_f32_32x32x16_bf16 v[32:47], v[226:229], a[216:219], 0
    v_rcp_f16 v219, v218
    v_rcp_f16 v221, v220
    v_rcp_f16_sdwa v218, v218 dst_sel:WORD_0 dst_unused:UNUSED_PAD src0_sel:WORD_1
    v_rcp_f16_sdwa v220, v220 dst_sel:WORD_0 dst_unused:UNUSED_PAD src0_sel:WORD_1
    v_fma_mix_f32 v219, v180, v219, 0 op_sel_hi:[0,1,0]
    v_fma_mix_f32 v221, v182, v221, 0 op_sel_hi:[0,1,0]
    v_fma_mix_f32 v218, v181, v218, 0 op_sel_hi:[0,1,0]
    v_mfma_f32_32x32x16_bf16 v[188:203], a[204:207], a[84:87], v[188:203]
    buffer_load_dwordx4 v15, s[12:15], s40 offen offset:3072  lds
    v_fma_mix_f32 v220, v183, v220, 0 op_sel_hi:[0,1,0]
    v_cvt_pk_bf16_f32 v212, v219, v218
    v_cvt_pk_bf16_f32 v213, v221, v220
    v_cvt_pk_f16_f32 v222, v184, v185
    v_cvt_pk_f16_f32 v224, v186, v187
    v_pk_fma_f16 v223, v222, v222, s36
    v_pk_fma_f16 v225, v224, v224, s36
    v_pk_mul_f16 v223, v223, v222
    v_pk_mul_f16 v225, v225, v224
    v_mfma_f32_32x32x16_bf16 v[188:203], a[208:211], a[88:91], v[188:203]
    s_add_u32 m0, s41, 1024
    s_nop 0
    buffer_load_dwordx4 v240, s[12:15], s40 offen offset:0  lds
    v_exp_f16 v222, v223
    v_exp_f16_e64 v224, v225
    v_exp_f16_sdwa v222, v223 dst_sel:WORD_1 dst_unused:UNUSED_PRESERVE src0_sel:WORD_1
    v_exp_f16_sdwa v224, v225 dst_sel:WORD_1 dst_unused:UNUSED_PRESERVE src0_sel:WORD_1
    v_pk_fma_f16 v222, v222, s101, s101
    v_mfma_f32_32x32x16_bf16 v[32:47], v[230:233], a[220:223], v[32:47]
    v_pk_fma_f16 v224, v224, s101, s101
    v_rcp_f16 v223, v222
    v_rcp_f16 v225, v224
    v_rcp_f16_sdwa v222, v222 dst_sel:WORD_0 dst_unused:UNUSED_PAD src0_sel:WORD_1
    v_rcp_f16_sdwa v224, v224 dst_sel:WORD_0 dst_unused:UNUSED_PAD src0_sel:WORD_1
    v_fma_mix_f32 v223, v184, v223, 0 op_sel_hi:[0,1,0]
    v_fma_mix_f32 v225, v186, v225, 0 op_sel_hi:[0,1,0]
    v_mfma_f32_32x32x16_bf16 v[188:203], a[212:215], a[92:95], v[188:203]
    buffer_load_dwordx4 v240, s[12:15], s40 offen offset:3072  lds
    v_fma_mix_f32 v222, v185, v222, 0 op_sel_hi:[0,1,0]
    v_fma_mix_f32 v224, v187, v224, 0 op_sel_hi:[0,1,0]
    v_cvt_pk_bf16_f32 v214, v223, v222
    v_cvt_pk_bf16_f32 v215, v225, v224
    v_mfma_f32_32x32x16_bf16 v[172:187], a[168:171], a[96:99], 0
    s_nop 0
    ds_write_b128 v10, v[212:215] offset:1024
    v_mfma_f32_32x32x16_bf16 v[48:63], v[226:229], a[240:243], 0
    s_nop 3
    v_cvt_pk_f16_f32 v218, v188, v189
    v_cvt_pk_f16_f32 v220, v190, v191
    v_pk_fma_f16 v219, v218, v218, s36
    v_pk_fma_f16 v221, v220, v220, s36
    v_pk_mul_f16 v219, v219, v218
    v_pk_mul_f16 v221, v221, v220
    v_exp_f16 v218, v219
    v_mfma_f32_32x32x16_bf16 v[172:187], a[172:175], a[100:103], v[172:187]
    s_add_u32 m0, s41, 2048
    v_exp_f16 v220, v221
    v_exp_f16_sdwa v218, v219 dst_sel:WORD_1 dst_unused:UNUSED_PRESERVE src0_sel:WORD_1
    v_exp_f16_sdwa v220, v221 dst_sel:WORD_1 dst_unused:UNUSED_PRESERVE src0_sel:WORD_1
    v_pk_fma_f16 v218, v218, s101, s101
    v_pk_fma_f16 v220, v220, s101, s101
    v_mfma_f32_32x32x16_bf16 v[48:63], v[230:233], a[244:247], v[48:63]
    buffer_load_dwordx4 v241, s[12:15], s40 offen offset:0  lds
    v_rcp_f16 v219, v218
    v_rcp_f16 v221, v220
    v_rcp_f16_sdwa v218, v218 dst_sel:WORD_0 dst_unused:UNUSED_PAD src0_sel:WORD_1
    v_mfma_f32_32x32x16_bf16 v[172:187], a[176:179], a[104:107], v[172:187]
    buffer_load_dwordx4 v241, s[12:15], s40 offen offset:3072  lds
    v_rcp_f16_sdwa v220, v220 dst_sel:WORD_0 dst_unused:UNUSED_PAD src0_sel:WORD_1
    v_fma_mix_f32 v219, v188, v219, 0 op_sel_hi:[0,1,0]
    v_fma_mix_f32 v221, v190, v221, 0 op_sel_hi:[0,1,0]
    v_fma_mix_f32 v218, v189, v218, 0 op_sel_hi:[0,1,0]
    v_fma_mix_f32 v220, v191, v220, 0 op_sel_hi:[0,1,0]
    v_cvt_pk_bf16_f32 v208, v219, v218
    v_mfma_f32_32x32x16_bf16 v[172:187], a[180:183], a[108:111], v[172:187]
    s_add_u32 m0, s41, 126464
    ds_read_b64_tr_b16 a[168:169], v1 offset:0
    ds_read_b64_tr_b16 a[176:177], v1 offset:4096
    v_cvt_pk_bf16_f32 v209, v221, v220
    v_cvt_pk_f16_f32 v222, v192, v193
    v_cvt_pk_f16_f32 v224, v194, v195
    v_pk_fma_f16 v223, v222, v222, s36
    v_pk_fma_f16 v225, v224, v224, s36
    v_pk_mul_f16 v223, v223, v222
    v_pk_mul_f16 v225, v225, v224
    v_mfma_f32_32x32x16_bf16 v[64:79], v[226:229], a[152:155], 0
    buffer_load_dwordx4 v13, s[8:11], s39 offen offset:0  lds
    v_exp_f16 v222, v223
    v_exp_f16 v224, v225
    v_exp_f16_sdwa v222, v223 dst_sel:WORD_1 dst_unused:UNUSED_PRESERVE src0_sel:WORD_1
    v_mfma_f32_32x32x16_bf16 v[172:187], a[184:187], a[112:115], v[172:187]
    ds_read_b64_tr_b16 a[170:171], v1 offset:512
    ds_read_b64_tr_b16 a[178:179], v1 offset:4608
    v_exp_f16_sdwa v224, v225 dst_sel:WORD_1 dst_unused:UNUSED_PRESERVE src0_sel:WORD_1
    v_pk_fma_f16 v222, v222, s101, s101
    v_pk_fma_f16 v224, v224, s101, s101
    v_rcp_f16 v223, v222
    v_rcp_f16 v225, v224
    v_mfma_f32_32x32x16_bf16 v[172:187], a[188:191], a[116:119], v[172:187]
    buffer_load_dwordx4 v14, s[8:11], s39 offen offset:1024  lds
    ds_read_b64_tr_b16 a[188:189], v1 offset:10240
    ds_read_b64_tr_b16 a[190:191], v1 offset:10752
    v_rcp_f16_sdwa v222, v222 dst_sel:WORD_0 dst_unused:UNUSED_PAD src0_sel:WORD_1
    v_rcp_f16_sdwa v224, v224 dst_sel:WORD_0 dst_unused:UNUSED_PAD src0_sel:WORD_1
    v_fma_mix_f32 v223, v192, v223, 0 op_sel_hi:[0,1,0]
    v_mfma_f32_32x32x16_bf16 v[64:79], v[230:233], a[156:159], v[64:79]
    ds_read_b64_tr_b16 a[172:173], v1 offset:2048
    ds_read_b64_tr_b16 a[182:183], v1 offset:6656
    v_fma_mix_f32 v225, v194, v225, 0 op_sel_hi:[0,1,0]
    v_fma_mix_f32 v222, v193, v222, 0 op_sel_hi:[0,1,0]
    v_fma_mix_f32 v224, v195, v224, 0 op_sel_hi:[0,1,0]
    v_cvt_pk_bf16_f32 v210, v223, v222
    v_cvt_pk_bf16_f32 v211, v225, v224
    v_cvt_pk_f16_f32 v218, v196, v197
    v_cvt_pk_f16_f32 v220, v198, v199
    v_mfma_f32_32x32x16_bf16 v[172:187], a[192:195], a[120:123], v[172:187]
    ds_write_b128 v10, v[208:211] offset:4096
    v_pk_fma_f16 v219, v218, v218, s36
    v_pk_fma_f16 v221, v220, v220, s36
    v_pk_mul_f16 v219, v219, v218
    v_pk_mul_f16 v221, v221, v220
    v_mfma_f32_32x32x16_bf16 v[172:187], a[196:199], a[124:127], v[172:187]
    v_exp_f16 v218, v219
    v_exp_f16 v220, v221
    v_exp_f16_sdwa v218, v219 dst_sel:WORD_1 dst_unused:UNUSED_PRESERVE src0_sel:WORD_1
    v_exp_f16_sdwa v220, v221 dst_sel:WORD_1 dst_unused:UNUSED_PRESERVE src0_sel:WORD_1
    v_pk_fma_f16 v218, v218, s101, s101
    v_mfma_f32_32x32x16_bf16 v[80:95], v[226:229], a[224:227], 0
    v_pk_fma_f16 v220, v220, s101, s101
    v_rcp_f16 v219, v218
    v_rcp_f16 v221, v220
    v_rcp_f16_sdwa v218, v218 dst_sel:WORD_0 dst_unused:UNUSED_PAD src0_sel:WORD_1
    v_rcp_f16_sdwa v220, v220 dst_sel:WORD_0 dst_unused:UNUSED_PAD src0_sel:WORD_1
    v_mfma_f32_32x32x16_bf16 v[172:187], a[200:203], a[128:131], v[172:187]
    buffer_load_dwordx4 v254, s[8:11], s39 offen offset:2048  lds
    v_fma_mix_f32 v219, v196, v219, 0 op_sel_hi:[0,1,0]
    v_fma_mix_f32 v221, v198, v221, 0 op_sel_hi:[0,1,0]
    v_fma_mix_f32 v218, v197, v218, 0 op_sel_hi:[0,1,0]
    v_fma_mix_f32 v220, v199, v220, 0 op_sel_hi:[0,1,0]
    v_cvt_pk_bf16_f32 v212, v219, v218
    v_cvt_pk_bf16_f32 v213, v221, v220
    v_cvt_pk_f16_f32 v222, v200, v201
    v_mfma_f32_32x32x16_bf16 v[80:95], v[230:233], a[228:231], v[80:95]
    buffer_load_dwordx4 v255, s[8:11], s39 offen offset:3072  lds
    v_cvt_pk_f16_f32 v224, v202, v203
    v_pk_fma_f16 v223, v222, v222, s36
    v_pk_fma_f16 v225, v224, v224, s36
    v_pk_mul_f16 v223, v223, v222
    v_pk_mul_f16 v225, v225, v224
    v_exp_f16 v222, v223
    v_mfma_f32_32x32x16_bf16 v[172:187], a[204:207], a[132:135], v[172:187]
    s_add_u32 m0, s41, 130560
    ds_read_b64_tr_b16 a[174:175], v1 offset:2560
    ds_read_b64_tr_b16 a[184:185], v1 offset:8192
    v_exp_f16 v224, v225
    v_exp_f16_sdwa v222, v223 dst_sel:WORD_1 dst_unused:UNUSED_PRESERVE src0_sel:WORD_1
    v_exp_f16_sdwa v224, v225 dst_sel:WORD_1 dst_unused:UNUSED_PRESERVE src0_sel:WORD_1
    v_pk_fma_f16 v222, v222, s101, s101
    v_mfma_f32_32x32x16_bf16 v[172:187], a[208:211], a[136:139], v[172:187]
    buffer_load_dwordx4 v13, s[8:11], s100 offen offset:0  lds
    v_pk_fma_f16 v224, v224, s101, s101
    v_rcp_f16_e64 v223, v222
    v_rcp_f16_e64 v225, v224
    v_rcp_f16_sdwa v222, v222 dst_sel:WORD_0 dst_unused:UNUSED_PAD src0_sel:WORD_1
    v_mfma_f32_32x32x16_bf16 v[96:111], v[226:229], a[248:251], 0
    ds_read_b64_tr_b16 a[180:181], v1 offset:6144
    ds_read_b64_tr_b16 a[186:187], v1 offset:8704
    v_rcp_f16_sdwa v224, v224 dst_sel:WORD_0 dst_unused:UNUSED_PAD src0_sel:WORD_1
    v_fma_mix_f32 v223, v200, v223, 0 op_sel_hi:[0,1,0]
    v_fma_mix_f32 v225, v202, v225, 0 op_sel_hi:[0,1,0]
    v_fma_mix_f32 v222, v201, v222, 0 op_sel_hi:[0,1,0]
    v_fma_mix_f32 v224, v203, v224, 0 op_sel_hi:[0,1,0]
    v_cvt_pk_bf16_f32 v214, v223, v222
    v_mfma_f32_32x32x16_bf16 v[172:187], a[212:215], a[140:143], v[172:187]
    s_waitcnt lgkmcnt(3)
    buffer_load_dwordx4 v14, s[8:11], s100 offen offset:1024  lds
    v_cvt_pk_bf16_f32 v215, v225, v224
    v_mfma_f32_32x32x16_bf16 v[188:203], a[168:171], a[0:3], 0
    s_nop 0
    ds_write_b128 v10, v[212:215] offset:5120
    v_mfma_f32_32x32x16_bf16 v[96:111], v[230:233], a[252:255], v[96:111]
    s_nop 5
    v_cvt_pk_f16_f32 v218, v172, v173
    v_cvt_pk_f16_f32 v220, v174, v175
    v_pk_fma_f16 v219, v218, v218, s36
    v_pk_fma_f16 v221, v220, v220, s36
    v_pk_mul_f16 v219, v219, v218
    v_pk_mul_f16 v221, v221, v220
    v_exp_f16 v218, v219
    v_mfma_f32_32x32x16_bf16 v[188:203], a[172:175], a[4:7], v[188:203]
    v_exp_f16_e64 v220, v221
    v_exp_f16_sdwa v218, v219 dst_sel:WORD_1 dst_unused:UNUSED_PRESERVE src0_sel:WORD_1
    v_exp_f16_sdwa v220, v221 dst_sel:WORD_1 dst_unused:UNUSED_PRESERVE src0_sel:WORD_1
    v_pk_fma_f16 v218, v218, s101, s101
    v_pk_fma_f16 v220, v220, s101, s101
    v_mfma_f32_32x32x16_bf16 v[188:203], a[176:179], a[8:11], v[188:203]
    ds_read_b64_tr_b16 a[192:193], v1 offset:12288
    ds_read_b64_tr_b16 a[198:199], v1 offset:14848
    v_rcp_f16 v219, v218
    v_rcp_f16_e64 v221, v220
    v_rcp_f16_sdwa v218, v218 dst_sel:WORD_0 dst_unused:UNUSED_PAD src0_sel:WORD_1
    v_rcp_f16_sdwa v220, v220 dst_sel:WORD_0 dst_unused:UNUSED_PAD src0_sel:WORD_1
    v_mfma_f32_32x32x16_bf16 v[112:127], v[226:229], a[160:163], 0
    s_waitcnt lgkmcnt(3)
    ds_read_b64_tr_b16 a[194:195], v1 offset:12800
    ds_read_b64_tr_b16 a[206:207], v1 offset:18944
    v_fma_mix_f32 v219, v172, v219, 0 op_sel_hi:[0,1,0]
    v_fma_mix_f32 v221, v174, v221, 0 op_sel_hi:[0,1,0]
    v_fma_mix_f32 v218, v173, v218, 0 op_sel_hi:[0,1,0]
    v_fma_mix_f32 v220, v175, v220, 0 op_sel_hi:[0,1,0]
    v_cvt_pk_bf16_f32 v208, v219, v218
    v_cvt_pk_bf16_f32 v209, v221, v220
    v_cvt_pk_f16_f32 v222, v176, v177
    v_mfma_f32_32x32x16_bf16 v[188:203], a[180:183], a[12:15], v[188:203]
    ds_read_b64_tr_b16 a[196:197], v1 offset:14336
    ds_read_b64_tr_b16 a[210:211], v1 offset:20992
    v_cvt_pk_f16_f32 v224, v178, v179
    v_pk_fma_f16 v223, v222, v222, s36
    v_pk_fma_f16 v225, v224, v224, s36
    v_pk_mul_f16 v223, v223, v222
    v_pk_mul_f16 v225, v225, v224
    v_exp_f16_e64 v222, v223
    v_mfma_f32_32x32x16_bf16 v[112:127], v[230:233], a[164:167], v[112:127]
    ds_read_b64_tr_b16 a[200:201], v1 offset:16384
    ds_read_b64_tr_b16 a[212:213], v1 offset:22528
    v_exp_f16_e64 v224, v225
    v_exp_f16_sdwa v222, v223 dst_sel:WORD_1 dst_unused:UNUSED_PRESERVE src0_sel:WORD_1
    v_exp_f16_sdwa v224, v225 dst_sel:WORD_1 dst_unused:UNUSED_PRESERVE src0_sel:WORD_1
    v_pk_fma_f16 v222, v222, s101, s101
    v_mfma_f32_32x32x16_bf16 v[188:203], a[184:187], a[16:19], v[188:203]
    ds_read_b64_tr_b16 a[202:203], v1 offset:16896
    ds_read_b64_tr_b16 a[214:215], v1 offset:23040
    v_pk_fma_f16 v224, v224, s101, s101
    v_rcp_f16_e64 v223, v222
    v_rcp_f16_e64 v225, v224
    v_rcp_f16_sdwa v222, v222 dst_sel:WORD_0 dst_unused:UNUSED_PAD src0_sel:WORD_1
    v_mfma_f32_32x32x16_bf16 v[188:203], a[188:191], a[20:23], v[188:203]
    ds_read_b64_tr_b16 a[204:205], v1 offset:18432
    v_rcp_f16_sdwa v224, v224 dst_sel:WORD_0 dst_unused:UNUSED_PAD src0_sel:WORD_1
    v_fma_mix_f32 v223, v176, v223, 0 op_sel_hi:[0,1,0]
    v_fma_mix_f32 v225, v178, v225, 0 op_sel_hi:[0,1,0]
    v_fma_mix_f32 v222, v177, v222, 0 op_sel_hi:[0,1,0]
    v_fma_mix_f32 v224, v179, v224, 0 op_sel_hi:[0,1,0]
    v_cvt_pk_bf16_f32 v210, v223, v222
    v_cvt_pk_bf16_f32 v211, v225, v224
    v_mfma_f32_32x32x16_bf16 v[128:143], v[226:229], a[232:235], 0
    s_waitcnt lgkmcnt(5)
    ds_read_b64_tr_b16 a[208:209], v1 offset:20480
    v_cvt_pk_f16_f32 v218, v180, v181
    v_cvt_pk_f16_f32 v220, v182, v183
    v_pk_fma_f16 v219, v218, v218, s36
    v_pk_fma_f16 v221, v220, v220, s36
    v_pk_mul_f16 v219, v219, v218
    v_pk_mul_f16 v221, v221, v220
    v_exp_f16 v218, v219
    v_mfma_f32_32x32x16_bf16 v[188:203], a[192:195], a[24:27], v[188:203]
    ds_write_b128 v10, v[208:211] offset:8192
    v_exp_f16 v220, v221
    v_exp_f16_sdwa v218, v219 dst_sel:WORD_1 dst_unused:UNUSED_PRESERVE src0_sel:WORD_1
    v_mfma_f32_32x32x16_bf16 v[188:203], a[196:199], a[28:31], v[188:203]
    s_cmp_eq_u32 s38, 3
    s_cselect_b32 s56, 1536, 0
    v_exp_f16_sdwa v220, v221 dst_sel:WORD_1 dst_unused:UNUSED_PRESERVE src0_sel:WORD_1
    v_pk_fma_f16 v218, v218, s101, s101
    v_pk_fma_f16 v220, v220, s101, s101
    v_rcp_f16 v219, v218
    v_rcp_f16_e64 v221, v220
    v_mfma_f32_32x32x16_bf16 v[128:143], v[230:233], a[236:239], v[128:143]
    s_waitcnt lgkmcnt(1)
    v_rcp_f16_sdwa v218, v218 dst_sel:WORD_0 dst_unused:UNUSED_PAD src0_sel:WORD_1
    v_rcp_f16_sdwa v220, v220 dst_sel:WORD_0 dst_unused:UNUSED_PAD src0_sel:WORD_1
    v_fma_mix_f32 v219, v180, v219, 0 op_sel_hi:[0,1,0]
    v_fma_mix_f32 v221, v182, v221, 0 op_sel_hi:[0,1,0]
    v_fma_mix_f32 v218, v181, v218, 0 op_sel_hi:[0,1,0]
    v_fma_mix_f32 v220, v183, v220, 0 op_sel_hi:[0,1,0]
    v_cvt_pk_bf16_f32 v212, v219, v218
    v_mfma_f32_32x32x16_bf16 v[188:203], a[200:203], a[32:35], v[188:203]
    s_sub_u32 s56, 128, s56
    v_cvt_pk_bf16_f32 v213, v221, v220
    v_cvt_pk_f16_f32 v222, v184, v185
    v_cvt_pk_f16_f32 v224, v186, v187
    v_pk_fma_f16 v223, v222, v222, s36
    v_pk_fma_f16 v225, v224, v224, s36
    v_pk_mul_f16 v223, v223, v222
    v_pk_mul_f16 v225, v225, v224
    v_exp_f16 v222, v223
    v_mfma_f32_32x32x16_bf16 v[188:203], a[204:207], a[36:39], v[188:203]
    s_add_u32 s39, s39, s56
    v_exp_f16_e64 v224, v225
    v_exp_f16_sdwa v222, v223 dst_sel:WORD_1 dst_unused:UNUSED_PRESERVE src0_sel:WORD_1
    v_exp_f16_sdwa v224, v225 dst_sel:WORD_1 dst_unused:UNUSED_PRESERVE src0_sel:WORD_1
    v_pk_fma_f16 v222, v222, s101, s101
    v_pk_fma_f16 v224, v224, s101, s101
    v_rcp_f16 v223, v222
    v_mfma_f32_32x32x16_bf16 v[188:203], a[208:211], a[40:43], v[188:203]
    s_add_u32 s100, s100, s56
    v_rcp_f16_e64 v225, v224
    v_rcp_f16_sdwa v222, v222 dst_sel:WORD_0 dst_unused:UNUSED_PAD src0_sel:WORD_1
    v_rcp_f16_sdwa v224, v224 dst_sel:WORD_0 dst_unused:UNUSED_PAD src0_sel:WORD_1
    v_fma_mix_f32 v223, v184, v223, 0 op_sel_hi:[0,1,0]
    v_fma_mix_f32 v225, v186, v225, 0 op_sel_hi:[0,1,0]
    v_fma_mix_f32 v222, v185, v222, 0 op_sel_hi:[0,1,0]
    v_mfma_f32_32x32x16_bf16 v[188:203], a[212:215], a[44:47], v[188:203]
    s_add_u32 s40, s40, 24576
    v_fma_mix_f32 v224, v187, v224, 0 op_sel_hi:[0,1,0]
    v_cvt_pk_bf16_f32 v214, v223, v222
    v_cvt_pk_bf16_f32 v215, v225, v224
    ds_write_b128 v10, v[212:215] offset:9216
    s_nop 6
    v_cvt_pk_f16_f32 v218, v188, v189
    v_cvt_pk_f16_f32 v220, v190, v191
    v_pk_fma_f16 v219, v218, v218, s36
    v_pk_fma_f16 v221, v220, v220, s36
    v_pk_mul_f16 v219, v219, v218
    v_pk_mul_f16 v221, v221, v220
    v_exp_f16 v218, v219
    v_exp_f16 v220, v221
    v_exp_f16_sdwa v218, v219 dst_sel:WORD_1 dst_unused:UNUSED_PRESERVE src0_sel:WORD_1
    v_exp_f16_sdwa v220, v221 dst_sel:WORD_1 dst_unused:UNUSED_PRESERVE src0_sel:WORD_1
    v_pk_fma_f16 v218, v218, s101, s101
    v_pk_fma_f16 v220, v220, s101, s101
    v_rcp_f16 v219, v218
    v_rcp_f16_e64 v221, v220
    v_rcp_f16_sdwa v218, v218 dst_sel:WORD_0 dst_unused:UNUSED_PAD src0_sel:WORD_1
    v_rcp_f16_sdwa v220, v220 dst_sel:WORD_0 dst_unused:UNUSED_PAD src0_sel:WORD_1
    v_fma_mix_f32 v219, v188, v219, 0 op_sel_hi:[0,1,0]
    v_fma_mix_f32 v221, v190, v221, 0 op_sel_hi:[0,1,0]
    v_fma_mix_f32 v218, v189, v218, 0 op_sel_hi:[0,1,0]
    v_fma_mix_f32 v220, v191, v220, 0 op_sel_hi:[0,1,0]
    v_cvt_pk_bf16_f32 v208, v219, v218
    v_cvt_pk_bf16_f32 v209, v221, v220
    v_cvt_pk_f16_f32 v222, v192, v193
    v_cvt_pk_f16_f32 v224, v194, v195
    v_pk_fma_f16 v223, v222, v222, s36
    v_pk_fma_f16 v225, v224, v224, s36
    v_pk_mul_f16 v223, v223, v222
    v_pk_mul_f16 v225, v225, v224
    v_exp_f16 v222, v223
    v_exp_f16 v224, v225
    v_exp_f16_sdwa v222, v223 dst_sel:WORD_1 dst_unused:UNUSED_PRESERVE src0_sel:WORD_1
    v_exp_f16_sdwa v224, v225 dst_sel:WORD_1 dst_unused:UNUSED_PRESERVE src0_sel:WORD_1
    v_pk_fma_f16 v222, v222, s101, s101
    s_waitcnt vmcnt(0) lgkmcnt(0)
    s_barrier
    v_mfma_f32_32x32x16_bf16 v[172:187], a[168:171], a[48:51], 0
    v_mov_b32 v251, 1
    v_pk_fma_f16 v224, v224, s101, s101
    v_rcp_f16 v223, v222
    v_rcp_f16_e64 v225, v224
    v_mfma_f32_32x32x16_bf16 v[172:187], a[172:175], a[52:55], v[172:187]
    s_add_u32 m0, s41, 101888
    buffer_atomic_add v251, v250, s[20:23], 0 offen sc1
    buffer_load_dwordx4 v13, s[8:11], s39 offen offset:0  lds
    v_mfma_f32_32x32x16_bf16 v[172:187], a[176:179], a[56:59], v[172:187]
    ds_read_b64_tr_b16 a[232:233], v3 offset:0
    v_rcp_f16_sdwa v222, v222 dst_sel:WORD_0 dst_unused:UNUSED_PAD src0_sel:WORD_1
    v_rcp_f16_sdwa v224, v224 dst_sel:WORD_0 dst_unused:UNUSED_PAD src0_sel:WORD_1
    v_fma_mix_f32 v223, v192, v223, 0 op_sel_hi:[0,1,0]
    v_fma_mix_f32 v225, v194, v225, 0 op_sel_hi:[0,1,0]
    v_mfma_f32_32x32x16_bf16 v[172:187], a[180:183], a[60:63], v[172:187]
    ds_read_b64_tr_b16 a[234:235], v3 offset:3072
    ds_read_b128 a[216:219], v9 offset:0
    v_fma_mix_f32 v222, v193, v222, 0 op_sel_hi:[0,1,0]
    v_fma_mix_f32 v224, v195, v224, 0 op_sel_hi:[0,1,0]
    v_cvt_pk_bf16_f32 v210, v223, v222
    v_cvt_pk_bf16_f32 v211, v225, v224
    v_cvt_pk_f16_f32 v218, v196, v197
    v_mfma_f32_32x32x16_bf16 v[172:187], a[184:187], a[64:67], v[172:187]
    ds_write_b128 v10, v[208:211] offset:24576
    v_cvt_pk_f16_f32 v220, v198, v199
    v_pk_fma_f16 v219, v218, v218, s36
    v_mfma_f32_32x32x16_bf16 v[172:187], a[188:191], a[68:71], v[172:187]
    buffer_load_dwordx4 v14, s[8:11], s39 offen offset:1024  lds
    v_pk_fma_f16 v221, v220, v220, s36
    v_pk_mul_f16 v219, v219, v218
    v_pk_mul_f16 v221, v221, v220
    v_exp_f16 v218, v219
    v_mfma_f32_32x32x16_bf16 v[172:187], a[192:195], a[72:75], v[172:187]
    v_exp_f16 v220, v221
    v_exp_f16_sdwa v218, v219 dst_sel:WORD_1 dst_unused:UNUSED_PRESERVE src0_sel:WORD_1
    v_exp_f16_sdwa v220, v221 dst_sel:WORD_1 dst_unused:UNUSED_PRESERVE src0_sel:WORD_1
    v_pk_fma_f16 v218, v218, s101, s101
    v_mfma_f32_32x32x16_bf16 v[172:187], a[196:199], a[76:79], v[172:187]
    ds_read_b64_tr_b16 a[236:237], v4 offset:0
    ds_read_b64_tr_b16 a[238:239], v4 offset:3072
    v_pk_fma_f16 v220, v220, s101, s101
    v_rcp_f16 v219, v218
    v_rcp_f16 v221, v220
    v_mfma_f32_32x32x16_bf16 v[172:187], a[200:203], a[80:83], v[172:187]
L_pg4:
    s_cbranch_execz L_wu0
    ds_read_b64_tr_b16 a[240:241], v5 offset:0
    ds_read_b64_tr_b16 a[242:243], v5 offset:3072
    v_rcp_f16_sdwa v218, v218 dst_sel:WORD_0 dst_unused:UNUSED_PAD src0_sel:WORD_1
    v_rcp_f16_sdwa v220, v220 dst_sel:WORD_0 dst_unused:UNUSED_PAD src0_sel:WORD_1
    v_fma_mix_f32 v219, v196, v219, 0 op_sel_hi:[0,1,0]
    v_mfma_f32_32x32x16_bf16 v[172:187], a[204:207], a[84:87], v[172:187]
    s_nop 0
    ds_read_b128 a[220:223], v9 offset:4096
    v_fma_mix_f32 v221, v198, v221, 0 op_sel_hi:[0,1,0]
    v_fma_mix_f32 v218, v197, v218, 0 op_sel_hi:[0,1,0]
    v_fma_mix_f32 v220, v199, v220, 0 op_sel_hi:[0,1,0]
    v_cvt_pk_bf16_f32 v212, v219, v218
    v_cvt_pk_bf16_f32 v213, v221, v220
    v_cvt_pk_f16_f32 v222, v200, v201
    v_mfma_f32_32x32x16_bf16 v[172:187], a[208:211], a[88:91], v[172:187]
    buffer_load_dwordx4 v254, s[8:11], s39 offen offset:2048  lds
    v_cvt_pk_f16_f32 v224, v202, v203
    v_pk_fma_f16 v223, v222, v222, s36
    v_pk_fma_f16 v225, v224, v224, s36
    v_pk_mul_f16 v223, v223, v222
    v_pk_mul_f16 v225, v225, v224
    v_mfma_f32_32x32x16_bf16 v[172:187], a[212:215], a[92:95], v[172:187]
    s_waitcnt lgkmcnt(1)
    v_exp_f16 v222, v223
    v_exp_f16_e64 v224, v225
    v_exp_f16_sdwa v222, v223 dst_sel:WORD_1 dst_unused:UNUSED_PRESERVE src0_sel:WORD_1
    v_mfma_f32_32x32x16_bf16 v[16:31], a[232:235], a[216:219], v[16:31]
    ds_read_b128 a[224:227], v9 offset:8192
    v_exp_f16_sdwa v224, v225 dst_sel:WORD_1 dst_unused:UNUSED_PRESERVE src0_sel:WORD_1
    v_pk_fma_f16 v222, v222, s101, s101
    v_pk_fma_f16 v224, v224, s101, s101
    v_rcp_f16 v223, v222
    v_mfma_f32_32x32x16_bf16 v[32:47], a[236:239], a[216:219], v[32:47]
    v_rcp_f16_e64 v225, v224
    v_rcp_f16_sdwa v222, v222 dst_sel:WORD_0 dst_unused:UNUSED_PAD src0_sel:WORD_1
    v_rcp_f16_sdwa v224, v224 dst_sel:WORD_0 dst_unused:UNUSED_PAD src0_sel:WORD_1
    v_fma_mix_f32 v223, v200, v223, 0 op_sel_hi:[0,1,0]
    v_mfma_f32_32x32x16_bf16 v[48:63], a[240:243], a[216:219], v[48:63]
    s_waitcnt lgkmcnt(1)
    v_fma_mix_f32 v225, v202, v225, 0 op_sel_hi:[0,1,0]
    v_fma_mix_f32 v222, v201, v222, 0 op_sel_hi:[0,1,0]
    v_fma_mix_f32 v224, v203, v224, 0 op_sel_hi:[0,1,0]
    v_cvt_pk_bf16_f32 v214, v223, v222
    v_cvt_pk_bf16_f32 v215, v225, v224
    v_cvt_pk_f16_f32 v218, v172, v173
    v_cvt_pk_f16_f32 v220, v174, v175
    v_mfma_f32_32x32x16_bf16 v[96:111], a[240:243], a[220:223], v[96:111]
    ds_write_b128 v10, v[212:215] offset:25600
    v_pk_fma_f16 v219, v218, v218, s36
    v_pk_fma_f16 v221, v220, v220, s36
    v_mfma_f32_32x32x16_bf16 v[80:95], a[236:239], a[220:223], v[80:95]
    v_pk_mul_f16 v219, v219, v218
    v_pk_mul_f16 v221, v221, v220
    v_exp_f16 v218, v219
    v_exp_f16 v220, v221
    v_mfma_f32_32x32x16_bf16 v[64:79], a[232:235], a[220:223], v[64:79]
    s_waitcnt lgkmcnt(1)
    v_exp_f16_sdwa v218, v219 dst_sel:WORD_1 dst_unused:UNUSED_PRESERVE src0_sel:WORD_1
    v_exp_f16_sdwa v220, v221 dst_sel:WORD_1 dst_unused:UNUSED_PRESERVE src0_sel:WORD_1
    v_pk_fma_f16 v218, v218, s101, s101
    v_pk_fma_f16 v220, v220, s101, s101
    v_mfma_f32_32x32x16_bf16 v[112:127], a[232:235], a[224:227], v[112:127]
    buffer_load_dwordx4 v255, s[8:11], s39 offen offset:3072  lds
    v_rcp_f16 v219, v218
    v_rcp_f16_e64 v221, v220
    v_mfma_f32_32x32x16_bf16 v[128:143], a[236:239], a[224:227], v[128:143]
    s_add_u32 m0, s41, 105984
    v_rcp_f16_sdwa v218, v218 dst_sel:WORD_0 dst_unused:UNUSED_PAD src0_sel:WORD_1
    v_rcp_f16_sdwa v220, v220 dst_sel:WORD_0 dst_unused:UNUSED_PAD src0_sel:WORD_1
    v_fma_mix_f32 v219, v172, v219, 0 op_sel_hi:[0,1,0]
    v_fma_mix_f32 v221, v174, v221, 0 op_sel_hi:[0,1,0]
    v_fma_mix_f32 v218, v173, v218, 0 op_sel_hi:[0,1,0]
    v_mfma_f32_32x32x16_bf16 v[144:159], a[240:243], a[224:227], v[144:159]
    buffer_load_dwordx4 v13, s[8:11], s100 offen offset:0  lds
    v_fma_mix_f32 v220, v175, v220, 0 op_sel_hi:[0,1,0]
    v_cvt_pk_bf16_f32 v208, v219, v218
    v_cvt_pk_bf16_f32 v209, v221, v220
    v_cvt_pk_f16_f32 v222, v176, v177
    v_cvt_pk_f16_f32 v224, v178, v179
    v_mfma_f32_32x32x16_bf16 v[188:203], a[168:171], a[96:99], 0
    ds_read_b64_tr_b16 a[168:169], v1 offset:24576
    v_pk_fma_f16 v223, v222, v222, s36
    v_pk_fma_f16 v225, v224, v224, s36
    v_pk_mul_f16 v223, v223, v222
    v_pk_mul_f16 v225, v225, v224
    v_exp_f16 v222, v223
    v_mfma_f32_32x32x16_bf16 v[188:203], a[172:175], a[100:103], v[188:203]
    ds_read_b64_tr_b16 a[170:171], v1 offset:25088
    v_exp_f16 v224, v225
    v_exp_f16_sdwa v222, v223 dst_sel:WORD_1 dst_unused:UNUSED_PRESERVE src0_sel:WORD_1
    v_exp_f16_sdwa v224, v225 dst_sel:WORD_1 dst_unused:UNUSED_PRESERVE src0_sel:WORD_1
    v_mfma_f32_32x32x16_bf16 v[188:203], a[176:179], a[104:107], v[188:203]
    ds_read_b64_tr_b16 a[244:245], v3 offset:6144
    v_pk_fma_f16 v222, v222, s101, s101
    v_pk_fma_f16 v224, v224, s101, s101
    v_rcp_f16 v223, v222
    v_rcp_f16 v225, v224
    v_mfma_f32_32x32x16_bf16 v[188:203], a[180:183], a[108:111], v[188:203]
    ds_read_b64_tr_b16 a[246:247], v3 offset:9216
    ds_read_b128 a[228:231], v9 offset:1024
    v_rcp_f16_sdwa v222, v222 dst_sel:WORD_0 dst_unused:UNUSED_PAD src0_sel:WORD_1
    v_rcp_f16_sdwa v224, v224 dst_sel:WORD_0 dst_unused:UNUSED_PAD src0_sel:WORD_1
    v_fma_mix_f32 v223, v176, v223, 0 op_sel_hi:[0,1,0]
    v_mfma_f32_32x32x16_bf16 v[188:203], a[184:187], a[112:115], v[188:203]
    buffer_load_dwordx4 v14, s[8:11], s100 offen offset:1024  lds
    ds_read_b64_tr_b16 a[248:249], v4 offset:6144
    ds_read_b64_tr_b16 a[250:251], v4 offset:9216
    v_fma_mix_f32 v225, v178, v225, 0 op_sel_hi:[0,1,0]
    v_fma_mix_f32 v222, v177, v222, 0 op_sel_hi:[0,1,0]
    v_fma_mix_f32 v224, v179, v224, 0 op_sel_hi:[0,1,0]
    v_mfma_f32_32x32x16_bf16 v[188:203], a[188:191], a[116:119], v[188:203]
    ds_read_b64_tr_b16 a[252:253], v5 offset:6144
    ds_read_b64_tr_b16 a[254:255], v5 offset:9216
    v_cvt_pk_bf16_f32 v210, v223, v222
    v_cvt_pk_bf16_f32 v211, v225, v224
    v_cvt_pk_f16_f32 v218, v180, v181
    v_cvt_pk_f16_f32 v220, v182, v183
    v_pk_fma_f16 v219, v218, v218, s36
    v_mfma_f32_32x32x16_bf16 v[188:203], a[192:195], a[120:123], v[188:203]
    ds_write_b128 v10, v[208:211] offset:28672
    v_pk_fma_f16 v221, v220, v220, s36
    v_pk_mul_f16 v219, v219, v218
    v_mfma_f32_32x32x16_bf16 v[188:203], a[196:199], a[124:127], v[188:203]
    v_pk_mul_f16 v221, v221, v220
    v_exp_f16_e64 v218, v219
    v_exp_f16_e64 v220, v221
    v_exp_f16_sdwa v218, v219 dst_sel:WORD_1 dst_unused:UNUSED_PRESERVE src0_sel:WORD_1
    v_mfma_f32_32x32x16_bf16 v[188:203], a[200:203], a[128:131], v[188:203]
    v_exp_f16_sdwa v220, v221 dst_sel:WORD_1 dst_unused:UNUSED_PRESERVE src0_sel:WORD_1
    v_pk_fma_f16 v218, v218, s101, s101
    v_pk_fma_f16 v220, v220, s101, s101
    v_rcp_f16_e64 v219, v218
    v_mfma_f32_32x32x16_bf16 v[188:203], a[204:207], a[132:135], v[188:203]
    s_add_u32 m0, s41, 24576
    ds_read_b128 a[216:219], v9 offset:5120
    ds_read_b64_tr_b16 a[184:185], v1 offset:32768
    v_rcp_f16_e64 v221, v220
    v_rcp_f16_sdwa v218, v218 dst_sel:WORD_0 dst_unused:UNUSED_PAD src0_sel:WORD_1
    v_mfma_f32_32x32x16_bf16 v[188:203], a[208:211], a[136:139], v[188:203]
    s_nop 0
    buffer_load_dwordx4 v15, s[12:15], s40 offen offset:0  lds
    v_rcp_f16_sdwa v220, v220 dst_sel:WORD_0 dst_unused:UNUSED_PAD src0_sel:WORD_1
    v_fma_mix_f32 v219, v180, v219, 0 op_sel_hi:[0,1,0]
    v_fma_mix_f32 v221, v182, v221, 0 op_sel_hi:[0,1,0]
    v_fma_mix_f32 v218, v181, v218, 0 op_sel_hi:[0,1,0]
    v_mfma_f32_32x32x16_bf16 v[188:203], a[212:215], a[140:143], v[188:203]
    s_waitcnt lgkmcnt(3)
    ds_read_b64_tr_b16 a[172:173], v1 offset:26624
    ds_read_b64_tr_b16 a[186:187], v1 offset:33280
    ds_read_b64_tr_b16 a[212:213], v1 offset:47104
    ds_read_b64_tr_b16 a[214:215], v1 offset:47616
    v_fma_mix_f32 v220, v183, v220, 0 op_sel_hi:[0,1,0]
    v_cvt_pk_bf16_f32 v212, v219, v218
    v_cvt_pk_bf16_f32 v213, v221, v220
    v_mfma_f32_32x32x16_bf16 v[16:31], a[244:247], a[228:231], v[16:31]
    ds_read_b128 a[220:223], v9 offset:9216
    ds_read_b64_tr_b16 a[190:191], v1 offset:35328
    v_cvt_pk_f16_f32 v222, v184, v185
    v_cvt_pk_f16_f32 v224, v186, v187
    v_pk_fma_f16 v223, v222, v222, s36
    v_pk_fma_f16 v225, v224, v224, s36
    v_pk_mul_f16 v223, v223, v222
    v_mfma_f32_32x32x16_bf16 v[32:47], a[248:251], a[228:231], v[32:47]
    ds_read_b64_tr_b16 a[174:175], v1 offset:27136
    ds_read_b64_tr_b16 a[194:195], v1 offset:37376
    v_pk_mul_f16 v225, v225, v224
    v_exp_f16 v222, v223
    v_exp_f16_e64 v224, v225
    v_mfma_f32_32x32x16_bf16 v[48:63], a[252:255], a[228:231], v[48:63]
    s_waitcnt lgkmcnt(9)
    buffer_load_dwordx4 v15, s[12:15], s40 offen offset:3072  lds
    ds_read_b64_tr_b16 a[232:233], v3 offset:12288
    v_exp_f16_sdwa v222, v223 dst_sel:WORD_1 dst_unused:UNUSED_PRESERVE src0_sel:WORD_1
    v_exp_f16_sdwa v224, v225 dst_sel:WORD_1 dst_unused:UNUSED_PRESERVE src0_sel:WORD_1
    v_mfma_f32_32x32x16_bf16 v[96:111], a[252:255], a[216:219], v[96:111]
    ds_read_b64_tr_b16 a[234:235], v3 offset:15360
    ds_read_b128 a[224:227], v9 offset:2048
    v_pk_fma_f16 v222, v222, s101, s101
    v_pk_fma_f16 v224, v224, s101, s101
    v_rcp_f16_e64 v223, v222
    v_mfma_f32_32x32x16_bf16 v[80:95], a[248:251], a[216:219], v[80:95]
    ds_read_b64_tr_b16 a[236:237], v4 offset:12288
    ds_read_b64_tr_b16 a[238:239], v4 offset:15360
    v_rcp_f16 v225, v224
    v_rcp_f16_sdwa v222, v222 dst_sel:WORD_0 dst_unused:UNUSED_PAD src0_sel:WORD_1
    v_mfma_f32_32x32x16_bf16 v[64:79], a[244:247], a[216:219], v[64:79]
    s_waitcnt lgkmcnt(8)
    ds_read_b64_tr_b16 a[240:241], v5 offset:12288
    ds_read_b64_tr_b16 a[242:243], v5 offset:15360
    v_rcp_f16_sdwa v224, v224 dst_sel:WORD_0 dst_unused:UNUSED_PAD src0_sel:WORD_1
    v_fma_mix_f32 v223, v184, v223, 0 op_sel_hi:[0,1,0]
    v_fma_mix_f32 v225, v186, v225, 0 op_sel_hi:[0,1,0]
    v_fma_mix_f32 v222, v185, v222, 0 op_sel_hi:[0,1,0]
    v_mfma_f32_32x32x16_bf16 v[112:127], a[244:247], a[220:223], v[112:127]
    ds_read_b128 a[228:231], v9 offset:6144
    ds_read_b128 a[216:219], v9 offset:10240
    v_fma_mix_f32 v224, v187, v224, 0 op_sel_hi:[0,1,0]
    v_cvt_pk_bf16_f32 v214, v223, v222
    v_cvt_pk_bf16_f32 v215, v225, v224
    v_cvt_pk_f16_f32 v218, v188, v189
    v_cvt_pk_f16_f32 v220, v190, v191
    v_mfma_f32_32x32x16_bf16 v[128:143], a[248:251], a[220:223], v[128:143]
    ds_write_b128 v10, v[212:215] offset:29696
    v_pk_fma_f16 v219, v218, v218, s36
    v_pk_fma_f16 v221, v220, v220, s36
    v_mfma_f32_32x32x16_bf16 v[144:159], a[252:255], a[220:223], v[144:159]
    s_waitcnt lgkmcnt(3)
    v_pk_mul_f16 v219, v219, v218
    v_pk_mul_f16 v221, v221, v220
    v_exp_f16 v218, v219
    v_exp_f16_e64 v220, v221
    v_mfma_f32_32x32x16_bf16 v[16:31], a[232:235], a[224:227], v[16:31]
    s_add_u32 m0, s41, 25600
    v_exp_f16_sdwa v218, v219 dst_sel:WORD_1 dst_unused:UNUSED_PRESERVE src0_sel:WORD_1
    v_exp_f16_sdwa v220, v221 dst_sel:WORD_1 dst_unused:UNUSED_PRESERVE src0_sel:WORD_1
    v_pk_fma_f16 v218, v218, s101, s101
    v_pk_fma_f16 v220, v220, s101, s101
    v_mfma_f32_32x32x16_bf16 v[32:47], a[236:239], a[224:227], v[32:47]
    buffer_load_dwordx4 v240, s[12:15], s40 offen offset:0  lds
    v_rcp_f16 v219, v218
    v_rcp_f16_e64 v221, v220
    v_mfma_f32_32x32x16_bf16 v[48:63], a[240:243], a[224:227], v[48:63]
    s_waitcnt lgkmcnt(1)
    buffer_load_dwordx4 v240, s[12:15], s40 offen offset:3072  lds
    v_rcp_f16_sdwa v218, v218 dst_sel:WORD_0 dst_unused:UNUSED_PAD src0_sel:WORD_1
    v_rcp_f16_sdwa v220, v220 dst_sel:WORD_0 dst_unused:UNUSED_PAD src0_sel:WORD_1
    v_fma_mix_f32 v219, v188, v219, 0 op_sel_hi:[0,1,0]
    v_mfma_f32_32x32x16_bf16 v[96:111], a[240:243], a[228:231], v[96:111]
    ds_read_b64_tr_b16 a[176:177], v1 offset:28672
    ds_read_b64_tr_b16 a[198:199], v1 offset:39424
    v_fma_mix_f32 v221, v190, v221, 0 op_sel_hi:[0,1,0]
    v_fma_mix_f32 v218, v189, v218, 0 op_sel_hi:[0,1,0]
    v_fma_mix_f32 v220, v191, v220, 0 op_sel_hi:[0,1,0]
    v_cvt_pk_bf16_f32 v208, v219, v218
    v_cvt_pk_bf16_f32 v209, v221, v220
    v_mfma_f32_32x32x16_bf16 v[80:95], a[236:239], a[228:231], v[80:95]
    ds_read_b64_tr_b16 a[178:179], v1 offset:29184
    ds_read_b64_tr_b16 a[200:201], v1 offset:40960
    v_cvt_pk_f16_f32 v222, v192, v193
    v_cvt_pk_f16_f32 v224, v194, v195
    v_pk_fma_f16 v223, v222, v222, s36
    v_pk_fma_f16 v225, v224, v224, s36
    v_pk_mul_f16 v223, v223, v222
    v_mfma_f32_32x32x16_bf16 v[64:79], a[232:235], a[228:231], v[64:79]
    ds_read_b64_tr_b16 a[180:181], v1 offset:30720
    ds_read_b64_tr_b16 a[202:203], v1 offset:41472
    v_pk_mul_f16 v225, v225, v224
    v_exp_f16 v222, v223
    v_exp_f16 v224, v225
    v_mfma_f32_32x32x16_bf16 v[112:127], a[232:235], a[216:219], v[112:127]
    s_add_u32 m0, s41, 26624
    ds_read_b64_tr_b16 a[182:183], v1 offset:31232
    ds_read_b64_tr_b16 a[204:205], v1 offset:43008
    v_exp_f16_sdwa v222, v223 dst_sel:WORD_1 dst_unused:UNUSED_PRESERVE src0_sel:WORD_1
    v_exp_f16_sdwa v224, v225 dst_sel:WORD_1 dst_unused:UNUSED_PRESERVE src0_sel:WORD_1
    v_pk_fma_f16 v222, v222, s101, s101
    v_mfma_f32_32x32x16_bf16 v[128:143], a[236:239], a[216:219], v[128:143]
    buffer_load_dwordx4 v241, s[12:15], s40 offen offset:0  lds
    v_pk_fma_f16 v224, v224, s101, s101
    v_rcp_f16 v223, v222
    v_rcp_f16 v225, v224
    v_mfma_f32_32x32x16_bf16 v[144:159], a[240:243], a[216:219], v[144:159]
    ds_read_b64_tr_b16 a[188:189], v1 offset:34816
    ds_read_b64_tr_b16 a[206:207], v1 offset:43520
    v_rcp_f16_sdwa v222, v222 dst_sel:WORD_0 dst_unused:UNUSED_PAD src0_sel:WORD_1
    v_rcp_f16_sdwa v224, v224 dst_sel:WORD_0 dst_unused:UNUSED_PAD src0_sel:WORD_1
    v_mfma_f32_32x32x16_bf16 v[172:187], a[168:171], a[0:3], 0
    ds_read_b64_tr_b16 a[192:193], v1 offset:36864
    ds_read_b64_tr_b16 a[208:209], v1 offset:45056
    v_fma_mix_f32 v223, v192, v223, 0 op_sel_hi:[0,1,0]
    v_fma_mix_f32 v225, v194, v225, 0 op_sel_hi:[0,1,0]
    v_fma_mix_f32 v222, v193, v222, 0 op_sel_hi:[0,1,0]
    v_fma_mix_f32 v224, v195, v224, 0 op_sel_hi:[0,1,0]
    v_mfma_f32_32x32x16_bf16 v[172:187], a[172:175], a[4:7], v[172:187]
    s_waitcnt lgkmcnt(5)
    ds_read_b64_tr_b16 a[196:197], v1 offset:38912
    ds_read_b64_tr_b16 a[210:211], v1 offset:45568
    v_cvt_pk_bf16_f32 v210, v223, v222
    v_cvt_pk_bf16_f32 v211, v225, v224
    v_cvt_pk_f16_f32 v218, v196, v197
    v_cvt_pk_f16_f32 v220, v198, v199
    v_pk_fma_f16 v219, v218, v218, s36
    v_mfma_f32_32x32x16_bf16 v[172:187], a[176:179], a[8:11], v[172:187]
    ds_write_b128 v10, v[208:211] offset:32768
    v_pk_fma_f16 v221, v220, v220, s36
    v_mfma_f32_32x32x16_bf16 v[172:187], a[180:183], a[12:15], v[172:187]
    v_pk_mul_f16 v219, v219, v218
    v_pk_mul_f16 v221, v221, v220
    v_exp_f16 v218, v219
    v_exp_f16 v220, v221
    v_mfma_f32_32x32x16_bf16 v[172:187], a[184:187], a[16:19], v[172:187]
    s_waitcnt lgkmcnt(1)
    v_exp_f16_sdwa v218, v219 dst_sel:WORD_1 dst_unused:UNUSED_PRESERVE src0_sel:WORD_1
    v_exp_f16_sdwa v220, v221 dst_sel:WORD_1 dst_unused:UNUSED_PRESERVE src0_sel:WORD_1
    v_pk_fma_f16 v218, v218, s101, s101
    v_pk_fma_f16 v220, v220, s101, s101
    v_mfma_f32_32x32x16_bf16 v[172:187], a[188:191], a[20:23], v[172:187]
    buffer_load_dwordx4 v241, s[12:15], s40 offen offset:3072  lds
    ds_read_b64_tr_b16 a[244:245], v3 offset:18432
    v_rcp_f16 v219, v218
    v_rcp_f16 v221, v220
    v_mfma_f32_32x32x16_bf16 v[172:187], a[192:195], a[24:27], v[172:187]
    ds_read_b64_tr_b16 a[246:247], v3 offset:21504
    ds_read_b128 a[220:223], v9 offset:3072
    v_rcp_f16_sdwa v218, v218 dst_sel:WORD_0 dst_unused:UNUSED_PAD src0_sel:WORD_1
    v_rcp_f16_sdwa v220, v220 dst_sel:WORD_0 dst_unused:UNUSED_PAD src0_sel:WORD_1
    v_fma_mix_f32 v219, v196, v219, 0 op_sel_hi:[0,1,0]
    v_mfma_f32_32x32x16_bf16 v[172:187], a[196:199], a[28:31], v[172:187]
    ds_read_b64_tr_b16 a[248:249], v4 offset:18432
    ds_read_b64_tr_b16 a[250:251], v4 offset:21504
    v_fma_mix_f32 v221, v198, v221, 0 op_sel_hi:[0,1,0]
    v_fma_mix_f32 v218, v197, v218, 0 op_sel_hi:[0,1,0]
    v_fma_mix_f32 v220, v199, v220, 0 op_sel_hi:[0,1,0]
    v_cvt_pk_bf16_f32 v212, v219, v218
    v_cvt_pk_bf16_f32 v213, v221, v220
    v_mfma_f32_32x32x16_bf16 v[172:187], a[200:203], a[32:35], v[172:187]
    ds_read_b64_tr_b16 a[252:253], v5 offset:18432
    ds_read_b64_tr_b16 a[254:255], v5 offset:21504
    v_cvt_pk_f16_f32 v222, v200, v201
    v_cvt_pk_f16_f32 v224, v202, v203
    v_pk_fma_f16 v223, v222, v222, s36
    v_pk_fma_f16 v225, v224, v224, s36
    v_mfma_f32_32x32x16_bf16 v[172:187], a[204:207], a[36:39], v[172:187]
    ds_read_b128 a[224:227], v9 offset:7168
    v_pk_mul_f16 v223, v223, v222
    v_pk_mul_f16 v225, v225, v224
    v_exp_f16_e64 v222, v223
    v_exp_f16_e64 v224, v225
    v_mfma_f32_32x32x16_bf16 v[172:187], a[208:211], a[40:43], v[172:187]
    v_exp_f16_sdwa v222, v223 dst_sel:WORD_1 dst_unused:UNUSED_PRESERVE src0_sel:WORD_1
    v_exp_f16_sdwa v224, v225 dst_sel:WORD_1 dst_unused:UNUSED_PRESERVE src0_sel:WORD_1
    v_pk_fma_f16 v222, v222, s101, s101
    v_pk_fma_f16 v224, v224, s101, s101
    v_mfma_f32_32x32x16_bf16 v[172:187], a[212:215], a[44:47], v[172:187]
    s_waitcnt lgkmcnt(1)
    v_rcp_f16 v223, v222
    v_rcp_f16_e64 v225, v224
    v_rcp_f16_sdwa v222, v222 dst_sel:WORD_0 dst_unused:UNUSED_PAD src0_sel:WORD_1
    v_mfma_f32_32x32x16_bf16 v[16:31], a[244:247], a[220:223], v[16:31]
    ds_read_b128 a[228:231], v9 offset:11264
    v_rcp_f16_sdwa v224, v224 dst_sel:WORD_0 dst_unused:UNUSED_PAD src0_sel:WORD_1
    v_fma_mix_f32 v223, v200, v223, 0 op_sel_hi:[0,1,0]
    v_fma_mix_f32 v225, v202, v225, 0 op_sel_hi:[0,1,0]
    v_fma_mix_f32 v222, v201, v222, 0 op_sel_hi:[0,1,0]
    v_fma_mix_f32 v224, v203, v224, 0 op_sel_hi:[0,1,0]
    v_mfma_f32_32x32x16_bf16 v[32:47], a[248:251], a[220:223], v[32:47]
    v_cvt_pk_bf16_f32 v214, v223, v222
    v_cvt_pk_bf16_f32 v215, v225, v224
    v_cvt_pk_f16_f32 v218, v172, v173
    v_cvt_pk_f16_f32 v220, v174, v175
    v_pk_fma_f16 v219, v218, v218, s36
    v_pk_fma_f16 v221, v220, v220, s36
    v_pk_mul_f16 v219, v219, v218
    v_mfma_f32_32x32x16_bf16 v[48:63], a[252:255], a[220:223], v[48:63]
    s_waitcnt lgkmcnt(1)
    ds_write_b128 v10, v[212:215] offset:33792
    v_pk_mul_f16 v221, v221, v220
    v_mfma_f32_32x32x16_bf16 v[96:111], a[252:255], a[224:227], v[96:111]
    v_exp_f16 v218, v219
    v_exp_f16 v220, v221
    v_exp_f16_sdwa v218, v219 dst_sel:WORD_1 dst_unused:UNUSED_PRESERVE src0_sel:WORD_1
    v_mfma_f32_32x32x16_bf16 v[80:95], a[248:251], a[224:227], v[80:95]
    v_exp_f16_sdwa v220, v221 dst_sel:WORD_1 dst_unused:UNUSED_PRESERVE src0_sel:WORD_1
    v_pk_fma_f16 v218, v218, s101, s101
    v_pk_fma_f16 v220, v220, s101, s101
    v_rcp_f16_e64 v219, v218
    v_mfma_f32_32x32x16_bf16 v[64:79], a[244:247], a[224:227], v[64:79]
    s_waitcnt lgkmcnt(1)
    v_rcp_f16_e64 v221, v220
    v_rcp_f16_sdwa v218, v218 dst_sel:WORD_0 dst_unused:UNUSED_PAD src0_sel:WORD_1
    v_rcp_f16_sdwa v220, v220 dst_sel:WORD_0 dst_unused:UNUSED_PAD src0_sel:WORD_1
    v_fma_mix_f32 v219, v172, v219, 0 op_sel_hi:[0,1,0]
    v_mfma_f32_32x32x16_bf16 v[112:127], a[244:247], a[228:231], v[112:127]
    s_add_u32 s39, s39, 128
    v_fma_mix_f32 v221, v174, v221, 0 op_sel_hi:[0,1,0]
    v_fma_mix_f32 v218, v173, v218, 0 op_sel_hi:[0,1,0]
    v_fma_mix_f32 v220, v175, v220, 0 op_sel_hi:[0,1,0]
    v_cvt_pk_bf16_f32 v208, v219, v218
    v_cvt_pk_bf16_f32 v209, v221, v220
    v_cvt_pk_f16_f32 v222, v176, v177
    v_cvt_pk_f16_f32 v224, v178, v179
    v_mfma_f32_32x32x16_bf16 v[128:143], a[248:251], a[228:231], v[128:143]
    s_add_u32 s100, s100, 128
    v_pk_fma_f16 v223, v222, v222, s36
    v_pk_fma_f16 v225, v224, v224, s36
    v_pk_mul_f16 v223, v223, v222
    v_pk_mul_f16 v225, v225, v224
    v_exp_f16_e64 v222, v223
    v_mfma_f32_32x32x16_bf16 v[144:159], a[252:255], a[228:231], v[144:159]
    s_add_u32 s40, s40, 24576
    v_exp_f16_e64 v224, v225
    v_exp_f16_sdwa v222, v223 dst_sel:WORD_1 dst_unused:UNUSED_PRESERVE src0_sel:WORD_1
    v_exp_f16_sdwa v224, v225 dst_sel:WORD_1 dst_unused:UNUSED_PRESERVE src0_sel:WORD_1
    v_pk_fma_f16 v222, v222, s101, s101
    s_waitcnt vmcnt(0) lgkmcnt(0)
    s_barrier
    v_mfma_f32_32x32x16_bf16 v[188:203], a[168:171], a[48:51], 0
    s_add_u32 m0, s41, 126464
    v_pk_fma_f16 v224, v224, s101, s101
    v_rcp_f16_e64 v223, v222
    v_rcp_f16_e64 v225, v224
    v_rcp_f16_sdwa v222, v222 dst_sel:WORD_0 dst_unused:UNUSED_PAD src0_sel:WORD_1
    v_mfma_f32_32x32x16_bf16 v[188:203], a[172:175], a[52:55], v[188:203]
    buffer_load_dwordx4 v13, s[8:11], s39 offen offset:0  lds
    v_rcp_f16_sdwa v224, v224 dst_sel:WORD_0 dst_unused:UNUSED_PAD src0_sel:WORD_1
    v_fma_mix_f32 v223, v176, v223, 0 op_sel_hi:[0,1,0]
    v_fma_mix_f32 v225, v178, v225, 0 op_sel_hi:[0,1,0]
    v_fma_mix_f32 v222, v177, v222, 0 op_sel_hi:[0,1,0]
    v_mfma_f32_32x32x16_bf16 v[188:203], a[176:179], a[56:59], v[188:203]
    ds_read_b64_tr_b16 a[232:233], v3 offset:24576
    v_fma_mix_f32 v224, v179, v224, 0 op_sel_hi:[0,1,0]
    v_cvt_pk_bf16_f32 v210, v223, v222
    v_cvt_pk_bf16_f32 v211, v225, v224
    v_cvt_pk_f16_f32 v218, v180, v181
    v_cvt_pk_f16_f32 v220, v182, v183
    v_pk_fma_f16 v219, v218, v218, s36
    v_mfma_f32_32x32x16_bf16 v[188:203], a[180:183], a[60:63], v[188:203]
    ds_write_b128 v10, v[208:211] offset:0
    v_pk_fma_f16 v221, v220, v220, s36
    v_pk_mul_f16 v219, v219, v218
    v_mfma_f32_32x32x16_bf16 v[188:203], a[184:187], a[64:67], v[188:203]
    v_pk_mul_f16 v221, v221, v220
    v_exp_f16_e64 v218, v219
    v_exp_f16_e64 v220, v221
    v_exp_f16_sdwa v218, v219 dst_sel:WORD_1 dst_unused:UNUSED_PRESERVE src0_sel:WORD_1
    v_mfma_f32_32x32x16_bf16 v[188:203], a[188:191], a[68:71], v[188:203]
    buffer_load_dwordx4 v14, s[8:11], s39 offen offset:1024  lds
    v_exp_f16_sdwa v220, v221 dst_sel:WORD_1 dst_unused:UNUSED_PRESERVE src0_sel:WORD_1
    v_pk_fma_f16 v218, v218, s101, s101
    v_pk_fma_f16 v220, v220, s101, s101
    v_mfma_f32_32x32x16_bf16 v[188:203], a[192:195], a[72:75], v[188:203]
    ds_read_b64_tr_b16 a[234:235], v3 offset:27648
    ds_read_b128 a[216:219], v9 offset:24576
    v_rcp_f16_e64 v219, v218
    v_rcp_f16_e64 v221, v220
    v_mfma_f32_32x32x16_bf16 v[188:203], a[196:199], a[76:79], v[188:203]
    ds_read_b64_tr_b16 a[236:237], v4 offset:24576
    ds_read_b64_tr_b16 a[238:239], v4 offset:27648
    v_rcp_f16_sdwa v218, v218 dst_sel:WORD_0 dst_unused:UNUSED_PAD src0_sel:WORD_1
    v_rcp_f16_sdwa v220, v220 dst_sel:WORD_0 dst_unused:UNUSED_PAD src0_sel:WORD_1
    v_fma_mix_f32 v219, v180, v219, 0 op_sel_hi:[0,1,0]
    v_mfma_f32_32x32x16_bf16 v[188:203], a[200:203], a[80:83], v[188:203]
    ds_read_b64_tr_b16 a[240:241], v5 offset:24576
    ds_read_b64_tr_b16 a[242:243], v5 offset:27648
    v_fma_mix_f32 v221, v182, v221, 0 op_sel_hi:[0,1,0]
    v_fma_mix_f32 v218, v181, v218, 0 op_sel_hi:[0,1,0]
    v_fma_mix_f32 v220, v183, v220, 0 op_sel_hi:[0,1,0]
    v_cvt_pk_bf16_f32 v212, v219, v218
    v_cvt_pk_bf16_f32 v213, v221, v220
    v_mfma_f32_32x32x16_bf16 v[188:203], a[204:207], a[84:87], v[188:203]
    ds_read_b128 a[220:223], v9 offset:28672
    v_cvt_pk_f16_f32 v222, v184, v185
    v_cvt_pk_f16_f32 v224, v186, v187
    v_pk_fma_f16 v223, v222, v222, s36
    v_pk_fma_f16 v225, v224, v224, s36
    v_pk_mul_f16 v223, v223, v222
    v_pk_mul_f16 v225, v225, v224
    v_mfma_f32_32x32x16_bf16 v[188:203], a[208:211], a[88:91], v[188:203]
    s_nop 0
    buffer_load_dwordx4 v254, s[8:11], s39 offen offset:2048  lds
    v_exp_f16_e64 v222, v223
    v_exp_f16_e64 v224, v225
    v_mfma_f32_32x32x16_bf16 v[188:203], a[212:215], a[92:95], v[188:203]
    s_waitcnt lgkmcnt(1)
    v_exp_f16_sdwa v222, v223 dst_sel:WORD_1 dst_unused:UNUSED_PRESERVE src0_sel:WORD_1
    v_exp_f16_sdwa v224, v225 dst_sel:WORD_1 dst_unused:UNUSED_PRESERVE src0_sel:WORD_1
    v_pk_fma_f16 v222, v222, s101, s101
    v_pk_fma_f16 v224, v224, s101, s101
    v_mfma_f32_32x32x16_bf16 v[16:31], a[232:235], a[216:219], v[16:31]
    ds_read_b128 a[224:227], v9 offset:32768
    v_rcp_f16_e64 v223, v222
    v_rcp_f16_e64 v225, v224
    v_rcp_f16_sdwa v222, v222 dst_sel:WORD_0 dst_unused:UNUSED_PAD src0_sel:WORD_1
    v_mfma_f32_32x32x16_bf16 v[32:47], a[236:239], a[216:219], v[32:47]
    s_nop 0
    v_rcp_f16_sdwa v224, v224 dst_sel:WORD_0 dst_unused:UNUSED_PAD src0_sel:WORD_1
    v_fma_mix_f32 v223, v184, v223, 0 op_sel_hi:[0,1,0]
    v_fma_mix_f32 v225, v186, v225, 0 op_sel_hi:[0,1,0]
    v_fma_mix_f32 v222, v185, v222, 0 op_sel_hi:[0,1,0]
    v_fma_mix_f32 v224, v187, v224, 0 op_sel_hi:[0,1,0]
    v_cvt_pk_bf16_f32 v214, v223, v222
    v_mfma_f32_32x32x16_bf16 v[48:63], a[240:243], a[216:219], v[48:63]
    s_waitcnt lgkmcnt(1)
    v_cvt_pk_bf16_f32 v215, v225, v224
    v_cvt_pk_f16_f32 v218, v188, v189
    v_cvt_pk_f16_f32 v220, v190, v191
    v_pk_fma_f16 v219, v218, v218, s36
    v_pk_fma_f16 v221, v220, v220, s36
    v_pk_mul_f16 v219, v219, v218
    v_pk_mul_f16 v221, v221, v220
    v_mfma_f32_32x32x16_bf16 v[96:111], a[240:243], a[220:223], v[96:111]
    ds_write_b128 v10, v[212:215] offset:1024
    v_exp_f16 v218, v219
    v_mfma_f32_32x32x16_bf16 v[80:95], a[236:239], a[220:223], v[80:95]
    v_exp_f16_e64 v220, v221
    v_exp_f16_sdwa v218, v219 dst_sel:WORD_1 dst_unused:UNUSED_PRESERVE src0_sel:WORD_1
    v_exp_f16_sdwa v220, v221 dst_sel:WORD_1 dst_unused:UNUSED_PRESERVE src0_sel:WORD_1
    v_pk_fma_f16 v218, v218, s101, s101
    v_mfma_f32_32x32x16_bf16 v[64:79], a[232:235], a[220:223], v[64:79]
    s_waitcnt lgkmcnt(1)
    v_pk_fma_f16 v220, v220, s101, s101
    v_rcp_f16 v219, v218
    v_rcp_f16 v221, v220
    v_rcp_f16_sdwa v218, v218 dst_sel:WORD_0 dst_unused:UNUSED_PAD src0_sel:WORD_1
    v_mfma_f32_32x32x16_bf16 v[112:127], a[232:235], a[224:227], v[112:127]
    buffer_load_dwordx4 v255, s[8:11], s39 offen offset:3072  lds
    v_rcp_f16_sdwa v220, v220 dst_sel:WORD_0 dst_unused:UNUSED_PAD src0_sel:WORD_1
    v_fma_mix_f32 v219, v188, v219, 0 op_sel_hi:[0,1,0]
    v_fma_mix_f32 v221, v190, v221, 0 op_sel_hi:[0,1,0]
    v_fma_mix_f32 v218, v189, v218, 0 op_sel_hi:[0,1,0]
    v_mfma_f32_32x32x16_bf16 v[128:143], a[236:239], a[224:227], v[128:143]
    s_add_u32 m0, s41, 130560
    v_fma_mix_f32 v220, v191, v220, 0 op_sel_hi:[0,1,0]
    v_cvt_pk_bf16_f32 v208, v219, v218
    v_cvt_pk_bf16_f32 v209, v221, v220
    v_cvt_pk_f16_f32 v222, v192, v193
    v_cvt_pk_f16_f32 v224, v194, v195
    v_pk_fma_f16 v223, v222, v222, s36
    v_pk_fma_f16 v225, v224, v224, s36
    v_mfma_f32_32x32x16_bf16 v[144:159], a[240:243], a[224:227], v[144:159]
    buffer_load_dwordx4 v13, s[8:11], s100 offen offset:0  lds
    v_pk_mul_f16 v223, v223, v222
    v_pk_mul_f16 v225, v225, v224
    v_exp_f16_e64 v222, v223
    v_mfma_f32_32x32x16_bf16 v[172:187], a[168:171], a[96:99], 0
    ds_read_b64_tr_b16 a[168:169], v1 offset:0
    v_exp_f16 v224, v225
    v_exp_f16_sdwa v222, v223 dst_sel:WORD_1 dst_unused:UNUSED_PRESERVE src0_sel:WORD_1
    v_exp_f16_sdwa v224, v225 dst_sel:WORD_1 dst_unused:UNUSED_PRESERVE src0_sel:WORD_1
    v_mfma_f32_32x32x16_bf16 v[172:187], a[172:175], a[100:103], v[172:187]
    ds_read_b64_tr_b16 a[170:171], v1 offset:512
    v_pk_fma_f16 v222, v222, s101, s101
    v_pk_fma_f16 v224, v224, s101, s101
    v_rcp_f16 v223, v222
    v_rcp_f16_e64 v225, v224
    v_mfma_f32_32x32x16_bf16 v[172:187], a[176:179], a[104:107], v[172:187]
L_pg5:
    s_cbranch_execz L_wu1
    ds_read_b64_tr_b16 a[244:245], v3 offset:30720
    v_rcp_f16_sdwa v222, v222 dst_sel:WORD_0 dst_unused:UNUSED_PAD src0_sel:WORD_1
    v_rcp_f16_sdwa v224, v224 dst_sel:WORD_0 dst_unused:UNUSED_PAD src0_sel:WORD_1
    v_fma_mix_f32 v223, v192, v223, 0 op_sel_hi:[0,1,0]
    v_fma_mix_f32 v225, v194, v225, 0 op_sel_hi:[0,1,0]
    v_mfma_f32_32x32x16_bf16 v[172:187], a[180:183], a[108:111], v[172:187]
    s_nop 0
    ds_read_b64_tr_b16 a[246:247], v3 offset:33792
    ds_read_b128 a[228:231], v9 offset:25600
    v_fma_mix_f32 v222, v193, v222, 0 op_sel_hi:[0,1,0]
    v_fma_mix_f32 v224, v195, v224, 0 op_sel_hi:[0,1,0]
    v_cvt_pk_bf16_f32 v210, v223, v222
    v_cvt_pk_bf16_f32 v211, v225, v224
    v_cvt_pk_f16_f32 v218, v196, v197
    v_mfma_f32_32x32x16_bf16 v[172:187], a[184:187], a[112:115], v[172:187]
    ds_write_b128 v10, v[208:211] offset:4096
    buffer_load_dwordx4 v14, s[8:11], s100 offen offset:1024  lds
    v_mfma_f32_32x32x16_bf16 v[172:187], a[188:191], a[116:119], v[172:187]
    v_cvt_pk_f16_f32 v220, v198, v199
    v_pk_fma_f16 v219, v218, v218, s36
    v_pk_fma_f16 v221, v220, v220, s36
    v_pk_mul_f16 v219, v219, v218
    v_pk_mul_f16 v221, v221, v220
    v_exp_f16_e64 v218, v219
    v_mfma_f32_32x32x16_bf16 v[172:187], a[192:195], a[120:123], v[172:187]
    v_exp_f16_e64 v220, v221
    v_exp_f16_sdwa v218, v219 dst_sel:WORD_1 dst_unused:UNUSED_PRESERVE src0_sel:WORD_1
    v_exp_f16_sdwa v220, v221 dst_sel:WORD_1 dst_unused:UNUSED_PRESERVE src0_sel:WORD_1
    v_mfma_f32_32x32x16_bf16 v[172:187], a[196:199], a[124:127], v[172:187]
    ds_read_b64_tr_b16 a[248:249], v4 offset:30720
    ds_read_b64_tr_b16 a[250:251], v4 offset:33792
    v_pk_fma_f16 v218, v218, s101, s101
    v_pk_fma_f16 v220, v220, s101, s101
    v_rcp_f16_e64 v219, v218
    v_mfma_f32_32x32x16_bf16 v[172:187], a[200:203], a[128:131], v[172:187]
    ds_read_b64_tr_b16 a[252:253], v5 offset:30720
    ds_read_b64_tr_b16 a[254:255], v5 offset:33792
    v_rcp_f16_e64 v221, v220
    v_rcp_f16_sdwa v218, v218 dst_sel:WORD_0 dst_unused:UNUSED_PAD src0_sel:WORD_1
    v_mfma_f32_32x32x16_bf16 v[172:187], a[204:207], a[132:135], v[172:187]
    s_add_u32 m0, s41, 0
    ds_read_b128 a[216:219], v9 offset:29696
    ds_read_b64_tr_b16 a[186:187], v1 offset:8704
    v_rcp_f16_sdwa v220, v220 dst_sel:WORD_0 dst_unused:UNUSED_PAD src0_sel:WORD_1
    v_fma_mix_f32 v219, v196, v219, 0 op_sel_hi:[0,1,0]
    v_fma_mix_f32 v221, v198, v221, 0 op_sel_hi:[0,1,0]
    v_fma_mix_f32 v218, v197, v218, 0 op_sel_hi:[0,1,0]
    v_mfma_f32_32x32x16_bf16 v[172:187], a[208:211], a[136:139], v[172:187]
    buffer_load_dwordx4 v15, s[12:15], s40 offen offset:0  lds
    v_fma_mix_f32 v220, v199, v220, 0 op_sel_hi:[0,1,0]
    v_cvt_pk_bf16_f32 v212, v219, v218
    v_cvt_pk_bf16_f32 v213, v221, v220
    v_cvt_pk_f16_f32 v222, v200, v201
    v_mfma_f32_32x32x16_bf16 v[172:187], a[212:215], a[140:143], v[172:187]
    s_waitcnt lgkmcnt(2)
    ds_read_b64_tr_b16 a[172:173], v1 offset:2048
    ds_read_b64_tr_b16 a[190:191], v1 offset:10752
    v_cvt_pk_f16_f32 v224, v202, v203
    v_pk_fma_f16 v223, v222, v222, s36
    v_pk_fma_f16 v225, v224, v224, s36
    v_pk_mul_f16 v223, v223, v222
    v_pk_mul_f16 v225, v225, v224
    v_mfma_f32_32x32x16_bf16 v[16:31], a[244:247], a[228:231], v[16:31]
    ds_read_b128 a[220:223], v9 offset:33792
    ds_read_b64_tr_b16 a[194:195], v1 offset:12800
    v_exp_f16_e64 v222, v223
    v_exp_f16_e64 v224, v225
    v_mfma_f32_32x32x16_bf16 v[32:47], a[248:251], a[228:231], v[32:47]
    ds_read_b64_tr_b16 a[174:175], v1 offset:2560
    ds_read_b64_tr_b16 a[198:199], v1 offset:14848
    v_exp_f16_sdwa v222, v223 dst_sel:WORD_1 dst_unused:UNUSED_PRESERVE src0_sel:WORD_1
    v_exp_f16_sdwa v224, v225 dst_sel:WORD_1 dst_unused:UNUSED_PRESERVE src0_sel:WORD_1
    v_pk_fma_f16 v222, v222, s101, s101
    v_mfma_f32_32x32x16_bf16 v[48:63], a[252:255], a[228:231], v[48:63]
    s_waitcnt lgkmcnt(7)
    buffer_load_dwordx4 v15, s[12:15], s40 offen offset:3072  lds
    ds_read_b64_tr_b16 a[232:233], v3 offset:36864
    ds_read_b64_tr_b16 a[234:235], v3 offset:39936
    v_pk_fma_f16 v224, v224, s101, s101
    v_rcp_f16 v223, v222
    v_mfma_f32_32x32x16_bf16 v[96:111], a[252:255], a[216:219], v[96:111]
    ds_read_b128 a[224:227], v9 offset:26624
    ds_read_b64_tr_b16 a[236:237], v4 offset:36864
    v_rcp_f16 v225, v224
    v_rcp_f16_sdwa v222, v222 dst_sel:WORD_0 dst_unused:UNUSED_PAD src0_sel:WORD_1
    v_mfma_f32_32x32x16_bf16 v[80:95], a[248:251], a[216:219], v[80:95]
    ds_read_b64_tr_b16 a[238:239], v4 offset:39936
    ds_read_b64_tr_b16 a[240:241], v5 offset:36864
    v_rcp_f16_sdwa v224, v224 dst_sel:WORD_0 dst_unused:UNUSED_PAD src0_sel:WORD_1
    v_fma_mix_f32 v223, v200, v223, 0 op_sel_hi:[0,1,0]
    v_fma_mix_f32 v225, v202, v225, 0 op_sel_hi:[0,1,0]
    v_mfma_f32_32x32x16_bf16 v[64:79], a[244:247], a[216:219], v[64:79]
    s_waitcnt lgkmcnt(9)
    ds_read_b64_tr_b16 a[242:243], v5 offset:39936
    ds_read_b128 a[228:231], v9 offset:30720
    v_fma_mix_f32 v222, v201, v222, 0 op_sel_hi:[0,1,0]
    v_fma_mix_f32 v224, v203, v224, 0 op_sel_hi:[0,1,0]
    v_cvt_pk_bf16_f32 v214, v223, v222
    v_cvt_pk_bf16_f32 v215, v225, v224
    v_cvt_pk_f16_f32 v218, v172, v173
    v_mfma_f32_32x32x16_bf16 v[112:127], a[244:247], a[220:223], v[112:127]
    ds_write_b128 v10, v[212:215] offset:5120
    v_cvt_pk_f16_f32 v220, v174, v175
    v_mfma_f32_32x32x16_bf16 v[128:143], a[248:251], a[220:223], v[128:143]
    s_add_u32 m0, s41, 1024
    v_pk_fma_f16 v219, v218, v218, s36
    v_pk_fma_f16 v221, v220, v220, s36
    v_pk_mul_f16 v219, v219, v218
    v_pk_mul_f16 v221, v221, v220
    v_exp_f16 v218, v219
    v_mfma_f32_32x32x16_bf16 v[144:159], a[252:255], a[220:223], v[144:159]
    s_waitcnt lgkmcnt(1)
    v_exp_f16_e64 v220, v221
    v_exp_f16_sdwa v218, v219 dst_sel:WORD_1 dst_unused:UNUSED_PRESERVE src0_sel:WORD_1
    v_exp_f16_sdwa v220, v221 dst_sel:WORD_1 dst_unused:UNUSED_PRESERVE src0_sel:WORD_1
    v_pk_fma_f16 v218, v218, s101, s101
    v_mfma_f32_32x32x16_bf16 v[16:31], a[232:235], a[224:227], v[16:31]
    buffer_load_dwordx4 v240, s[12:15], s40 offen offset:0  lds
    ds_read_b128 a[216:219], v9 offset:34816
    v_pk_fma_f16 v220, v220, s101, s101
    v_rcp_f16_e64 v219, v218
    v_mfma_f32_32x32x16_bf16 v[32:47], a[236:239], a[224:227], v[32:47]
    ds_read_b64_tr_b16 a[176:177], v1 offset:4096
    ds_read_b64_tr_b16 a[200:201], v1 offset:16384
    v_rcp_f16_e64 v221, v220
    v_rcp_f16_sdwa v218, v218 dst_sel:WORD_0 dst_unused:UNUSED_PAD src0_sel:WORD_1
    v_mfma_f32_32x32x16_bf16 v[48:63], a[240:243], a[224:227], v[48:63]
    buffer_load_dwordx4 v240, s[12:15], s40 offen offset:3072  lds
    v_rcp_f16_sdwa v220, v220 dst_sel:WORD_0 dst_unused:UNUSED_PAD src0_sel:WORD_1
    v_fma_mix_f32 v219, v172, v219, 0 op_sel_hi:[0,1,0]
    v_fma_mix_f32 v221, v174, v221, 0 op_sel_hi:[0,1,0]
    v_fma_mix_f32 v218, v173, v218, 0 op_sel_hi:[0,1,0]
    v_mfma_f32_32x32x16_bf16 v[96:111], a[240:243], a[228:231], v[96:111]
    ds_read_b64_tr_b16 a[178:179], v1 offset:4608
    ds_read_b64_tr_b16 a[202:203], v1 offset:16896
    v_fma_mix_f32 v220, v175, v220, 0 op_sel_hi:[0,1,0]
    v_cvt_pk_bf16_f32 v208, v219, v218
    v_cvt_pk_bf16_f32 v209, v221, v220
    v_cvt_pk_f16_f32 v222, v176, v177
    v_cvt_pk_f16_f32 v224, v178, v179
    v_mfma_f32_32x32x16_bf16 v[80:95], a[236:239], a[228:231], v[80:95]
    ds_read_b64_tr_b16 a[180:181], v1 offset:6144
    ds_read_b64_tr_b16 a[204:205], v1 offset:18432
    v_pk_fma_f16 v223, v222, v222, s36
    v_pk_fma_f16 v225, v224, v224, s36
    v_pk_mul_f16 v223, v223, v222
    v_pk_mul_f16 v225, v225, v224
    v_mfma_f32_32x32x16_bf16 v[64:79], a[232:235], a[228:231], v[64:79]
    s_waitcnt lgkmcnt(6)
    ds_read_b64_tr_b16 a[182:183], v1 offset:6656
    ds_read_b64_tr_b16 a[206:207], v1 offset:18944
    v_exp_f16 v222, v223
    v_exp_f16_e64 v224, v225
    v_mfma_f32_32x32x16_bf16 v[112:127], a[232:235], a[216:219], v[112:127]
    s_add_u32 m0, s41, 2048
    buffer_load_dword v251, v250, s[20:23], 0 offen sc1
    ds_read_b64_tr_b16 a[184:185], v1 offset:8192
    ds_read_b64_tr_b16 a[208:209], v1 offset:20480
    v_exp_f16_sdwa v222, v223 dst_sel:WORD_1 dst_unused:UNUSED_PRESERVE src0_sel:WORD_1
    v_exp_f16_sdwa v224, v225 dst_sel:WORD_1 dst_unused:UNUSED_PRESERVE src0_sel:WORD_1
    v_mfma_f32_32x32x16_bf16 v[128:143], a[236:239], a[216:219], v[128:143]
    buffer_load_dwordx4 v241, s[12:15], s40 offen offset:0  lds
    v_pk_fma_f16 v222, v222, s101, s101
    v_pk_fma_f16 v224, v224, s101, s101
    v_rcp_f16_e64 v223, v222
    v_mfma_f32_32x32x16_bf16 v[144:159], a[240:243], a[216:219], v[144:159]
    ds_read_b64_tr_b16 a[188:189], v1 offset:10240
    ds_read_b64_tr_b16 a[210:211], v1 offset:20992
    v_rcp_f16_e64 v225, v224
    v_rcp_f16_sdwa v222, v222 dst_sel:WORD_0 dst_unused:UNUSED_PAD src0_sel:WORD_1
    v_mfma_f32_32x32x16_bf16 v[188:203], a[168:171], a[0:3], 0
    s_nop 0
    ds_read_b64_tr_b16 a[192:193], v1 offset:12288
    ds_read_b64_tr_b16 a[212:213], v1 offset:22528
    v_rcp_f16_sdwa v224, v224 dst_sel:WORD_0 dst_unused:UNUSED_PAD src0_sel:WORD_1
    v_fma_mix_f32 v223, v176, v223, 0 op_sel_hi:[0,1,0]
    v_fma_mix_f32 v225, v178, v225, 0 op_sel_hi:[0,1,0]
    v_fma_mix_f32 v222, v177, v222, 0 op_sel_hi:[0,1,0]
    v_mfma_f32_32x32x16_bf16 v[188:203], a[172:175], a[4:7], v[188:203]
    s_waitcnt lgkmcnt(5)
    ds_read_b64_tr_b16 a[196:197], v1 offset:14336
    ds_read_b64_tr_b16 a[214:215], v1 offset:23040
    v_fma_mix_f32 v224, v179, v224, 0 op_sel_hi:[0,1,0]
    v_cvt_pk_bf16_f32 v210, v223, v222
    v_cvt_pk_bf16_f32 v211, v225, v224
    v_cvt_pk_f16_f32 v218, v180, v181
    v_cvt_pk_f16_f32 v220, v182, v183
    v_mfma_f32_32x32x16_bf16 v[188:203], a[176:179], a[8:11], v[188:203]
    ds_write_b128 v10, v[208:211] offset:8192
    v_pk_fma_f16 v219, v218, v218, s36
    v_pk_fma_f16 v221, v220, v220, s36
    v_mfma_f32_32x32x16_bf16 v[188:203], a[180:183], a[12:15], v[188:203]
    v_pk_mul_f16 v219, v219, v218
    v_pk_mul_f16 v221, v221, v220
    v_exp_f16 v218, v219
    v_exp_f16 v220, v221
    v_mfma_f32_32x32x16_bf16 v[188:203], a[184:187], a[16:19], v[188:203]
    s_waitcnt lgkmcnt(2)
    v_exp_f16_sdwa v218, v219 dst_sel:WORD_1 dst_unused:UNUSED_PRESERVE src0_sel:WORD_1
    v_exp_f16_sdwa v220, v221 dst_sel:WORD_1 dst_unused:UNUSED_PRESERVE src0_sel:WORD_1
    v_pk_fma_f16 v218, v218, s101, s101
    v_pk_fma_f16 v220, v220, s101, s101
    v_mfma_f32_32x32x16_bf16 v[188:203], a[188:191], a[20:23], v[188:203]
    buffer_load_dwordx4 v241, s[12:15], s40 offen offset:3072  lds
    ds_read_b64_tr_b16 a[244:245], v3 offset:43008
    v_rcp_f16 v219, v218
    v_rcp_f16_e64 v221, v220
    v_mfma_f32_32x32x16_bf16 v[188:203], a[192:195], a[24:27], v[188:203]
    ds_read_b64_tr_b16 a[246:247], v3 offset:46080
    ds_read_b128 a[220:223], v9 offset:27648
    v_rcp_f16_sdwa v218, v218 dst_sel:WORD_0 dst_unused:UNUSED_PAD src0_sel:WORD_1
    v_rcp_f16_sdwa v220, v220 dst_sel:WORD_0 dst_unused:UNUSED_PAD src0_sel:WORD_1
    v_fma_mix_f32 v219, v180, v219, 0 op_sel_hi:[0,1,0]
    v_mfma_f32_32x32x16_bf16 v[188:203], a[196:199], a[28:31], v[188:203]
    ds_read_b64_tr_b16 a[248:249], v4 offset:43008
    ds_read_b64_tr_b16 a[250:251], v4 offset:46080
    v_fma_mix_f32 v221, v182, v221, 0 op_sel_hi:[0,1,0]
    v_fma_mix_f32 v218, v181, v218, 0 op_sel_hi:[0,1,0]
    v_fma_mix_f32 v220, v183, v220, 0 op_sel_hi:[0,1,0]
    v_cvt_pk_bf16_f32 v212, v219, v218
    v_cvt_pk_bf16_f32 v213, v221, v220
    v_mfma_f32_32x32x16_bf16 v[188:203], a[200:203], a[32:35], v[188:203]
    ds_read_b64_tr_b16 a[252:253], v5 offset:43008
    ds_read_b64_tr_b16 a[254:255], v5 offset:46080
    v_cvt_pk_f16_f32 v222, v184, v185
    v_cvt_pk_f16_f32 v224, v186, v187
    v_pk_fma_f16 v223, v222, v222, s36
    v_pk_fma_f16 v225, v224, v224, s36
    v_mfma_f32_32x32x16_bf16 v[188:203], a[204:207], a[36:39], v[188:203]
    ds_read_b128 a[224:227], v9 offset:31744
    v_pk_mul_f16 v223, v223, v222
    v_pk_mul_f16 v225, v225, v224
    v_exp_f16 v222, v223
    v_exp_f16_e64 v224, v225
    v_mfma_f32_32x32x16_bf16 v[188:203], a[208:211], a[40:43], v[188:203]
    s_waitcnt lgkmcnt(3)
    v_exp_f16_sdwa v222, v223 dst_sel:WORD_1 dst_unused:UNUSED_PRESERVE src0_sel:WORD_1
    v_exp_f16_sdwa v224, v225 dst_sel:WORD_1 dst_unused:UNUSED_PRESERVE src0_sel:WORD_1
    v_pk_fma_f16 v222, v222, s101, s101
    v_pk_fma_f16 v224, v224, s101, s101
    v_mfma_f32_32x32x16_bf16 v[188:203], a[212:215], a[44:47], v[188:203]
    v_rcp_f16 v223, v222
    v_rcp_f16_e64 v225, v224
    v_rcp_f16_sdwa v222, v222 dst_sel:WORD_0 dst_unused:UNUSED_PAD src0_sel:WORD_1
    v_mfma_f32_32x32x16_bf16 v[16:31], a[244:247], a[220:223], v[16:31]
    ds_read_b128 a[228:231], v9 offset:35840
    v_rcp_f16_sdwa v224, v224 dst_sel:WORD_0 dst_unused:UNUSED_PAD src0_sel:WORD_1
    v_fma_mix_f32 v223, v184, v223, 0 op_sel_hi:[0,1,0]
    v_fma_mix_f32 v225, v186, v225, 0 op_sel_hi:[0,1,0]
    v_fma_mix_f32 v222, v185, v222, 0 op_sel_hi:[0,1,0]
    v_fma_mix_f32 v224, v187, v224, 0 op_sel_hi:[0,1,0]
    v_mfma_f32_32x32x16_bf16 v[32:47], a[248:251], a[220:223], v[32:47]
    s_waitcnt lgkmcnt(1)
    v_cvt_pk_bf16_f32 v214, v223, v222
    v_cvt_pk_bf16_f32 v215, v225, v224
    v_cvt_pk_f16_f32 v218, v188, v189
    v_cvt_pk_f16_f32 v220, v190, v191
    v_pk_fma_f16 v219, v218, v218, s36
    v_pk_fma_f16 v221, v220, v220, s36
    v_pk_mul_f16 v219, v219, v218
    v_mfma_f32_32x32x16_bf16 v[48:63], a[252:255], a[220:223], v[48:63]
    ds_write_b128 v10, v[212:215] offset:9216
    v_pk_mul_f16 v221, v221, v220
    v_mfma_f32_32x32x16_bf16 v[96:111], a[252:255], a[224:227], v[96:111]
    s_add_u32 s39, s39, 128
    v_exp_f16 v218, v219
    v_exp_f16 v220, v221
    v_exp_f16_sdwa v218, v219 dst_sel:WORD_1 dst_unused:UNUSED_PRESERVE src0_sel:WORD_1
    v_mfma_f32_32x32x16_bf16 v[80:95], a[248:251], a[224:227], v[80:95]
    s_add_u32 s100, s100, 128
    v_exp_f16_sdwa v220, v221 dst_sel:WORD_1 dst_unused:UNUSED_PRESERVE src0_sel:WORD_1
    v_pk_fma_f16 v218, v218, s101, s101
    v_pk_fma_f16 v220, v220, s101, s101
    v_rcp_f16_e64 v219, v218
    v_mfma_f32_32x32x16_bf16 v[64:79], a[244:247], a[224:227], v[64:79]
    s_waitcnt lgkmcnt(1)
    v_rcp_f16_e64 v221, v220
    v_rcp_f16_sdwa v218, v218 dst_sel:WORD_0 dst_unused:UNUSED_PAD src0_sel:WORD_1
    v_rcp_f16_sdwa v220, v220 dst_sel:WORD_0 dst_unused:UNUSED_PAD src0_sel:WORD_1
    v_fma_mix_f32 v219, v188, v219, 0 op_sel_hi:[0,1,0]
    v_mfma_f32_32x32x16_bf16 v[112:127], a[244:247], a[228:231], v[112:127]
    s_cmp_eq_u32 s38, 3
    s_cselect_b32 s57, 294912, 0
    v_fma_mix_f32 v221, v190, v221, 0 op_sel_hi:[0,1,0]
    v_fma_mix_f32 v218, v189, v218, 0 op_sel_hi:[0,1,0]
    v_fma_mix_f32 v220, v191, v220, 0 op_sel_hi:[0,1,0]
    v_cvt_pk_bf16_f32 v208, v219, v218
    v_cvt_pk_bf16_f32 v209, v221, v220
    v_cvt_pk_f16_f32 v222, v192, v193
    v_cvt_pk_f16_f32 v224, v194, v195
    v_mfma_f32_32x32x16_bf16 v[128:143], a[248:251], a[228:231], v[128:143]
    s_sub_u32 s57, 24576, s57
    v_pk_fma_f16 v223, v222, v222, s36
    v_pk_fma_f16 v225, v224, v224, s36
    v_pk_mul_f16 v223, v223, v222
    v_pk_mul_f16 v225, v225, v224
    v_exp_f16 v222, v223
    v_mfma_f32_32x32x16_bf16 v[144:159], a[252:255], a[228:231], v[144:159]
    s_add_u32 s40, s40, s57
    v_exp_f16 v224, v225
    v_exp_f16_sdwa v222, v223 dst_sel:WORD_1 dst_unused:UNUSED_PRESERVE src0_sel:WORD_1
    v_exp_f16_sdwa v224, v225 dst_sel:WORD_1 dst_unused:UNUSED_PRESERVE src0_sel:WORD_1
    v_pk_fma_f16 v222, v222, s101, s101
    s_waitcnt vmcnt(0) lgkmcnt(0)
    v_readfirstlane_b32 s33, v251
    s_cmp_eq_u32 s28, 0
    s_cselect_b32 s97, 4, 0
    s_cmp_ge_u32 s33, s97
    s_cbranch_scc0 L_spin1
L_back1:
    s_barrier
    v_mfma_f32_32x32x16_bf16 v[172:187], a[168:171], a[48:51], 0
    s_add_u32 m0, s41, 101888
    v_and_b32_e64 v252, 15, v0
    v_mul_u32_u24 v252, 384, v252
    v_bfe_u32 v251, v0, 4, 2
    s_mul_i32 s42, s3, 6144
    v_lshl_add_u32 v253, v251, 4, v252
    v_add_u32_e64 v252, v252, v253
    v_pk_fma_f16 v224, v224, s101, s101
    v_mfma_f32_32x32x16_bf16 v[172:187], a[172:175], a[52:55], v[172:187]
    buffer_load_dwordx4 v13, s[8:11], s39 offen offset:0  lds
    v_rcp_f16_e64 v223, v222
    v_rcp_f16_e64 v225, v224
    v_mfma_f32_32x32x16_bf16 v[172:187], a[176:179], a[56:59], v[172:187]
    ds_read_b64_tr_b16 a[232:233], v3 offset:0
    v_rcp_f16_sdwa v222, v222 dst_sel:WORD_0 dst_unused:UNUSED_PAD src0_sel:WORD_1
    v_rcp_f16_sdwa v224, v224 dst_sel:WORD_0 dst_unused:UNUSED_PAD src0_sel:WORD_1
    v_fma_mix_f32 v223, v192, v223, 0 op_sel_hi:[0,1,0]
    v_fma_mix_f32 v225, v194, v225, 0 op_sel_hi:[0,1,0]
    v_mfma_f32_32x32x16_bf16 v[172:187], a[180:183], a[60:63], v[172:187]
    ds_read_b64_tr_b16 a[234:235], v3 offset:3072
    ds_read_b128 a[216:219], v9 offset:0
    v_fma_mix_f32 v222, v193, v222, 0 op_sel_hi:[0,1,0]
    v_fma_mix_f32 v224, v195, v224, 0 op_sel_hi:[0,1,0]
    v_cvt_pk_bf16_f32 v210, v223, v222
    v_cvt_pk_bf16_f32 v211, v225, v224
    v_cvt_pk_f16_f32 v218, v196, v197
    v_mfma_f32_32x32x16_bf16 v[172:187], a[184:187], a[64:67], v[172:187]
    buffer_load_dwordx4 a[144:147], v253, s[24:27], s42 offen offset:0 sc1
    ds_read_b64_tr_b16 a[236:237], v4 offset:0
    ds_read_b64_tr_b16 a[238:239], v4 offset:3072
    v_cvt_pk_f16_f32 v220, v198, v199
    v_pk_fma_f16 v219, v218, v218, s36
    v_pk_fma_f16 v221, v220, v220, s36
    v_pk_mul_f16 v219, v219, v218
    v_mfma_f32_32x32x16_bf16 v[172:187], a[188:191], a[68:71], v[172:187]
    ds_write_b128 v10, v[208:211] offset:24576
    buffer_load_dwordx4 v14, s[8:11], s39 offen offset:1024  lds
    v_mfma_f32_32x32x16_bf16 v[172:187], a[192:195], a[72:75], v[172:187]
    v_pk_mul_f16 v221, v221, v220
    v_exp_f16_e64 v218, v219
    v_exp_f16_e64 v220, v221
    v_exp_f16_sdwa v218, v219 dst_sel:WORD_1 dst_unused:UNUSED_PRESERVE src0_sel:WORD_1
    v_mfma_f32_32x32x16_bf16 v[172:187], a[196:199], a[76:79], v[172:187]
    v_exp_f16_sdwa v220, v221 dst_sel:WORD_1 dst_unused:UNUSED_PRESERVE src0_sel:WORD_1
    v_pk_fma_f16 v218, v218, s101, s101
    v_pk_fma_f16 v220, v220, s101, s101
    v_rcp_f16_e64 v219, v218
    v_mfma_f32_32x32x16_bf16 v[172:187], a[200:203], a[80:83], v[172:187]
    ds_read_b64_tr_b16 a[240:241], v5 offset:0
    ds_read_b64_tr_b16 a[242:243], v5 offset:3072
    v_rcp_f16_e64 v221, v220
    v_rcp_f16_sdwa v218, v218 dst_sel:WORD_0 dst_unused:UNUSED_PAD src0_sel:WORD_1
    v_mfma_f32_32x32x16_bf16 v[172:187], a[204:207], a[84:87], v[172:187]
    ds_read_b128 a[220:223], v9 offset:4096
    v_rcp_f16_sdwa v220, v220 dst_sel:WORD_0 dst_unused:UNUSED_PAD src0_sel:WORD_1
    v_fma_mix_f32 v219, v196, v219, 0 op_sel_hi:[0,1,0]
    v_fma_mix_f32 v221, v198, v221, 0 op_sel_hi:[0,1,0]
    v_fma_mix_f32 v218, v197, v218, 0 op_sel_hi:[0,1,0]
    v_fma_mix_f32 v220, v199, v220, 0 op_sel_hi:[0,1,0]
    v_mfma_f32_32x32x16_bf16 v[172:187], a[208:211], a[88:91], v[172:187]
    buffer_load_dwordx4 v254, s[8:11], s39 offen offset:2048  lds
    v_cvt_pk_bf16_f32 v212, v219, v218
    v_cvt_pk_bf16_f32 v213, v221, v220
    v_cvt_pk_f16_f32 v222, v200, v201
    v_cvt_pk_f16_f32 v224, v202, v203
    v_pk_fma_f16 v223, v222, v222, s36
    v_mfma_f32_32x32x16_bf16 v[172:187], a[212:215], a[92:95], v[172:187]
    s_waitcnt lgkmcnt(1)
    v_pk_fma_f16 v225, v224, v224, s36
    v_pk_mul_f16 v223, v223, v222
    v_pk_mul_f16 v225, v225, v224
    v_exp_f16 v222, v223
    v_exp_f16_e64 v224, v225
    v_mfma_f32_32x32x16_bf16 v[16:31], a[232:235], a[216:219], v[16:31]
    buffer_load_dwordx4 a[148:151], v253, s[24:27], s42 offen offset:64 sc1
    ds_read_b128 a[224:227], v9 offset:8192
    v_exp_f16_sdwa v222, v223 dst_sel:WORD_1 dst_unused:UNUSED_PRESERVE src0_sel:WORD_1
    v_exp_f16_sdwa v224, v225 dst_sel:WORD_1 dst_unused:UNUSED_PRESERVE src0_sel:WORD_1
    v_pk_fma_f16 v222, v222, s101, s101
    v_mfma_f32_32x32x16_bf16 v[32:47], a[236:239], a[216:219], v[32:47]
    v_pk_fma_f16 v224, v224, s101, s101
    v_rcp_f16 v223, v222
    v_rcp_f16_e64 v225, v224
    v_rcp_f16_sdwa v222, v222 dst_sel:WORD_0 dst_unused:UNUSED_PAD src0_sel:WORD_1
    v_mfma_f32_32x32x16_bf16 v[48:63], a[240:243], a[216:219], v[48:63]
    s_waitcnt lgkmcnt(1)
    v_rcp_f16_sdwa v224, v224 dst_sel:WORD_0 dst_unused:UNUSED_PAD src0_sel:WORD_1
    v_fma_mix_f32 v223, v200, v223, 0 op_sel_hi:[0,1,0]
    v_fma_mix_f32 v225, v202, v225, 0 op_sel_hi:[0,1,0]
    v_fma_mix_f32 v222, v201, v222, 0 op_sel_hi:[0,1,0]
    v_fma_mix_f32 v224, v203, v224, 0 op_sel_hi:[0,1,0]
    v_cvt_pk_bf16_f32 v214, v223, v222
    v_mfma_f32_32x32x16_bf16 v[96:111], a[240:243], a[220:223], v[96:111]
    buffer_load_dwordx4 v255, s[8:11], s39 offen offset:3072  lds
    v_cvt_pk_bf16_f32 v215, v225, v224
    v_cvt_pk_f16_f32 v218, v172, v173
    v_cvt_pk_f16_f32 v220, v174, v175
    v_pk_fma_f16 v219, v218, v218, s36
    v_pk_fma_f16 v221, v220, v220, s36
    v_mfma_f32_32x32x16_bf16 v[80:95], a[236:239], a[220:223], v[80:95]
    ds_write_b128 v10, v[212:215] offset:25600
    v_pk_mul_f16 v219, v219, v218
    v_pk_mul_f16 v221, v221, v220
    v_mfma_f32_32x32x16_bf16 v[64:79], a[232:235], a[220:223], v[64:79]
    s_waitcnt lgkmcnt(1)
    v_exp_f16 v218, v219
    v_exp_f16_e64 v220, v221
    v_exp_f16_sdwa v218, v219 dst_sel:WORD_1 dst_unused:UNUSED_PRESERVE src0_sel:WORD_1
    v_mfma_f32_32x32x16_bf16 v[112:127], a[232:235], a[224:227], v[112:127]
    v_exp_f16_sdwa v220, v221 dst_sel:WORD_1 dst_unused:UNUSED_PRESERVE src0_sel:WORD_1
    v_pk_fma_f16 v218, v218, s101, s101
    v_pk_fma_f16 v220, v220, s101, s101
    v_rcp_f16_e64 v219, v218
    v_mfma_f32_32x32x16_bf16 v[128:143], a[236:239], a[224:227], v[128:143]
    v_rcp_f16_e64 v221, v220
    v_rcp_f16_sdwa v218, v218 dst_sel:WORD_0 dst_unused:UNUSED_PAD src0_sel:WORD_1
    v_rcp_f16_sdwa v220, v220 dst_sel:WORD_0 dst_unused:UNUSED_PAD src0_sel:WORD_1
    v_fma_mix_f32 v219, v172, v219, 0 op_sel_hi:[0,1,0]
    v_mfma_f32_32x32x16_bf16 v[144:159], a[240:243], a[224:227], v[144:159]
    s_add_u32 m0, s41, 105984
    buffer_load_dwordx4 a[152:155], v253, s[24:27], s42 offen offset:128 sc1
    buffer_load_dwordx4 v13, s[8:11], s100 offen offset:0  lds
    v_fma_mix_f32 v221, v174, v221, 0 op_sel_hi:[0,1,0]
    v_fma_mix_f32 v218, v173, v218, 0 op_sel_hi:[0,1,0]
    v_fma_mix_f32 v220, v175, v220, 0 op_sel_hi:[0,1,0]
    v_cvt_pk_bf16_f32 v208, v219, v218
    v_mfma_f32_32x32x16_bf16 v[188:203], a[168:171], a[96:99], 0
    ds_read_b64_tr_b16 a[168:169], v1 offset:24576
    v_cvt_pk_bf16_f32 v209, v221, v220
    v_cvt_pk_f16_f32 v222, v176, v177
    v_cvt_pk_f16_f32 v224, v178, v179
    v_pk_fma_f16 v223, v222, v222, s36
    v_pk_fma_f16 v225, v224, v224, s36
    v_pk_mul_f16 v223, v223, v222
    v_mfma_f32_32x32x16_bf16 v[188:203], a[172:175], a[100:103], v[188:203]
    ds_read_b64_tr_b16 a[170:171], v1 offset:25088
    v_pk_mul_f16 v225, v225, v224
    v_exp_f16_e64 v222, v223
    v_exp_f16_e64 v224, v225
    v_mfma_f32_32x32x16_bf16 v[188:203], a[176:179], a[104:107], v[188:203]
    ds_read_b64_tr_b16 a[172:173], v1 offset:26624
    v_exp_f16_sdwa v222, v223 dst_sel:WORD_1 dst_unused:UNUSED_PRESERVE src0_sel:WORD_1
    v_exp_f16_sdwa v224, v225 dst_sel:WORD_1 dst_unused:UNUSED_PRESERVE src0_sel:WORD_1
    v_pk_fma_f16 v222, v222, s101, s101
    v_pk_fma_f16 v224, v224, s101, s101
    v_mfma_f32_32x32x16_bf16 v[188:203], a[180:183], a[108:111], v[188:203]
    ds_read_b64_tr_b16 a[174:175], v1 offset:27136
    v_rcp_f16_e64 v223, v222
    v_rcp_f16_e64 v225, v224
    v_rcp_f16_sdwa v222, v222 dst_sel:WORD_0 dst_unused:UNUSED_PAD src0_sel:WORD_1
    v_mfma_f32_32x32x16_bf16 v[188:203], a[184:187], a[112:115], v[188:203]
    buffer_load_dwordx4 v14, s[8:11], s100 offen offset:1024  lds
    ds_read_b64_tr_b16 a[244:245], v3 offset:6144
    ds_read_b64_tr_b16 a[246:247], v3 offset:9216
    v_rcp_f16_sdwa v224, v224 dst_sel:WORD_0 dst_unused:UNUSED_PAD src0_sel:WORD_1
    v_fma_mix_f32 v223, v176, v223, 0 op_sel_hi:[0,1,0]
    v_mfma_f32_32x32x16_bf16 v[188:203], a[188:191], a[116:119], v[188:203]
    ds_read_b128 a[228:231], v9 offset:1024
    ds_read_b64_tr_b16 a[248:249], v4 offset:6144
    v_fma_mix_f32 v225, v178, v225, 0 op_sel_hi:[0,1,0]
    v_fma_mix_f32 v222, v177, v222, 0 op_sel_hi:[0,1,0]
    v_fma_mix_f32 v224, v179, v224, 0 op_sel_hi:[0,1,0]
    v_cvt_pk_bf16_f32 v210, v223, v222
    v_cvt_pk_bf16_f32 v211, v225, v224
    v_mfma_f32_32x32x16_bf16 v[188:203], a[192:195], a[120:123], v[188:203]
    ds_read_b64_tr_b16 a[250:251], v4 offset:9216
    ds_read_b64_tr_b16 a[252:253], v5 offset:6144
    v_cvt_pk_f16_f32 v218, v180, v181
    v_cvt_pk_f16_f32 v220, v182, v183
    v_pk_fma_f16 v219, v218, v218, s36
    v_pk_fma_f16 v221, v220, v220, s36
    v_pk_mul_f16 v219, v219, v218
    v_mfma_f32_32x32x16_bf16 v[188:203], a[196:199], a[124:127], v[188:203]
    buffer_load_dwordx4 a[156:159], v253, s[24:27], s42 offen offset:192 sc1
    ds_read_b64_tr_b16 a[254:255], v5 offset:9216
    ds_read_b128 a[216:219], v9 offset:5120
    v_pk_mul_f16 v221, v221, v220
    v_exp_f16_e64 v218, v219
    v_mfma_f32_32x32x16_bf16 v[188:203], a[200:203], a[128:131], v[188:203]
    ds_write_b128 v10, v[208:211] offset:28672
    v_exp_f16_e64 v220, v221
    v_mfma_f32_32x32x16_bf16 v[188:203], a[204:207], a[132:135], v[188:203]
    v_exp_f16_sdwa v218, v219 dst_sel:WORD_1 dst_unused:UNUSED_PRESERVE src0_sel:WORD_1
    v_exp_f16_sdwa v220, v221 dst_sel:WORD_1 dst_unused:UNUSED_PRESERVE src0_sel:WORD_1
    v_pk_fma_f16 v218, v218, s101, s101
    v_pk_fma_f16 v220, v220, s101, s101
    v_mfma_f32_32x32x16_bf16 v[188:203], a[208:211], a[136:139], v[188:203]
    s_add_u32 m0, s41, 24576
    v_rcp_f16 v219, v218
    v_rcp_f16_e64 v221, v220
    v_rcp_f16_sdwa v218, v218 dst_sel:WORD_0 dst_unused:UNUSED_PAD src0_sel:WORD_1
    v_mfma_f32_32x32x16_bf16 v[188:203], a[212:215], a[140:143], v[188:203]
    s_waitcnt lgkmcnt(1)
    buffer_load_dwordx4 v15, s[12:15], s40 offen offset:0  lds
    ds_read_b64_tr_b16 a[212:213], v1 offset:47104
    ds_read_b64_tr_b16 a[214:215], v1 offset:47616
    v_rcp_f16_sdwa v220, v220 dst_sel:WORD_0 dst_unused:UNUSED_PAD src0_sel:WORD_1
    v_fma_mix_f32 v219, v180, v219, 0 op_sel_hi:[0,1,0]
    v_mfma_f32_32x32x16_bf16 v[16:31], a[244:247], a[228:231], v[16:31]
    ds_read_b128 a[220:223], v9 offset:9216
    ds_read_b64_tr_b16 a[184:185], v1 offset:32768
    v_fma_mix_f32 v221, v182, v221, 0 op_sel_hi:[0,1,0]
    v_fma_mix_f32 v218, v181, v218, 0 op_sel_hi:[0,1,0]
    v_fma_mix_f32 v220, v183, v220, 0 op_sel_hi:[0,1,0]
    v_cvt_pk_bf16_f32 v212, v219, v218
    v_cvt_pk_bf16_f32 v213, v221, v220
    v_mfma_f32_32x32x16_bf16 v[32:47], a[248:251], a[228:231], v[32:47]
    ds_read_b64_tr_b16 a[176:177], v1 offset:28672
    ds_read_b64_tr_b16 a[186:187], v1 offset:33280
    v_cvt_pk_f16_f32 v222, v184, v185
    v_cvt_pk_f16_f32 v224, v186, v187
    v_pk_fma_f16 v223, v222, v222, s36
    v_pk_fma_f16 v225, v224, v224, s36
    v_pk_mul_f16 v223, v223, v222
    v_mfma_f32_32x32x16_bf16 v[48:63], a[252:255], a[228:231], v[48:63]
    buffer_load_dwordx4 v15, s[12:15], s40 offen offset:3072  lds
    ds_read_b64_tr_b16 a[232:233], v3 offset:12288
    v_pk_mul_f16 v225, v225, v224
    v_exp_f16_e64 v222, v223
    v_mfma_f32_32x32x16_bf16 v[96:111], a[252:255], a[216:219], v[96:111]
L_pg6:
    s_cbranch_execz L_wu1
    buffer_load_dwordx4 a[160:163], v253, s[24:27], s42 offen offset:256 sc1
    ds_read_b64_tr_b16 a[234:235], v3 offset:15360
    ds_read_b128 a[224:227], v9 offset:2048
    v_exp_f16 v224, v225
    v_exp_f16_sdwa v222, v223 dst_sel:WORD_1 dst_unused:UNUSED_PRESERVE src0_sel:WORD_1
    v_mfma_f32_32x32x16_bf16 v[80:95], a[248:251], a[216:219], v[80:95]
    ds_read_b64_tr_b16 a[236:237], v4 offset:12288
    ds_read_b64_tr_b16 a[238:239], v4 offset:15360
    v_exp_f16_sdwa v224, v225 dst_sel:WORD_1 dst_unused:UNUSED_PRESERVE src0_sel:WORD_1
    v_pk_fma_f16 v222, v222, s101, s101
    v_pk_fma_f16 v224, v224, s101, s101
    v_mfma_f32_32x32x16_bf16 v[64:79], a[244:247], a[216:219], v[64:79]
    s_waitcnt lgkmcnt(8)
    ds_read_b64_tr_b16 a[240:241], v5 offset:12288
    ds_read_b64_tr_b16 a[242:243], v5 offset:15360
    v_rcp_f16 v223, v222
    v_rcp_f16_e64 v225, v224
    v_mfma_f32_32x32x16_bf16 v[112:127], a[244:247], a[220:223], v[112:127]
    s_add_u32 m0, s41, 25600
    ds_read_b128 a[228:231], v9 offset:6144
    ds_read_b64_tr_b16 a[190:191], v1 offset:35328
    v_rcp_f16_sdwa v222, v222 dst_sel:WORD_0 dst_unused:UNUSED_PAD src0_sel:WORD_1
    v_rcp_f16_sdwa v224, v224 dst_sel:WORD_0 dst_unused:UNUSED_PAD src0_sel:WORD_1
    v_fma_mix_f32 v223, v184, v223, 0 op_sel_hi:[0,1,0]
    v_mfma_f32_32x32x16_bf16 v[128:143], a[248:251], a[220:223], v[128:143]
    s_nop 0
    buffer_load_dwordx4 v240, s[12:15], s40 offen offset:0  lds
    v_fma_mix_f32 v225, v186, v225, 0 op_sel_hi:[0,1,0]
    v_fma_mix_f32 v222, v185, v222, 0 op_sel_hi:[0,1,0]
    v_fma_mix_f32 v224, v187, v224, 0 op_sel_hi:[0,1,0]
    v_cvt_pk_bf16_f32 v214, v223, v222
    v_cvt_pk_bf16_f32 v215, v225, v224
    v_mfma_f32_32x32x16_bf16 v[144:159], a[252:255], a[220:223], v[144:159]
    s_waitcnt lgkmcnt(2)
    ds_read_b128 a[216:219], v9 offset:10240
    ds_read_b64_tr_b16 a[194:195], v1 offset:37376
    v_cvt_pk_f16_f32 v218, v188, v189
    v_cvt_pk_f16_f32 v220, v190, v191
    v_pk_fma_f16 v219, v218, v218, s36
    v_pk_fma_f16 v221, v220, v220, s36
    v_pk_mul_f16 v219, v219, v218
    v_mfma_f32_32x32x16_bf16 v[16:31], a[232:235], a[224:227], v[16:31]
    ds_write_b128 v10, v[212:215] offset:29696
    v_pk_mul_f16 v221, v221, v220
    v_mfma_f32_32x32x16_bf16 v[32:47], a[236:239], a[224:227], v[32:47]
    v_exp_f16 v218, v219
    v_exp_f16_e64 v220, v221
    v_exp_f16_sdwa v218, v219 dst_sel:WORD_1 dst_unused:UNUSED_PRESERVE src0_sel:WORD_1
    v_mfma_f32_32x32x16_bf16 v[48:63], a[240:243], a[224:227], v[48:63]
    s_waitcnt lgkmcnt(2)
    buffer_load_dwordx4 a[164:167], v253, s[24:27], s42 offen offset:320 sc1
    v_exp_f16_sdwa v220, v221 dst_sel:WORD_1 dst_unused:UNUSED_PRESERVE src0_sel:WORD_1
    v_pk_fma_f16 v218, v218, s101, s101
    v_pk_fma_f16 v220, v220, s101, s101
    v_rcp_f16 v219, v218
    v_mfma_f32_32x32x16_bf16 v[96:111], a[240:243], a[228:231], v[96:111]
    buffer_load_dwordx4 v240, s[12:15], s40 offen offset:3072  lds
    v_rcp_f16 v221, v220
    v_rcp_f16_sdwa v218, v218 dst_sel:WORD_0 dst_unused:UNUSED_PAD src0_sel:WORD_1
    v_mfma_f32_32x32x16_bf16 v[80:95], a[236:239], a[228:231], v[80:95]
    ds_read_b64_tr_b16 a[178:179], v1 offset:29184
    ds_read_b64_tr_b16 a[198:199], v1 offset:39424
    v_rcp_f16_sdwa v220, v220 dst_sel:WORD_0 dst_unused:UNUSED_PAD src0_sel:WORD_1
    v_fma_mix_f32 v219, v188, v219, 0 op_sel_hi:[0,1,0]
    v_fma_mix_f32 v221, v190, v221, 0 op_sel_hi:[0,1,0]
    v_fma_mix_f32 v218, v189, v218, 0 op_sel_hi:[0,1,0]
    v_mfma_f32_32x32x16_bf16 v[64:79], a[232:235], a[228:231], v[64:79]
    ds_read_b64_tr_b16 a[180:181], v1 offset:30720
    ds_read_b64_tr_b16 a[200:201], v1 offset:40960
    v_fma_mix_f32 v220, v191, v220, 0 op_sel_hi:[0,1,0]
    v_cvt_pk_bf16_f32 v208, v219, v218
    v_cvt_pk_bf16_f32 v209, v221, v220
    v_cvt_pk_f16_f32 v222, v192, v193
    v_cvt_pk_f16_f32 v224, v194, v195
    v_mfma_f32_32x32x16_bf16 v[112:127], a[232:235], a[216:219], v[112:127]
    s_add_u32 m0, s41, 26624
    ds_read_b64_tr_b16 a[182:183], v1 offset:31232
    ds_read_b64_tr_b16 a[202:203], v1 offset:41472
    v_pk_fma_f16 v223, v222, v222, s36
    v_pk_fma_f16 v225, v224, v224, s36
    v_pk_mul_f16 v223, v223, v222
    v_pk_mul_f16 v225, v225, v224
    v_mfma_f32_32x32x16_bf16 v[128:143], a[236:239], a[216:219], v[128:143]
    buffer_load_dwordx4 v241, s[12:15], s40 offen offset:0  lds
    v_exp_f16_e64 v222, v223
    v_exp_f16_e64 v224, v225
    v_mfma_f32_32x32x16_bf16 v[144:159], a[240:243], a[216:219], v[144:159]
    ds_read_b64_tr_b16 a[188:189], v1 offset:34816
    ds_read_b64_tr_b16 a[204:205], v1 offset:43008
    v_exp_f16_sdwa v222, v223 dst_sel:WORD_1 dst_unused:UNUSED_PRESERVE src0_sel:WORD_1
    v_exp_f16_sdwa v224, v225 dst_sel:WORD_1 dst_unused:UNUSED_PRESERVE src0_sel:WORD_1
    v_pk_fma_f16 v222, v222, s101, s101
    v_mfma_f32_32x32x16_bf16 v[172:187], a[168:171], a[0:3], 0
    ds_read_b64_tr_b16 a[192:193], v1 offset:36864
    ds_read_b64_tr_b16 a[206:207], v1 offset:43520
    v_pk_fma_f16 v224, v224, s101, s101
    v_rcp_f16 v223, v222
    v_rcp_f16_e64 v225, v224
    v_mfma_f32_32x32x16_bf16 v[172:187], a[172:175], a[4:7], v[172:187]
    s_waitcnt lgkmcnt(5)
    ds_read_b64_tr_b16 a[196:197], v1 offset:38912
    ds_read_b64_tr_b16 a[208:209], v1 offset:45056
    v_rcp_f16_sdwa v222, v222 dst_sel:WORD_0 dst_unused:UNUSED_PAD src0_sel:WORD_1
    v_rcp_f16_sdwa v224, v224 dst_sel:WORD_0 dst_unused:UNUSED_PAD src0_sel:WORD_1
    v_fma_mix_f32 v223, v192, v223, 0 op_sel_hi:[0,1,0]
    v_mfma_f32_32x32x16_bf16 v[172:187], a[176:179], a[8:11], v[172:187]
    ds_read_b64_tr_b16 a[244:245], v3 offset:18432
    ds_read_b64_tr_b16 a[210:211], v1 offset:45568
    v_fma_mix_f32 v225, v194, v225, 0 op_sel_hi:[0,1,0]
    v_fma_mix_f32 v222, v193, v222, 0 op_sel_hi:[0,1,0]
    v_fma_mix_f32 v224, v195, v224, 0 op_sel_hi:[0,1,0]
    v_cvt_pk_bf16_f32 v210, v223, v222
    v_cvt_pk_bf16_f32 v211, v225, v224
    v_mfma_f32_32x32x16_bf16 v[172:187], a[180:183], a[12:15], v[172:187]
    ds_write_b128 v10, v[208:211] offset:32768
    buffer_load_dwordx4 v241, s[12:15], s40 offen offset:3072  lds
    v_mfma_f32_32x32x16_bf16 v[172:187], a[184:187], a[16:19], v[172:187]
    s_waitcnt lgkmcnt(4)
    v_cvt_pk_f16_f32 v218, v196, v197
    v_cvt_pk_f16_f32 v220, v198, v199
    v_pk_fma_f16 v219, v218, v218, s36
    v_pk_fma_f16 v221, v220, v220, s36
    v_pk_mul_f16 v219, v219, v218
    v_pk_mul_f16 v221, v221, v220
    v_mfma_f32_32x32x16_bf16 v[172:187], a[188:191], a[20:23], v[172:187]
    v_exp_f16 v218, v219
    v_exp_f16_e64 v220, v221
    v_exp_f16_sdwa v218, v219 dst_sel:WORD_1 dst_unused:UNUSED_PRESERVE src0_sel:WORD_1
    v_exp_f16_sdwa v220, v221 dst_sel:WORD_1 dst_unused:UNUSED_PRESERVE src0_sel:WORD_1
    v_mfma_f32_32x32x16_bf16 v[172:187], a[192:195], a[24:27], v[172:187]
    ds_read_b64_tr_b16 a[246:247], v3 offset:21504
    ds_read_b128 a[220:223], v9 offset:3072
    v_pk_fma_f16 v218, v218, s101, s101
    v_pk_fma_f16 v220, v220, s101, s101
    v_rcp_f16_e64 v219, v218
    v_mfma_f32_32x32x16_bf16 v[172:187], a[196:199], a[28:31], v[172:187]
    ds_read_b64_tr_b16 a[248:249], v4 offset:18432
    ds_read_b64_tr_b16 a[250:251], v4 offset:21504
    v_rcp_f16_e64 v221, v220
    v_rcp_f16_sdwa v218, v218 dst_sel:WORD_0 dst_unused:UNUSED_PAD src0_sel:WORD_1
    v_rcp_f16_sdwa v220, v220 dst_sel:WORD_0 dst_unused:UNUSED_PAD src0_sel:WORD_1
    v_mfma_f32_32x32x16_bf16 v[172:187], a[200:203], a[32:35], v[172:187]
    s_nop 0
    ds_read_b64_tr_b16 a[252:253], v5 offset:18432
    ds_read_b64_tr_b16 a[254:255], v5 offset:21504
    v_fma_mix_f32 v219, v196, v219, 0 op_sel_hi:[0,1,0]
    v_fma_mix_f32 v221, v198, v221, 0 op_sel_hi:[0,1,0]
    v_fma_mix_f32 v218, v197, v218, 0 op_sel_hi:[0,1,0]
    v_fma_mix_f32 v220, v199, v220, 0 op_sel_hi:[0,1,0]
    v_cvt_pk_bf16_f32 v212, v219, v218
    v_mfma_f32_32x32x16_bf16 v[172:187], a[204:207], a[36:39], v[172:187]
    s_waitcnt lgkmcnt(4)
    ds_read_b128 a[224:227], v9 offset:7168
    v_cvt_pk_bf16_f32 v213, v221, v220
    v_cvt_pk_f16_f32 v222, v200, v201
    v_cvt_pk_f16_f32 v224, v202, v203
    v_pk_fma_f16 v223, v222, v222, s36
    v_pk_fma_f16 v225, v224, v224, s36
    v_pk_mul_f16 v223, v223, v222
    v_mfma_f32_32x32x16_bf16 v[172:187], a[208:211], a[40:43], v[172:187]
    v_pk_mul_f16 v225, v225, v224
    v_exp_f16_e64 v222, v223
    v_exp_f16_e64 v224, v225
    v_exp_f16_sdwa v222, v223 dst_sel:WORD_1 dst_unused:UNUSED_PRESERVE src0_sel:WORD_1
    v_mfma_f32_32x32x16_bf16 v[172:187], a[212:215], a[44:47], v[172:187]
    v_exp_f16_sdwa v224, v225 dst_sel:WORD_1 dst_unused:UNUSED_PRESERVE src0_sel:WORD_1
    v_pk_fma_f16 v222, v222, s101, s101
    v_pk_fma_f16 v224, v224, s101, s101
    v_rcp_f16 v223, v222
    v_mfma_f32_32x32x16_bf16 v[16:31], a[244:247], a[220:223], v[16:31]
    s_waitcnt lgkmcnt(0)
    ds_read_b128 a[228:231], v9 offset:11264
    v_rcp_f16_e64 v225, v224
    v_rcp_f16_sdwa v222, v222 dst_sel:WORD_0 dst_unused:UNUSED_PAD src0_sel:WORD_1
    v_rcp_f16_sdwa v224, v224 dst_sel:WORD_0 dst_unused:UNUSED_PAD src0_sel:WORD_1
    v_mfma_f32_32x32x16_bf16 v[32:47], a[248:251], a[220:223], v[32:47]
    v_fma_mix_f32 v223, v200, v223, 0 op_sel_hi:[0,1,0]
    v_fma_mix_f32 v225, v202, v225, 0 op_sel_hi:[0,1,0]
    v_fma_mix_f32 v222, v201, v222, 0 op_sel_hi:[0,1,0]
    v_fma_mix_f32 v224, v203, v224, 0 op_sel_hi:[0,1,0]
    v_cvt_pk_bf16_f32 v214, v223, v222
    v_cvt_pk_bf16_f32 v215, v225, v224
    v_cvt_pk_f16_f32 v218, v172, v173
    v_mfma_f32_32x32x16_bf16 v[48:63], a[252:255], a[220:223], v[48:63]
    s_nop 0
    ds_write_b128 v10, v[212:215] offset:33792
    v_cvt_pk_f16_f32 v220, v174, v175
    v_pk_fma_f16 v219, v218, v218, s36
    v_mfma_f32_32x32x16_bf16 v[96:111], a[252:255], a[224:227], v[96:111]
    s_cmp_eq_u32 s38, 2
    s_cselect_b32 s56, 1536, 0
    v_pk_fma_f16 v221, v220, v220, s36
    v_pk_mul_f16 v219, v219, v218
    v_pk_mul_f16 v221, v221, v220
    v_exp_f16 v218, v219
    v_exp_f16 v220, v221
    v_mfma_f32_32x32x16_bf16 v[80:95], a[248:251], a[224:227], v[80:95]
    s_sub_u32 s56, 128, s56
    v_exp_f16_sdwa v218, v219 dst_sel:WORD_1 dst_unused:UNUSED_PRESERVE src0_sel:WORD_1
    v_exp_f16_sdwa v220, v221 dst_sel:WORD_1 dst_unused:UNUSED_PRESERVE src0_sel:WORD_1
    v_pk_fma_f16 v218, v218, s101, s101
    v_pk_fma_f16 v220, v220, s101, s101
    v_rcp_f16_e64 v219, v218
    v_mfma_f32_32x32x16_bf16 v[64:79], a[244:247], a[224:227], v[64:79]
    s_waitcnt lgkmcnt(1)
    v_rcp_f16_e64 v221, v220
    v_rcp_f16_sdwa v218, v218 dst_sel:WORD_0 dst_unused:UNUSED_PAD src0_sel:WORD_1
    v_rcp_f16_sdwa v220, v220 dst_sel:WORD_0 dst_unused:UNUSED_PAD src0_sel:WORD_1
    v_fma_mix_f32 v219, v172, v219, 0 op_sel_hi:[0,1,0]
    v_mfma_f32_32x32x16_bf16 v[112:127], a[244:247], a[228:231], v[112:127]
    s_add_u32 s39, s39, s56
    v_fma_mix_f32 v221, v174, v221, 0 op_sel_hi:[0,1,0]
    v_fma_mix_f32 v218, v173, v218, 0 op_sel_hi:[0,1,0]
    v_fma_mix_f32 v220, v175, v220, 0 op_sel_hi:[0,1,0]
    v_cvt_pk_bf16_f32 v208, v219, v218
    v_cvt_pk_bf16_f32 v209, v221, v220
    v_cvt_pk_f16_f32 v222, v176, v177
    v_cvt_pk_f16_f32 v224, v178, v179
    v_mfma_f32_32x32x16_bf16 v[128:143], a[248:251], a[228:231], v[128:143]
    s_add_u32 s100, s100, s56
    v_pk_fma_f16 v223, v222, v222, s36
    v_pk_fma_f16 v225, v224, v224, s36
    v_pk_mul_f16 v223, v223, v222
    v_pk_mul_f16 v225, v225, v224
    v_exp_f16 v222, v223
    v_mfma_f32_32x32x16_bf16 v[144:159], a[252:255], a[228:231], v[144:159]
    s_add_u32 s40, s40, 24576
    v_exp_f16_e64 v224, v225
    v_exp_f16_sdwa v222, v223 dst_sel:WORD_1 dst_unused:UNUSED_PRESERVE src0_sel:WORD_1
    v_exp_f16_sdwa v224, v225 dst_sel:WORD_1 dst_unused:UNUSED_PRESERVE src0_sel:WORD_1
    v_pk_fma_f16 v222, v222, s101, s101
    s_waitcnt vmcnt(0) lgkmcnt(0)
    s_barrier
    v_mfma_f32_32x32x16_bf16 v[188:203], a[168:171], a[48:51], 0
    s_add_u32 m0, s41, 126464
    v_pk_fma_f16 v224, v224, s101, s101
    v_rcp_f16 v223, v222
    v_rcp_f16 v225, v224
    v_rcp_f16_sdwa v222, v222 dst_sel:WORD_0 dst_unused:UNUSED_PAD src0_sel:WORD_1
    v_mfma_f32_32x32x16_bf16 v[188:203], a[172:175], a[52:55], v[188:203]
    buffer_load_dwordx4 v13, s[8:11], s39 offen offset:0  lds
    v_rcp_f16_sdwa v224, v224 dst_sel:WORD_0 dst_unused:UNUSED_PAD src0_sel:WORD_1
    v_fma_mix_f32 v223, v176, v223, 0 op_sel_hi:[0,1,0]
    v_fma_mix_f32 v225, v178, v225, 0 op_sel_hi:[0,1,0]
    v_fma_mix_f32 v222, v177, v222, 0 op_sel_hi:[0,1,0]
    v_mfma_f32_32x32x16_bf16 v[188:203], a[176:179], a[56:59], v[188:203]
    ds_read_b64_tr_b16 a[232:233], v3 offset:24576
    v_fma_mix_f32 v224, v179, v224, 0 op_sel_hi:[0,1,0]
    v_cvt_pk_bf16_f32 v210, v223, v222
    v_cvt_pk_bf16_f32 v211, v225, v224
    v_cvt_pk_f16_f32 v218, v180, v181
    v_cvt_pk_f16_f32 v220, v182, v183
    v_pk_fma_f16 v219, v218, v218, s36
    v_mfma_f32_32x32x16_bf16 v[188:203], a[180:183], a[60:63], v[188:203]
    ds_write_b128 v10, v[208:211] offset:0
    v_pk_fma_f16 v221, v220, v220, s36
    v_pk_mul_f16 v219, v219, v218
    v_mfma_f32_32x32x16_bf16 v[188:203], a[184:187], a[64:67], v[188:203]
    v_pk_mul_f16 v221, v221, v220
    v_exp_f16_e64 v218, v219
    v_exp_f16_e64 v220, v221
    v_exp_f16_sdwa v218, v219 dst_sel:WORD_1 dst_unused:UNUSED_PRESERVE src0_sel:WORD_1
    v_mfma_f32_32x32x16_bf16 v[188:203], a[188:191], a[68:71], v[188:203]
    v_exp_f16_sdwa v220, v221 dst_sel:WORD_1 dst_unused:UNUSED_PRESERVE src0_sel:WORD_1
    v_pk_fma_f16 v218, v218, s101, s101
    v_pk_fma_f16 v220, v220, s101, s101
    v_rcp_f16_e64 v219, v218
    v_mfma_f32_32x32x16_bf16 v[188:203], a[192:195], a[72:75], v[188:203]
    ds_read_b64_tr_b16 a[234:235], v3 offset:27648
    ds_read_b128 a[216:219], v9 offset:24576
    v_rcp_f16_e64 v221, v220
    v_rcp_f16_sdwa v218, v218 dst_sel:WORD_0 dst_unused:UNUSED_PAD src0_sel:WORD_1
    v_mfma_f32_32x32x16_bf16 v[188:203], a[196:199], a[76:79], v[188:203]
    ds_read_b64_tr_b16 a[236:237], v4 offset:24576
    ds_read_b64_tr_b16 a[238:239], v4 offset:27648
    v_rcp_f16_sdwa v220, v220 dst_sel:WORD_0 dst_unused:UNUSED_PAD src0_sel:WORD_1
    v_fma_mix_f32 v219, v180, v219, 0 op_sel_hi:[0,1,0]
    v_fma_mix_f32 v221, v182, v221, 0 op_sel_hi:[0,1,0]
    v_fma_mix_f32 v218, v181, v218, 0 op_sel_hi:[0,1,0]
    v_mfma_f32_32x32x16_bf16 v[188:203], a[200:203], a[80:83], v[188:203]
    ds_read_b64_tr_b16 a[240:241], v5 offset:24576
    ds_read_b64_tr_b16 a[242:243], v5 offset:27648
    v_fma_mix_f32 v220, v183, v220, 0 op_sel_hi:[0,1,0]
    v_cvt_pk_bf16_f32 v212, v219, v218
    v_cvt_pk_bf16_f32 v213, v221, v220
    v_cvt_pk_f16_f32 v222, v184, v185
    v_cvt_pk_f16_f32 v224, v186, v187
    v_mfma_f32_32x32x16_bf16 v[188:203], a[204:207], a[84:87], v[188:203]
    buffer_load_dwordx4 v14, s[8:11], s39 offen offset:1024  lds
    ds_read_b128 a[220:223], v9 offset:28672
    v_pk_fma_f16 v223, v222, v222, s36
    v_pk_fma_f16 v225, v224, v224, s36
    v_pk_mul_f16 v223, v223, v222
    v_pk_mul_f16 v225, v225, v224
    v_mfma_f32_32x32x16_bf16 v[188:203], a[208:211], a[88:91], v[188:203]
    v_exp_f16 v222, v223
    v_exp_f16_e64 v224, v225
    v_exp_f16_sdwa v222, v223 dst_sel:WORD_1 dst_unused:UNUSED_PRESERVE src0_sel:WORD_1
    v_mfma_f32_32x32x16_bf16 v[188:203], a[212:215], a[92:95], v[188:203]
    s_waitcnt lgkmcnt(1)
    buffer_load_dwordx4 v254, s[8:11], s39 offen offset:2048  lds
    v_exp_f16_sdwa v224, v225 dst_sel:WORD_1 dst_unused:UNUSED_PRESERVE src0_sel:WORD_1
    v_pk_fma_f16 v222, v222, s101, s101
    v_pk_fma_f16 v224, v224, s101, s101
    v_rcp_f16_e64 v223, v222
    v_mfma_f32_32x32x16_bf16 v[16:31], a[232:235], a[216:219], v[16:31]
    ds_read_b128 a[224:227], v9 offset:32768
    v_rcp_f16_e64 v225, v224
    v_rcp_f16_sdwa v222, v222 dst_sel:WORD_0 dst_unused:UNUSED_PAD src0_sel:WORD_1
    v_rcp_f16_sdwa v224, v224 dst_sel:WORD_0 dst_unused:UNUSED_PAD src0_sel:WORD_1
    v_mfma_f32_32x32x16_bf16 v[32:47], a[236:239], a[216:219], v[32:47]
    v_fma_mix_f32 v223, v184, v223, 0 op_sel_hi:[0,1,0]
    v_fma_mix_f32 v225, v186, v225, 0 op_sel_hi:[0,1,0]
    v_fma_mix_f32 v222, v185, v222, 0 op_sel_hi:[0,1,0]
    v_fma_mix_f32 v224, v187, v224, 0 op_sel_hi:[0,1,0]
    v_cvt_pk_bf16_f32 v214, v223, v222
    v_cvt_pk_bf16_f32 v215, v225, v224
    v_cvt_pk_f16_f32 v218, v188, v189
    v_mfma_f32_32x32x16_bf16 v[48:63], a[240:243], a[216:219], v[48:63]
    s_waitcnt lgkmcnt(1)
    ds_write_b128 v10, v[212:215] offset:1024
    v_cvt_pk_f16_f32 v220, v190, v191
    v_pk_fma_f16 v219, v218, v218, s36
    v_mfma_f32_32x32x16_bf16 v[96:111], a[240:243], a[220:223], v[96:111]
    v_pk_fma_f16 v221, v220, v220, s36
    v_pk_mul_f16 v219, v219, v218
    v_pk_mul_f16 v221, v221, v220
    v_exp_f16 v218, v219
    v_exp_f16 v220, v221
    v_mfma_f32_32x32x16_bf16 v[80:95], a[236:239], a[220:223], v[80:95]
    v_exp_f16_sdwa v218, v219 dst_sel:WORD_1 dst_unused:UNUSED_PRESERVE src0_sel:WORD_1
    v_exp_f16_sdwa v220, v221 dst_sel:WORD_1 dst_unused:UNUSED_PRESERVE src0_sel:WORD_1
    v_pk_fma_f16 v218, v218, s101, s101
    v_pk_fma_f16 v220, v220, s101, s101
    v_mfma_f32_32x32x16_bf16 v[64:79], a[232:235], a[220:223], v[64:79]
    s_waitcnt lgkmcnt(1)
    buffer_load_dwordx4 v255, s[8:11], s39 offen offset:3072  lds
    v_rcp_f16 v219, v218
    v_rcp_f16 v221, v220
    v_rcp_f16_sdwa v218, v218 dst_sel:WORD_0 dst_unused:UNUSED_PAD src0_sel:WORD_1
    v_mfma_f32_32x32x16_bf16 v[112:127], a[232:235], a[224:227], v[112:127]
    v_rcp_f16_sdwa v220, v220 dst_sel:WORD_0 dst_unused:UNUSED_PAD src0_sel:WORD_1
    v_fma_mix_f32 v219, v188, v219, 0 op_sel_hi:[0,1,0]
    v_fma_mix_f32 v221, v190, v221, 0 op_sel_hi:[0,1,0]
    v_fma_mix_f32 v218, v189, v218, 0 op_sel_hi:[0,1,0]
    v_fma_mix_f32 v220, v191, v220, 0 op_sel_hi:[0,1,0]
    v_cvt_pk_bf16_f32 v208, v219, v218
    v_mfma_f32_32x32x16_bf16 v[128:143], a[236:239], a[224:227], v[128:143]
    v_cvt_pk_bf16_f32 v209, v221, v220
    v_cvt_pk_f16_f32 v222, v192, v193
    v_cvt_pk_f16_f32 v224, v194, v195
    v_pk_fma_f16 v223, v222, v222, s36
    v_pk_fma_f16 v225, v224, v224, s36
    v_pk_mul_f16 v223, v223, v222
    v_pk_mul_f16 v225, v225, v224
    v_mfma_f32_32x32x16_bf16 v[144:159], a[240:243], a[224:227], v[144:159]
    v_exp_f16 v222, v223
    v_exp_f16 v224, v225
    v_exp_f16_sdwa v222, v223 dst_sel:WORD_1 dst_unused:UNUSED_PRESERVE src0_sel:WORD_1
    v_mfma_f32_32x32x16_bf16 v[172:187], a[168:171], a[96:99], 0
    s_add_u32 m0, s41, 130560
    ds_read_b64_tr_b16 a[168:169], v1 offset:0
    v_exp_f16_sdwa v224, v225 dst_sel:WORD_1 dst_unused:UNUSED_PRESERVE src0_sel:WORD_1
    v_pk_fma_f16 v222, v222, s101, s101
    v_pk_fma_f16 v224, v224, s101, s101
    v_rcp_f16 v223, v222
    v_mfma_f32_32x32x16_bf16 v[172:187], a[172:175], a[100:103], v[172:187]
    buffer_load_dwordx4 v13, s[8:11], s100 offen offset:0  lds
    v_rcp_f16 v225, v224
    v_rcp_f16_sdwa v222, v222 dst_sel:WORD_0 dst_unused:UNUSED_PAD src0_sel:WORD_1
    v_rcp_f16_sdwa v224, v224 dst_sel:WORD_0 dst_unused:UNUSED_PAD src0_sel:WORD_1
    v_mfma_f32_32x32x16_bf16 v[172:187], a[176:179], a[104:107], v[172:187]
    ds_read_b64_tr_b16 a[244:245], v3 offset:30720
    ds_read_b64_tr_b16 a[246:247], v3 offset:33792
    v_fma_mix_f32 v223, v192, v223, 0 op_sel_hi:[0,1,0]
    v_fma_mix_f32 v225, v194, v225, 0 op_sel_hi:[0,1,0]
    v_fma_mix_f32 v222, v193, v222, 0 op_sel_hi:[0,1,0]
    v_fma_mix_f32 v224, v195, v224, 0 op_sel_hi:[0,1,0]
    v_cvt_pk_bf16_f32 v210, v223, v222
    v_mfma_f32_32x32x16_bf16 v[172:187], a[180:183], a[108:111], v[172:187]
    ds_read_b128 a[228:231], v9 offset:25600
    ds_read_b64_tr_b16 a[248:249], v4 offset:30720
    v_cvt_pk_bf16_f32 v211, v225, v224
    v_cvt_pk_f16_f32 v218, v196, v197
    v_cvt_pk_f16_f32 v220, v198, v199
    v_pk_fma_f16 v219, v218, v218, s36
    v_pk_fma_f16 v221, v220, v220, s36
    v_mfma_f32_32x32x16_bf16 v[172:187], a[184:187], a[112:115], v[172:187]
    ds_write_b128 v10, v[208:211] offset:4096
    v_pk_mul_f16 v219, v219, v218
    v_pk_mul_f16 v221, v221, v220
    v_mfma_f32_32x32x16_bf16 v[172:187], a[188:191], a[116:119], v[172:187]
    v_exp_f16 v218, v219
    v_exp_f16 v220, v221
    v_exp_f16_sdwa v218, v219 dst_sel:WORD_1 dst_unused:UNUSED_PRESERVE src0_sel:WORD_1
    v_mfma_f32_32x32x16_bf16 v[172:187], a[192:195], a[120:123], v[172:187]
    buffer_load_dwordx4 v14, s[8:11], s100 offen offset:1024  lds
    v_exp_f16_sdwa v220, v221 dst_sel:WORD_1 dst_unused:UNUSED_PRESERVE src0_sel:WORD_1
    v_pk_fma_f16 v218, v218, s101, s101
    v_pk_fma_f16 v220, v220, s101, s101
    v_rcp_f16 v219, v218
    v_mfma_f32_32x32x16_bf16 v[172:187], a[196:199], a[124:127], v[172:187]
    ds_read_b64_tr_b16 a[250:251], v4 offset:33792
    ds_read_b64_tr_b16 a[252:253], v5 offset:30720
    v_rcp_f16 v221, v220
    v_rcp_f16_sdwa v218, v218 dst_sel:WORD_0 dst_unused:UNUSED_PAD src0_sel:WORD_1
    v_mfma_f32_32x32x16_bf16 v[172:187], a[200:203], a[128:131], v[172:187]
    ds_read_b64_tr_b16 a[254:255], v5 offset:33792
    ds_read_b64_tr_b16 v[226:227], v2 offset:0
    v_rcp_f16_sdwa v220, v220 dst_sel:WORD_0 dst_unused:UNUSED_PAD src0_sel:WORD_1
    v_fma_mix_f32 v219, v196, v219, 0 op_sel_hi:[0,1,0]
    v_fma_mix_f32 v221, v198, v221, 0 op_sel_hi:[0,1,0]
    v_fma_mix_f32 v218, v197, v218, 0 op_sel_hi:[0,1,0]
    v_mfma_f32_32x32x16_bf16 v[172:187], a[204:207], a[132:135], v[172:187]
    ds_read_b64_tr_b16 v[228:229], v2 offset:512
    ds_read_b128 a[216:219], v9 offset:29696
    v_fma_mix_f32 v220, v199, v220, 0 op_sel_hi:[0,1,0]
    v_cvt_pk_bf16_f32 v212, v219, v218
    v_cvt_pk_bf16_f32 v213, v221, v220
    v_cvt_pk_f16_f32 v222, v200, v201
    v_cvt_pk_f16_f32 v224, v202, v203
    v_mfma_f32_32x32x16_bf16 v[172:187], a[208:211], a[136:139], v[172:187]
    s_add_u32 m0, s41, 0
    ds_read_b64_tr_b16 a[170:171], v1 offset:512
    ds_read_b64_tr_b16 a[184:185], v1 offset:8192
    v_pk_fma_f16 v223, v222, v222, s36
    v_pk_fma_f16 v225, v224, v224, s36
    v_pk_mul_f16 v223, v223, v222
    v_pk_mul_f16 v225, v225, v224
    v_exp_f16 v222, v223
    v_mfma_f32_32x32x16_bf16 v[172:187], a[212:215], a[140:143], v[172:187]
    s_waitcnt lgkmcnt(4)
    ds_read_b64_tr_b16 v[230:231], v2 offset:4096
    ds_read_b64_tr_b16 v[232:233], v2 offset:4608
    ds_read_b64_tr_b16 a[214:215], v1 offset:23040
    v_exp_f16 v224, v225
    v_exp_f16_sdwa v222, v223 dst_sel:WORD_1 dst_unused:UNUSED_PRESERVE src0_sel:WORD_1
    v_mfma_f32_32x32x16_bf16 v[16:31], a[244:247], a[228:231], v[16:31]
    buffer_load_dwordx4 v15, s[12:15], s40 offen offset:0  lds
    v_exp_f16_sdwa v224, v225 dst_sel:WORD_1 dst_unused:UNUSED_PRESERVE src0_sel:WORD_1
    v_pk_fma_f16 v222, v222, s101, s101
    v_pk_fma_f16 v224, v224, s101, s101
    v_mfma_f32_32x32x16_bf16 v[32:47], a[248:251], a[228:231], v[32:47]
    ds_read_b128 a[220:223], v9 offset:33792
    ds_read_b64_tr_b16 a[232:233], v3 offset:36864
    v_rcp_f16 v223, v222
    v_rcp_f16 v225, v224
    v_rcp_f16_sdwa v222, v222 dst_sel:WORD_0 dst_unused:UNUSED_PAD src0_sel:WORD_1
    v_mfma_f32_32x32x16_bf16 v[48:63], a[252:255], a[228:231], v[48:63]
    s_waitcnt lgkmcnt(3)
    ds_read_b64_tr_b16 a[234:235], v3 offset:39936
    ds_read_b128 a[224:227], v9 offset:26624
    v_rcp_f16_sdwa v224, v224 dst_sel:WORD_0 dst_unused:UNUSED_PAD src0_sel:WORD_1
    v_fma_mix_f32 v223, v200, v223, 0 op_sel_hi:[0,1,0]
    v_fma_mix_f32 v225, v202, v225, 0 op_sel_hi:[0,1,0]
    v_fma_mix_f32 v222, v201, v222, 0 op_sel_hi:[0,1,0]
    v_mfma_f32_16x16x32_bf16 v[204:207], v[226:229], a[144:147], 0
    s_nop 0
    ds_read_b64_tr_b16 v[226:227], v2 offset:8192
    ds_read_b64_tr_b16 v[228:229], v2 offset:8704
    ds_read_b64_tr_b16 a[236:237], v4 offset:36864
    ds_read_b64_tr_b16 a[238:239], v4 offset:39936
    v_mfma_f32_32x32x16_bf16 v[96:111], a[252:255], a[216:219], v[96:111]
    ds_read_b64_tr_b16 a[240:241], v5 offset:36864
    ds_read_b64_tr_b16 a[242:243], v5 offset:39936
    v_fma_mix_f32 v224, v203, v224, 0 op_sel_hi:[0,1,0]
    v_cvt_pk_bf16_f32 v214, v223, v222
    v_cvt_pk_bf16_f32 v215, v225, v224
    v_cvt_pk_f16_f32 v218, v172, v173
    v_cvt_pk_f16_f32 v220, v174, v175
    v_mfma_f32_32x32x16_bf16 v[80:95], a[248:251], a[216:219], v[80:95]
    ds_write_b128 v10, v[212:215] offset:5120
    buffer_load_dwordx4 v15, s[12:15], s40 offen offset:3072  lds
    v_mfma_f32_16x16x32_bf16 v[204:207], v[230:233], a[148:151], v[204:207]
    ds_read_b64_tr_b16 v[230:231], v2 offset:12288
    v_pk_fma_f16 v219, v218, v218, s36
    v_mfma_f32_32x32x16_bf16 v[64:79], a[244:247], a[216:219], v[64:79]
    s_waitcnt lgkmcnt(6)
    v_pk_fma_f16 v221, v220, v220, s36
    v_pk_mul_f16 v219, v219, v218
    v_pk_mul_f16 v221, v221, v220
    v_exp_f16 v218, v219
    v_exp_f16_e64 v220, v221
    v_mfma_f32_32x32x16_bf16 v[112:127], a[244:247], a[220:223], v[112:127]
    v_exp_f16_sdwa v218, v219 dst_sel:WORD_1 dst_unused:UNUSED_PRESERVE src0_sel:WORD_1
    v_exp_f16_sdwa v220, v221 dst_sel:WORD_1 dst_unused:UNUSED_PRESERVE src0_sel:WORD_1
    v_pk_fma_f16 v218, v218, s101, s101
    v_pk_fma_f16 v220, v220, s101, s101
    v_mfma_f32_16x16x32_bf16 v[204:207], v[226:229], a[152:155], v[204:207]
    ds_read_b64_tr_b16 v[226:227], v2 offset:16384
    ds_read_b64_tr_b16 v[228:229], v2 offset:16896
    v_mfma_f32_32x32x16_bf16 v[128:143], a[248:251], a[220:223], v[128:143]
    s_add_u32 m0, s41, 1024
    ds_read_b64_tr_b16 v[232:233], v2 offset:12800
    ds_read_b128 a[228:231], v9 offset:30720
    v_rcp_f16 v219, v218
    v_rcp_f16_e64 v221, v220
    v_mfma_f32_32x32x16_bf16 v[144:159], a[252:255], a[220:223], v[144:159]
    buffer_load_dwordx4 v240, s[12:15], s40 offen offset:0  lds
    v_rcp_f16_sdwa v218, v218 dst_sel:WORD_0 dst_unused:UNUSED_PAD src0_sel:WORD_1
    v_rcp_f16_sdwa v220, v220 dst_sel:WORD_0 dst_unused:UNUSED_PAD src0_sel:WORD_1
    v_fma_mix_f32 v219, v172, v219, 0 op_sel_hi:[0,1,0]
    v_mfma_f32_32x32x16_bf16 v[16:31], a[232:235], a[224:227], v[16:31]
    s_waitcnt lgkmcnt(1)
    ds_read_b64_tr_b16 a[172:173], v1 offset:2048
    ds_read_b64_tr_b16 a[186:187], v1 offset:8704
    v_fma_mix_f32 v221, v174, v221, 0 op_sel_hi:[0,1,0]
    v_fma_mix_f32 v218, v173, v218, 0 op_sel_hi:[0,1,0]
    v_fma_mix_f32 v220, v175, v220, 0 op_sel_hi:[0,1,0]
    v_cvt_pk_bf16_f32 v208, v219, v218
    v_cvt_pk_bf16_f32 v209, v221, v220
    v_mfma_f32_16x16x32_bf16 v[204:207], v[230:233], a[156:159], v[204:207]
    ds_read_b64_tr_b16 v[230:231], v2 offset:20480
    ds_read_b64_tr_b16 v[232:233], v2 offset:20992
    v_cvt_pk_f16_f32 v222, v176, v177
    v_mfma_f32_32x32x16_bf16 v[32:47], a[236:239], a[224:227], v[32:47]
    ds_read_b128 a[216:219], v9 offset:34816
    ds_read_b64_tr_b16 a[188:189], v1 offset:10240
    v_cvt_pk_f16_f32 v224, v178, v179
    v_pk_fma_f16 v223, v222, v222, s36
    v_pk_fma_f16 v225, v224, v224, s36
    v_pk_mul_f16 v223, v223, v222
    v_pk_mul_f16 v225, v225, v224
    v_mfma_f32_32x32x16_bf16 v[48:63], a[240:243], a[224:227], v[48:63]
    buffer_load_dwordx4 v240, s[12:15], s40 offen offset:3072  lds
    v_exp_f16 v222, v223
    v_exp_f16_e64 v224, v225
    v_exp_f16_sdwa v222, v223 dst_sel:WORD_1 dst_unused:UNUSED_PRESERVE src0_sel:WORD_1
    v_mfma_f32_16x16x32_bf16 v[204:207], v[226:229], a[160:163], v[204:207]
    s_waitcnt lgkmcnt(2)
    ds_read_b64_tr_b16 a[174:175], v1 offset:2560
    ds_read_b64_tr_b16 a[190:191], v1 offset:10752
    v_mfma_f32_32x32x16_bf16 v[96:111], a[240:243], a[228:231], v[96:111]
    ds_read_b64_tr_b16 a[176:177], v1 offset:4096
    ds_read_b64_tr_b16 a[192:193], v1 offset:12288
    v_exp_f16_sdwa v224, v225 dst_sel:WORD_1 dst_unused:UNUSED_PRESERVE src0_sel:WORD_1
    v_pk_fma_f16 v222, v222, s101, s101
    v_pk_fma_f16 v224, v224, s101, s101
    v_mfma_f32_32x32x16_bf16 v[80:95], a[236:239], a[228:231], v[80:95]
    ds_read_b64_tr_b16 a[178:179], v1 offset:4608
    ds_read_b64_tr_b16 a[194:195], v1 offset:12800
L_pg7:
    s_cbranch_execz L_wu1
    v_rcp_f16 v223, v222
    v_rcp_f16 v225, v224
    v_rcp_f16_sdwa v222, v222 dst_sel:WORD_0 dst_unused:UNUSED_PAD src0_sel:WORD_1
    v_mfma_f32_16x16x32_bf16 v[204:207], v[230:233], a[164:167], v[204:207]
    s_add_u32 m0, s41, 2048
    ds_read_b64_tr_b16 a[180:181], v1 offset:6144
    ds_read_b64_tr_b16 a[198:199], v1 offset:14848
    v_mfma_f32_32x32x16_bf16 v[64:79], a[232:235], a[228:231], v[64:79]
    s_waitcnt lgkmcnt(7)
    buffer_load_dwordx4 v241, s[12:15], s40 offen offset:0  lds
    v_rcp_f16_sdwa v224, v224 dst_sel:WORD_0 dst_unused:UNUSED_PAD src0_sel:WORD_1
    v_fma_mix_f32 v223, v176, v223, 0 op_sel_hi:[0,1,0]
    v_fma_mix_f32 v225, v178, v225, 0 op_sel_hi:[0,1,0]
    v_fma_mix_f32 v222, v177, v222, 0 op_sel_hi:[0,1,0]
    v_mfma_f32_32x32x16_bf16 v[112:127], a[232:235], a[216:219], v[112:127]
    ds_read_b64_tr_b16 a[182:183], v1 offset:6656
    ds_read_b64_tr_b16 a[200:201], v1 offset:16384
    v_fma_mix_f32 v224, v179, v224, 0 op_sel_hi:[0,1,0]
    v_cvt_pk_bf16_f32 v210, v223, v222
    v_cvt_pk_bf16_f32 v211, v225, v224
    v_cvt_pk_f16_f32 v218, v180, v181
    v_cvt_pk_f16_f32 v220, v182, v183
    v_mfma_f32_32x32x16_bf16 v[128:143], a[236:239], a[216:219], v[128:143]
    ds_write_b128 v10, v[208:211] offset:8192
    v_pk_fma_f16 v219, v218, v218, s36
    v_pk_fma_f16 v221, v220, v220, s36
    v_mfma_f32_32x32x16_bf16 v[144:159], a[240:243], a[216:219], v[144:159]
    v_pk_mul_f16 v219, v219, v218
    v_pk_mul_f16 v221, v221, v220
    v_exp_f16 v218, v219
    v_exp_f16 v220, v221
    v_exp_f16_sdwa v218, v219 dst_sel:WORD_1 dst_unused:UNUSED_PRESERVE src0_sel:WORD_1
    v_mfma_f32_32x32x16_bf16 v[188:203], a[168:171], a[0:3], 0
    v_exp_f16_sdwa v220, v221 dst_sel:WORD_1 dst_unused:UNUSED_PRESERVE src0_sel:WORD_1
    v_pk_fma_f16 v218, v218, s101, s101
    v_pk_fma_f16 v220, v220, s101, s101
    v_rcp_f16 v219, v218
    v_mfma_f32_32x32x16_bf16 v[188:203], a[172:175], a[4:7], v[188:203]
    s_waitcnt lgkmcnt(2)
    ds_read_b64_tr_b16 a[196:197], v1 offset:14336
    ds_read_b64_tr_b16 a[202:203], v1 offset:16896
    v_rcp_f16_e64 v221, v220
    v_rcp_f16_sdwa v218, v218 dst_sel:WORD_0 dst_unused:UNUSED_PAD src0_sel:WORD_1
    v_rcp_f16_sdwa v220, v220 dst_sel:WORD_0 dst_unused:UNUSED_PAD src0_sel:WORD_1
    v_mfma_f32_32x32x16_bf16 v[188:203], a[176:179], a[8:11], v[188:203]
    buffer_load_dwordx4 v241, s[12:15], s40 offen offset:3072  lds
    v_fma_mix_f32 v219, v180, v219, 0 op_sel_hi:[0,1,0]
    v_fma_mix_f32 v221, v182, v221, 0 op_sel_hi:[0,1,0]
    v_fma_mix_f32 v218, v181, v218, 0 op_sel_hi:[0,1,0]
    v_fma_mix_f32 v220, v183, v220, 0 op_sel_hi:[0,1,0]
    v_cvt_pk_bf16_f32 v212, v219, v218
    v_mfma_f32_32x32x16_bf16 v[188:203], a[180:183], a[12:15], v[188:203]
    ds_read_b64_tr_b16 a[204:205], v1 offset:18432
    ds_read_b64_tr_b16 a[206:207], v1 offset:18944
    v_cvt_pk_bf16_f32 v213, v221, v220
    v_cvt_pk_f16_f32 v222, v184, v185
    v_cvt_pk_f16_f32 v224, v186, v187
    v_pk_fma_f16 v223, v222, v222, s36
    v_pk_fma_f16 v225, v224, v224, s36
    v_mfma_f32_32x32x16_bf16 v[188:203], a[184:187], a[16:19], v[188:203]
    ds_read_b64_tr_b16 a[208:209], v1 offset:20480
    ds_read_b64_tr_b16 a[210:211], v1 offset:20992
    v_pk_mul_f16 v223, v223, v222
    v_pk_mul_f16 v225, v225, v224
    v_exp_f16_e64 v222, v223
    v_mfma_f32_32x32x16_bf16 v[188:203], a[188:191], a[20:23], v[188:203]
    ds_read_b64_tr_b16 a[244:245], v3 offset:43008
    ds_read_b64_tr_b16 a[212:213], v1 offset:22528
    v_exp_f16 v224, v225
    v_exp_f16_sdwa v222, v223 dst_sel:WORD_1 dst_unused:UNUSED_PRESERVE src0_sel:WORD_1
    v_exp_f16_sdwa v224, v225 dst_sel:WORD_1 dst_unused:UNUSED_PRESERVE src0_sel:WORD_1
    v_mfma_f32_32x32x16_bf16 v[188:203], a[192:195], a[24:27], v[188:203]
    s_waitcnt lgkmcnt(4)
    ds_read_b64_tr_b16 a[246:247], v3 offset:46080
    ds_read_b128 a[220:223], v9 offset:27648
    v_pk_fma_f16 v222, v222, s101, s101
    v_pk_fma_f16 v224, v224, s101, s101
    v_rcp_f16 v223, v222
    v_mfma_f32_32x32x16_bf16 v[188:203], a[196:199], a[28:31], v[188:203]
    ds_read_b64_tr_b16 a[248:249], v4 offset:43008
    ds_read_b64_tr_b16 a[250:251], v4 offset:46080
    v_rcp_f16 v225, v224
    v_rcp_f16_sdwa v222, v222 dst_sel:WORD_0 dst_unused:UNUSED_PAD src0_sel:WORD_1
    v_rcp_f16_sdwa v224, v224 dst_sel:WORD_0 dst_unused:UNUSED_PAD src0_sel:WORD_1
    v_mfma_f32_32x32x16_bf16 v[188:203], a[200:203], a[32:35], v[188:203]
    ds_read_b64_tr_b16 a[252:253], v5 offset:43008
    ds_read_b64_tr_b16 a[254:255], v5 offset:46080
    v_fma_mix_f32 v223, v184, v223, 0 op_sel_hi:[0,1,0]
    v_fma_mix_f32 v225, v186, v225, 0 op_sel_hi:[0,1,0]
    v_fma_mix_f32 v222, v185, v222, 0 op_sel_hi:[0,1,0]
    v_fma_mix_f32 v224, v187, v224, 0 op_sel_hi:[0,1,0]
    v_cvt_pk_bf16_f32 v214, v223, v222
    v_mfma_f32_32x32x16_bf16 v[188:203], a[204:207], a[36:39], v[188:203]
    s_waitcnt lgkmcnt(4)
    ds_read_b128 a[224:227], v9 offset:31744
    ds_read_b128 a[228:231], v9 offset:35840
    v_cvt_pk_bf16_f32 v215, v225, v224
    v_cvt_pk_f16_f32 v218, v204, v205
    v_cvt_pk_f16_f32 v220, v206, v207
    v_pk_fma_f16 v219, v218, v218, s36
    v_pk_fma_f16 v221, v220, v220, s36
    v_mfma_f32_32x32x16_bf16 v[188:203], a[208:211], a[40:43], v[188:203]
    ds_write_b128 v10, v[212:215] offset:9216
    v_pk_mul_f16 v219, v219, v218
    v_pk_mul_f16 v221, v221, v220
    v_mfma_f32_32x32x16_bf16 v[188:203], a[212:215], a[44:47], v[188:203]
    v_exp_f16 v218, v219
    v_exp_f16 v220, v221
    v_exp_f16_sdwa v218, v219 dst_sel:WORD_1 dst_unused:UNUSED_PRESERVE src0_sel:WORD_1
    v_mfma_f32_32x32x16_bf16 v[16:31], a[244:247], a[220:223], v[16:31]
    s_waitcnt lgkmcnt(1)
    v_exp_f16_sdwa v220, v221 dst_sel:WORD_1 dst_unused:UNUSED_PRESERVE src0_sel:WORD_1
    v_pk_fma_f16 v218, v218, s101, s101
    v_pk_fma_f16 v220, v220, s101, s101
    v_rcp_f16_e64 v219, v218
    v_rcp_f16_e64 v221, v220
    v_mfma_f32_32x32x16_bf16 v[32:47], a[248:251], a[220:223], v[32:47]
    v_rcp_f16_sdwa v218, v218 dst_sel:WORD_0 dst_unused:UNUSED_PAD src0_sel:WORD_1
    v_rcp_f16_sdwa v220, v220 dst_sel:WORD_0 dst_unused:UNUSED_PAD src0_sel:WORD_1
    v_fma_mix_f32 v219, v204, v219, 0 op_sel_hi:[0,1,0]
    v_fma_mix_f32 v221, v206, v221, 0 op_sel_hi:[0,1,0]
    v_fma_mix_f32 v218, v205, v218, 0 op_sel_hi:[0,1,0]
    v_mfma_f32_32x32x16_bf16 v[48:63], a[252:255], a[220:223], v[48:63]
    v_fma_mix_f32 v220, v207, v220, 0 op_sel_hi:[0,1,0]
    v_cvt_pk_bf16_f32 v216, v219, v218
    v_cvt_pk_bf16_f32 v217, v221, v220
    v_cvt_pk_f16_f32 v218, v188, v189
    v_cvt_pk_f16_f32 v220, v190, v191
    v_pk_fma_f16 v219, v218, v218, s36
    v_pk_fma_f16 v221, v220, v220, s36
    v_mfma_f32_32x32x16_bf16 v[96:111], a[252:255], a[224:227], v[96:111]
    v_pk_mul_f16 v219, v219, v218
    v_pk_mul_f16 v221, v221, v220
    v_exp_f16_e64 v218, v219
    v_exp_f16_e64 v220, v221
    v_mfma_f32_32x32x16_bf16 v[80:95], a[248:251], a[224:227], v[80:95]
    v_exp_f16_sdwa v218, v219 dst_sel:WORD_1 dst_unused:UNUSED_PRESERVE src0_sel:WORD_1
    v_exp_f16_sdwa v220, v221 dst_sel:WORD_1 dst_unused:UNUSED_PRESERVE src0_sel:WORD_1
    v_pk_fma_f16 v218, v218, s101, s101
    v_pk_fma_f16 v220, v220, s101, s101
    v_rcp_f16_e64 v219, v218
    v_mfma_f32_32x32x16_bf16 v[64:79], a[244:247], a[224:227], v[64:79]
    v_rcp_f16_e64 v221, v220
    v_rcp_f16_sdwa v218, v218 dst_sel:WORD_0 dst_unused:UNUSED_PAD src0_sel:WORD_1
    v_rcp_f16_sdwa v220, v220 dst_sel:WORD_0 dst_unused:UNUSED_PAD src0_sel:WORD_1
    v_fma_mix_f32 v219, v188, v219, 0 op_sel_hi:[0,1,0]
    v_mfma_f32_32x32x16_bf16 v[112:127], a[244:247], a[228:231], v[112:127]
    s_add_u32 s39, s39, 128
    v_fma_mix_f32 v221, v190, v221, 0 op_sel_hi:[0,1,0]
    v_fma_mix_f32 v218, v189, v218, 0 op_sel_hi:[0,1,0]
    v_fma_mix_f32 v220, v191, v220, 0 op_sel_hi:[0,1,0]
    v_cvt_pk_bf16_f32 v208, v219, v218
    v_cvt_pk_bf16_f32 v209, v221, v220
    v_cvt_pk_f16_f32 v222, v192, v193
    v_cvt_pk_f16_f32 v224, v194, v195
    v_mfma_f32_32x32x16_bf16 v[128:143], a[248:251], a[228:231], v[128:143]
    s_add_u32 s100, s100, 128
    v_pk_fma_f16 v223, v222, v222, s36
    v_pk_fma_f16 v225, v224, v224, s36
    v_pk_mul_f16 v223, v223, v222
    v_pk_mul_f16 v225, v225, v224
    v_exp_f16_e64 v222, v223
    v_mfma_f32_32x32x16_bf16 v[144:159], a[252:255], a[228:231], v[144:159]
    s_add_u32 s40, s40, 24576
    v_exp_f16_e64 v224, v225
    v_exp_f16_sdwa v222, v223 dst_sel:WORD_1 dst_unused:UNUSED_PRESERVE src0_sel:WORD_1
    v_exp_f16_sdwa v224, v225 dst_sel:WORD_1 dst_unused:UNUSED_PRESERVE src0_sel:WORD_1
    v_pk_fma_f16 v222, v222, s101, s101
    s_waitcnt vmcnt(0) lgkmcnt(0)
    s_barrier
    v_mfma_f32_32x32x16_bf16 v[172:187], a[168:171], a[48:51], 0
    ds_read_b64_tr_b16 a[232:233], v3 offset:0
    v_pk_fma_f16 v224, v224, s101, s101
    v_rcp_f16_e64 v223, v222
    v_rcp_f16_e64 v225, v224
    v_rcp_f16_sdwa v222, v222 dst_sel:WORD_0 dst_unused:UNUSED_PAD src0_sel:WORD_1
    v_mfma_f32_32x32x16_bf16 v[172:187], a[172:175], a[52:55], v[172:187]
    s_add_u32 m0, s41, 101888
    ds_write_b64 v12, v[216:217] offset:2048
    buffer_load_dwordx4 v13, s[8:11], s39 offen offset:0  lds
    v_rcp_f16_sdwa v224, v224 dst_sel:WORD_0 dst_unused:UNUSED_PAD src0_sel:WORD_1
    v_mfma_f32_32x32x16_bf16 v[172:187], a[176:179], a[56:59], v[172:187]
    v_fma_mix_f32 v223, v192, v223, 0 op_sel_hi:[0,1,0]
    v_fma_mix_f32 v225, v194, v225, 0 op_sel_hi:[0,1,0]
    v_fma_mix_f32 v222, v193, v222, 0 op_sel_hi:[0,1,0]
    v_fma_mix_f32 v224, v195, v224, 0 op_sel_hi:[0,1,0]
    v_cvt_pk_bf16_f32 v210, v223, v222
    v_cvt_pk_bf16_f32 v211, v225, v224
    v_cvt_pk_f16_f32 v218, v196, v197
    v_mfma_f32_32x32x16_bf16 v[172:187], a[180:183], a[60:63], v[172:187]
    ds_write_b128 v10, v[208:211] offset:24576
    v_cvt_pk_f16_f32 v220, v198, v199
    v_pk_fma_f16 v219, v218, v218, s36
    v_mfma_f32_32x32x16_bf16 v[172:187], a[184:187], a[64:67], v[172:187]
    v_pk_fma_f16 v221, v220, v220, s36
    v_pk_mul_f16 v219, v219, v218
    v_pk_mul_f16 v221, v221, v220
    v_exp_f16_e64 v218, v219
    v_exp_f16_e64 v220, v221
    v_mfma_f32_32x32x16_bf16 v[172:187], a[188:191], a[68:71], v[172:187]
    v_exp_f16_sdwa v218, v219 dst_sel:WORD_1 dst_unused:UNUSED_PRESERVE src0_sel:WORD_1
    v_exp_f16_sdwa v220, v221 dst_sel:WORD_1 dst_unused:UNUSED_PRESERVE src0_sel:WORD_1
    v_pk_fma_f16 v218, v218, s101, s101
    v_pk_fma_f16 v220, v220, s101, s101
    v_mfma_f32_32x32x16_bf16 v[172:187], a[192:195], a[72:75], v[172:187]
    ds_read_b64_tr_b16 a[234:235], v3 offset:3072
    ds_read_b128 a[216:219], v9 offset:0
    v_rcp_f16_e64 v219, v218
    v_rcp_f16_e64 v221, v220
    v_rcp_f16_sdwa v218, v218 dst_sel:WORD_0 dst_unused:UNUSED_PAD src0_sel:WORD_1
    v_mfma_f32_32x32x16_bf16 v[172:187], a[196:199], a[76:79], v[172:187]
    ds_read_b64_tr_b16 a[236:237], v4 offset:0
    ds_read_b64_tr_b16 a[238:239], v4 offset:3072
    v_rcp_f16_sdwa v220, v220 dst_sel:WORD_0 dst_unused:UNUSED_PAD src0_sel:WORD_1
    v_fma_mix_f32 v219, v196, v219, 0 op_sel_hi:[0,1,0]
    v_fma_mix_f32 v221, v198, v221, 0 op_sel_hi:[0,1,0]
    v_fma_mix_f32 v218, v197, v218, 0 op_sel_hi:[0,1,0]
    v_mfma_f32_32x32x16_bf16 v[172:187], a[200:203], a[80:83], v[172:187]
    ds_read_b64_tr_b16 a[240:241], v5 offset:0
    ds_read_b64_tr_b16 a[242:243], v5 offset:3072
    v_fma_mix_f32 v220, v199, v220, 0 op_sel_hi:[0,1,0]
    v_cvt_pk_bf16_f32 v212, v219, v218
    v_cvt_pk_bf16_f32 v213, v221, v220
    v_cvt_pk_f16_f32 v222, v200, v201
    v_cvt_pk_f16_f32 v224, v202, v203
    v_mfma_f32_32x32x16_bf16 v[172:187], a[204:207], a[84:87], v[172:187]
    buffer_load_dwordx4 v14, s[8:11], s39 offen offset:1024  lds
    ds_read_b128 a[220:223], v9 offset:4096
    v_pk_fma_f16 v223, v222, v222, s36
    v_pk_fma_f16 v225, v224, v224, s36
    v_pk_mul_f16 v223, v223, v222
    v_pk_mul_f16 v225, v225, v224
    v_mfma_f32_32x32x16_bf16 v[172:187], a[208:211], a[88:91], v[172:187]
    v_exp_f16 v222, v223
    v_exp_f16_e64 v224, v225
    v_exp_f16_sdwa v222, v223 dst_sel:WORD_1 dst_unused:UNUSED_PRESERVE src0_sel:WORD_1
    v_mfma_f32_32x32x16_bf16 v[172:187], a[212:215], a[92:95], v[172:187]
    s_waitcnt lgkmcnt(1)
    buffer_load_dwordx4 v254, s[8:11], s39 offen offset:2048  lds
    v_exp_f16_sdwa v224, v225 dst_sel:WORD_1 dst_unused:UNUSED_PRESERVE src0_sel:WORD_1
    v_pk_fma_f16 v222, v222, s101, s101
    v_pk_fma_f16 v224, v224, s101, s101
    v_rcp_f16_e64 v223, v222
    v_mfma_f32_32x32x16_bf16 v[16:31], a[232:235], a[216:219], v[16:31]
    ds_read_b128 a[224:227], v9 offset:8192
    v_rcp_f16_e64 v225, v224
    v_rcp_f16_sdwa v222, v222 dst_sel:WORD_0 dst_unused:UNUSED_PAD src0_sel:WORD_1
    v_rcp_f16_sdwa v224, v224 dst_sel:WORD_0 dst_unused:UNUSED_PAD src0_sel:WORD_1
    v_mfma_f32_32x32x16_bf16 v[32:47], a[236:239], a[216:219], v[32:47]
    v_fma_mix_f32 v223, v200, v223, 0 op_sel_hi:[0,1,0]
    v_fma_mix_f32 v225, v202, v225, 0 op_sel_hi:[0,1,0]
    v_fma_mix_f32 v222, v201, v222, 0 op_sel_hi:[0,1,0]
    v_fma_mix_f32 v224, v203, v224, 0 op_sel_hi:[0,1,0]
    v_cvt_pk_bf16_f32 v214, v223, v222
    v_cvt_pk_bf16_f32 v215, v225, v224
    v_cvt_pk_f16_f32 v218, v172, v173
    v_mfma_f32_32x32x16_bf16 v[48:63], a[240:243], a[216:219], v[48:63]
    s_waitcnt lgkmcnt(1)
    ds_write_b128 v10, v[212:215] offset:25600
    v_cvt_pk_f16_f32 v220, v174, v175
    v_pk_fma_f16 v219, v218, v218, s36
    v_mfma_f32_32x32x16_bf16 v[96:111], a[240:243], a[220:223], v[96:111]
    v_pk_fma_f16 v221, v220, v220, s36
    v_pk_mul_f16 v219, v219, v218
    v_pk_mul_f16 v221, v221, v220
    v_exp_f16 v218, v219
    v_exp_f16 v220, v221
    v_mfma_f32_32x32x16_bf16 v[80:95], a[236:239], a[220:223], v[80:95]
    v_exp_f16_sdwa v218, v219 dst_sel:WORD_1 dst_unused:UNUSED_PRESERVE src0_sel:WORD_1
    v_exp_f16_sdwa v220, v221 dst_sel:WORD_1 dst_unused:UNUSED_PRESERVE src0_sel:WORD_1
    v_pk_fma_f16 v218, v218, s101, s101
    v_pk_fma_f16 v220, v220, s101, s101
    v_mfma_f32_32x32x16_bf16 v[64:79], a[232:235], a[220:223], v[64:79]
    s_waitcnt lgkmcnt(1)
    buffer_load_dwordx4 v255, s[8:11], s39 offen offset:3072  lds
    v_rcp_f16 v219, v218
    v_rcp_f16 v221, v220
    v_rcp_f16_sdwa v218, v218 dst_sel:WORD_0 dst_unused:UNUSED_PAD src0_sel:WORD_1
    v_mfma_f32_32x32x16_bf16 v[112:127], a[232:235], a[224:227], v[112:127]
    v_rcp_f16_sdwa v220, v220 dst_sel:WORD_0 dst_unused:UNUSED_PAD src0_sel:WORD_1
    v_fma_mix_f32 v219, v172, v219, 0 op_sel_hi:[0,1,0]
    v_fma_mix_f32 v221, v174, v221, 0 op_sel_hi:[0,1,0]
    v_fma_mix_f32 v218, v173, v218, 0 op_sel_hi:[0,1,0]
    v_fma_mix_f32 v220, v175, v220, 0 op_sel_hi:[0,1,0]
    v_cvt_pk_bf16_f32 v208, v219, v218
    v_mfma_f32_32x32x16_bf16 v[128:143], a[236:239], a[224:227], v[128:143]
    v_cvt_pk_bf16_f32 v209, v221, v220
    v_cvt_pk_f16_f32 v222, v176, v177
    v_cvt_pk_f16_f32 v224, v178, v179
    v_pk_fma_f16 v223, v222, v222, s36
    v_pk_fma_f16 v225, v224, v224, s36
    v_pk_mul_f16 v223, v223, v222
    v_pk_mul_f16 v225, v225, v224
    v_mfma_f32_32x32x16_bf16 v[144:159], a[240:243], a[224:227], v[144:159]
    v_exp_f16 v222, v223
    v_exp_f16 v224, v225
    v_exp_f16_sdwa v222, v223 dst_sel:WORD_1 dst_unused:UNUSED_PRESERVE src0_sel:WORD_1
    v_mfma_f32_32x32x16_bf16 v[188:203], a[168:171], a[96:99], 0
    s_add_u32 m0, s41, 105984
    ds_read_b64_tr_b16 a[168:169], v1 offset:24576
    v_exp_f16_sdwa v224, v225 dst_sel:WORD_1 dst_unused:UNUSED_PRESERVE src0_sel:WORD_1
    v_pk_fma_f16 v222, v222, s101, s101
    v_pk_fma_f16 v224, v224, s101, s101
    v_rcp_f16 v223, v222
    v_mfma_f32_32x32x16_bf16 v[188:203], a[172:175], a[100:103], v[188:203]
    buffer_load_dwordx4 v13, s[8:11], s100 offen offset:0  lds
    v_rcp_f16 v225, v224
    v_rcp_f16_sdwa v222, v222 dst_sel:WORD_0 dst_unused:UNUSED_PAD src0_sel:WORD_1
    v_rcp_f16_sdwa v224, v224 dst_sel:WORD_0 dst_unused:UNUSED_PAD src0_sel:WORD_1
    v_mfma_f32_32x32x16_bf16 v[188:203], a[176:179], a[104:107], v[188:203]
    ds_read_b64_tr_b16 a[244:245], v3 offset:6144
    ds_read_b64_tr_b16 a[246:247], v3 offset:9216
    v_fma_mix_f32 v223, v176, v223, 0 op_sel_hi:[0,1,0]
    v_fma_mix_f32 v225, v178, v225, 0 op_sel_hi:[0,1,0]
    v_fma_mix_f32 v222, v177, v222, 0 op_sel_hi:[0,1,0]
    v_fma_mix_f32 v224, v179, v224, 0 op_sel_hi:[0,1,0]
    v_cvt_pk_bf16_f32 v210, v223, v222
    v_mfma_f32_32x32x16_bf16 v[188:203], a[180:183], a[108:111], v[188:203]
    ds_read_b128 a[228:231], v9 offset:1024
    ds_read_b64_tr_b16 a[248:249], v4 offset:6144
    v_cvt_pk_bf16_f32 v211, v225, v224
    v_cvt_pk_f16_f32 v218, v180, v181
    v_cvt_pk_f16_f32 v220, v182, v183
    v_pk_fma_f16 v219, v218, v218, s36
    v_pk_fma_f16 v221, v220, v220, s36
    v_mfma_f32_32x32x16_bf16 v[188:203], a[184:187], a[112:115], v[188:203]
    ds_write_b128 v10, v[208:211] offset:28672
    v_pk_mul_f16 v219, v219, v218
    v_pk_mul_f16 v221, v221, v220
    v_mfma_f32_32x32x16_bf16 v[188:203], a[188:191], a[116:119], v[188:203]
    v_exp_f16 v218, v219
    v_exp_f16 v220, v221
    v_exp_f16_sdwa v218, v219 dst_sel:WORD_1 dst_unused:UNUSED_PRESERVE src0_sel:WORD_1
    v_mfma_f32_32x32x16_bf16 v[188:203], a[192:195], a[120:123], v[188:203]
    buffer_load_dwordx4 v14, s[8:11], s100 offen offset:1024  lds
    v_exp_f16_sdwa v220, v221 dst_sel:WORD_1 dst_unused:UNUSED_PRESERVE src0_sel:WORD_1
    v_pk_fma_f16 v218, v218, s101, s101
    v_pk_fma_f16 v220, v220, s101, s101
    v_rcp_f16_e64 v219, v218
    v_mfma_f32_32x32x16_bf16 v[188:203], a[196:199], a[124:127], v[188:203]
    ds_read_b64_tr_b16 a[250:251], v4 offset:9216
    ds_read_b64_tr_b16 a[252:253], v5 offset:6144
    v_rcp_f16_e64 v221, v220
    v_rcp_f16_sdwa v218, v218 dst_sel:WORD_0 dst_unused:UNUSED_PAD src0_sel:WORD_1
    v_mfma_f32_32x32x16_bf16 v[188:203], a[200:203], a[128:131], v[188:203]
    ds_read_b64_tr_b16 a[254:255], v5 offset:9216
    ds_read_b64_tr_b16 v[226:227], v2 offset:24576
    v_rcp_f16_sdwa v220, v220 dst_sel:WORD_0 dst_unused:UNUSED_PAD src0_sel:WORD_1
    v_fma_mix_f32 v219, v180, v219, 0 op_sel_hi:[0,1,0]
    v_fma_mix_f32 v221, v182, v221, 0 op_sel_hi:[0,1,0]
    v_fma_mix_f32 v218, v181, v218, 0 op_sel_hi:[0,1,0]
    v_mfma_f32_32x32x16_bf16 v[188:203], a[204:207], a[132:135], v[188:203]
    ds_read_b64_tr_b16 v[228:229], v2 offset:25088
    ds_read_b128 a[216:219], v9 offset:5120
    v_fma_mix_f32 v220, v183, v220, 0 op_sel_hi:[0,1,0]
    v_cvt_pk_bf16_f32 v212, v219, v218
    v_cvt_pk_bf16_f32 v213, v221, v220
    v_cvt_pk_f16_f32 v222, v184, v185
    v_cvt_pk_f16_f32 v224, v186, v187
    v_mfma_f32_32x32x16_bf16 v[188:203], a[208:211], a[136:139], v[188:203]
    s_add_u32 m0, s41, 24576
    ds_read_b64_tr_b16 a[170:171], v1 offset:25088
    ds_read_b64_tr_b16 a[184:185], v1 offset:32768
    v_pk_fma_f16 v223, v222, v222, s36
    v_pk_fma_f16 v225, v224, v224, s36
    v_pk_mul_f16 v223, v223, v222
    v_pk_mul_f16 v225, v225, v224
    v_exp_f16 v222, v223
    v_mfma_f32_32x32x16_bf16 v[188:203], a[212:215], a[140:143], v[188:203]
    s_waitcnt lgkmcnt(4)
    ds_read_b64_tr_b16 v[230:231], v2 offset:28672
    ds_read_b64_tr_b16 v[232:233], v2 offset:29184
    ds_read_b64_tr_b16 a[214:215], v1 offset:47616
    v_exp_f16_e64 v224, v225
    v_exp_f16_sdwa v222, v223 dst_sel:WORD_1 dst_unused:UNUSED_PRESERVE src0_sel:WORD_1
    v_mfma_f32_32x32x16_bf16 v[16:31], a[244:247], a[228:231], v[16:31]
    buffer_load_dwordx4 v15, s[12:15], s40 offen offset:0  lds
    v_exp_f16_sdwa v224, v225 dst_sel:WORD_1 dst_unused:UNUSED_PRESERVE src0_sel:WORD_1
    v_pk_fma_f16 v222, v222, s101, s101
    v_pk_fma_f16 v224, v224, s101, s101
    v_mfma_f32_32x32x16_bf16 v[32:47], a[248:251], a[228:231], v[32:47]
    ds_read_b128 a[220:223], v9 offset:9216
    ds_read_b64_tr_b16 a[232:233], v3 offset:12288
    v_rcp_f16_e64 v223, v222
    v_rcp_f16 v225, v224
    v_rcp_f16_sdwa v222, v222 dst_sel:WORD_0 dst_unused:UNUSED_PAD src0_sel:WORD_1
    v_mfma_f32_32x32x16_bf16 v[48:63], a[252:255], a[228:231], v[48:63]
    s_waitcnt lgkmcnt(3)
    ds_read_b64_tr_b16 a[234:235], v3 offset:15360
    ds_read_b128 a[224:227], v9 offset:2048
    v_rcp_f16_sdwa v224, v224 dst_sel:WORD_0 dst_unused:UNUSED_PAD src0_sel:WORD_1
    v_fma_mix_f32 v223, v184, v223, 0 op_sel_hi:[0,1,0]
    v_fma_mix_f32 v225, v186, v225, 0 op_sel_hi:[0,1,0]
    v_fma_mix_f32 v222, v185, v222, 0 op_sel_hi:[0,1,0]
    v_mfma_f32_16x16x32_bf16 v[204:207], v[226:229], a[144:147], 0
    ds_read_b64_tr_b16 v[226:227], v2 offset:32768
    ds_read_b64_tr_b16 v[228:229], v2 offset:33280
    ds_read_b64_tr_b16 a[236:237], v4 offset:12288
    ds_read_b64_tr_b16 a[238:239], v4 offset:15360
    v_mfma_f32_32x32x16_bf16 v[96:111], a[252:255], a[216:219], v[96:111]
    ds_read_b64_tr_b16 a[240:241], v5 offset:12288
    ds_read_b64_tr_b16 a[242:243], v5 offset:15360
    v_fma_mix_f32 v224, v187, v224, 0 op_sel_hi:[0,1,0]
    v_cvt_pk_bf16_f32 v214, v223, v222
    v_cvt_pk_bf16_f32 v215, v225, v224
    v_cvt_pk_f16_f32 v218, v188, v189
    v_cvt_pk_f16_f32 v220, v190, v191
    v_mfma_f32_32x32x16_bf16 v[80:95], a[248:251], a[216:219], v[80:95]
    ds_write_b128 v10, v[212:215] offset:29696
    buffer_load_dwordx4 v15, s[12:15], s40 offen offset:3072  lds
    v_mfma_f32_16x16x32_bf16 v[204:207], v[230:233], a[148:151], v[204:207]
    s_nop 0
    ds_read_b64_tr_b16 v[230:231], v2 offset:36864
    v_pk_fma_f16 v219, v218, v218, s36
    v_mfma_f32_32x32x16_bf16 v[64:79], a[244:247], a[216:219], v[64:79]
    s_waitcnt lgkmcnt(6)
    v_pk_fma_f16 v221, v220, v220, s36
    v_pk_mul_f16 v219, v219, v218
    v_pk_mul_f16 v221, v221, v220
    v_exp_f16 v218, v219
    v_exp_f16 v220, v221
    v_mfma_f32_32x32x16_bf16 v[112:127], a[244:247], a[220:223], v[112:127]
    v_exp_f16_sdwa v218, v219 dst_sel:WORD_1 dst_unused:UNUSED_PRESERVE src0_sel:WORD_1
    v_exp_f16_sdwa v220, v221 dst_sel:WORD_1 dst_unused:UNUSED_PRESERVE src0_sel:WORD_1
    v_pk_fma_f16 v218, v218, s101, s101
    v_pk_fma_f16 v220, v220, s101, s101
    v_mfma_f32_16x16x32_bf16 v[204:207], v[226:229], a[152:155], v[204:207]
    ds_read_b64_tr_b16 v[226:227], v2 offset:40960
    ds_read_b64_tr_b16 v[228:229], v2 offset:41472
    v_mfma_f32_32x32x16_bf16 v[128:143], a[248:251], a[220:223], v[128:143]
    s_add_u32 m0, s41, 25600
    ds_read_b64_tr_b16 v[232:233], v2 offset:37376
    ds_read_b128 a[228:231], v9 offset:6144
    v_rcp_f16 v219, v218
    v_rcp_f16 v221, v220
    v_mfma_f32_32x32x16_bf16 v[144:159], a[252:255], a[220:223], v[144:159]
    s_nop 0
    buffer_load_dwordx4 v240, s[12:15], s40 offen offset:0  lds
    v_rcp_f16_sdwa v218, v218 dst_sel:WORD_0 dst_unused:UNUSED_PAD src0_sel:WORD_1
    v_rcp_f16_sdwa v220, v220 dst_sel:WORD_0 dst_unused:UNUSED_PAD src0_sel:WORD_1
    v_fma_mix_f32 v219, v188, v219, 0 op_sel_hi:[0,1,0]
    v_mfma_f32_32x32x16_bf16 v[16:31], a[232:235], a[224:227], v[16:31]
    s_waitcnt lgkmcnt(1)
    ds_read_b64_tr_b16 a[172:173], v1 offset:26624
    ds_read_b64_tr_b16 a[186:187], v1 offset:33280
    v_fma_mix_f32 v221, v190, v221, 0 op_sel_hi:[0,1,0]
    v_fma_mix_f32 v218, v189, v218, 0 op_sel_hi:[0,1,0]
    v_fma_mix_f32 v220, v191, v220, 0 op_sel_hi:[0,1,0]
    v_cvt_pk_bf16_f32 v208, v219, v218
    v_cvt_pk_bf16_f32 v209, v221, v220
    v_mfma_f32_16x16x32_bf16 v[204:207], v[230:233], a[156:159], v[204:207]
    ds_read_b64_tr_b16 v[230:231], v2 offset:45056
    ds_read_b64_tr_b16 v[232:233], v2 offset:45568
    v_cvt_pk_f16_f32 v222, v192, v193
    v_mfma_f32_32x32x16_bf16 v[32:47], a[236:239], a[224:227], v[32:47]
    ds_read_b128 a[216:219], v9 offset:10240
    ds_read_b64_tr_b16 a[188:189], v1 offset:34816
    v_cvt_pk_f16_f32 v224, v194, v195
    v_pk_fma_f16 v223, v222, v222, s36
    v_pk_fma_f16 v225, v224, v224, s36
    v_pk_mul_f16 v223, v223, v222
    v_pk_mul_f16 v225, v225, v224
    v_mfma_f32_32x32x16_bf16 v[48:63], a[240:243], a[224:227], v[48:63]
    buffer_load_dwordx4 v240, s[12:15], s40 offen offset:3072  lds
    v_exp_f16 v222, v223
    v_exp_f16_e64 v224, v225
    v_exp_f16_sdwa v222, v223 dst_sel:WORD_1 dst_unused:UNUSED_PRESERVE src0_sel:WORD_1
    v_mfma_f32_16x16x32_bf16 v[204:207], v[226:229], a[160:163], v[204:207]
    s_waitcnt lgkmcnt(2)
    ds_read_b64_tr_b16 a[174:175], v1 offset:27136
    ds_read_b64_tr_b16 a[190:191], v1 offset:35328
    v_mfma_f32_32x32x16_bf16 v[96:111], a[240:243], a[228:231], v[96:111]
    ds_read_b64_tr_b16 a[176:177], v1 offset:28672
    ds_read_b64_tr_b16 a[192:193], v1 offset:36864
    v_exp_f16_sdwa v224, v225 dst_sel:WORD_1 dst_unused:UNUSED_PRESERVE src0_sel:WORD_1
    v_pk_fma_f16 v222, v222, s101, s101
    v_pk_fma_f16 v224, v224, s101, s101
    v_mfma_f32_32x32x16_bf16 v[80:95], a[236:239], a[228:231], v[80:95]
    ds_read_b64_tr_b16 a[178:179], v1 offset:29184
    ds_read_b64_tr_b16 a[194:195], v1 offset:37376
    v_rcp_f16 v223, v222
    v_rcp_f16 v225, v224
    v_rcp_f16_sdwa v222, v222 dst_sel:WORD_0 dst_unused:UNUSED_PAD src0_sel:WORD_1
    v_mfma_f32_16x16x32_bf16 v[204:207], v[230:233], a[164:167], v[204:207]
    s_add_u32 m0, s41, 26624
    ds_read_b64_tr_b16 a[180:181], v1 offset:30720
    ds_read_b64_tr_b16 a[198:199], v1 offset:39424
    v_mfma_f32_32x32x16_bf16 v[64:79], a[232:235], a[228:231], v[64:79]
    s_waitcnt lgkmcnt(7)
    buffer_load_dwordx4 v241, s[12:15], s40 offen offset:0  lds
    v_rcp_f16_sdwa v224, v224 dst_sel:WORD_0 dst_unused:UNUSED_PAD src0_sel:WORD_1
    v_fma_mix_f32 v223, v192, v223, 0 op_sel_hi:[0,1,0]
    v_fma_mix_f32 v225, v194, v225, 0 op_sel_hi:[0,1,0]
    v_fma_mix_f32 v222, v193, v222, 0 op_sel_hi:[0,1,0]
    v_mfma_f32_32x32x16_bf16 v[112:127], a[232:235], a[216:219], v[112:127]
    s_nop 0
    ds_read_b64_tr_b16 a[182:183], v1 offset:31232
    ds_read_b64_tr_b16 a[200:201], v1 offset:40960
    v_fma_mix_f32 v224, v195, v224, 0 op_sel_hi:[0,1,0]
    v_cvt_pk_bf16_f32 v210, v223, v222
    v_cvt_pk_bf16_f32 v211, v225, v224
    v_cvt_pk_f16_f32 v218, v196, v197
    v_cvt_pk_f16_f32 v220, v198, v199
    v_mfma_f32_32x32x16_bf16 v[128:143], a[236:239], a[216:219], v[128:143]
    ds_write_b128 v10, v[208:211] offset:32768
    v_pk_fma_f16 v219, v218, v218, s36
    v_pk_fma_f16 v221, v220, v220, s36
    v_mfma_f32_32x32x16_bf16 v[144:159], a[240:243], a[216:219], v[144:159]
    v_pk_mul_f16 v219, v219, v218
    v_pk_mul_f16 v221, v221, v220
    v_exp_f16 v218, v219
    v_exp_f16 v220, v221
    v_exp_f16_sdwa v218, v219 dst_sel:WORD_1 dst_unused:UNUSED_PRESERVE src0_sel:WORD_1
    v_mfma_f32_32x32x16_bf16 v[172:187], a[168:171], a[0:3], 0
    v_exp_f16_sdwa v220, v221 dst_sel:WORD_1 dst_unused:UNUSED_PRESERVE src0_sel:WORD_1
    v_pk_fma_f16 v218, v218, s101, s101
    v_pk_fma_f16 v220, v220, s101, s101
    v_rcp_f16 v219, v218
    v_mfma_f32_32x32x16_bf16 v[172:187], a[172:175], a[4:7], v[172:187]
    s_waitcnt lgkmcnt(2)
    ds_read_b64_tr_b16 a[196:197], v1 offset:38912
    ds_read_b64_tr_b16 a[202:203], v1 offset:41472
    v_rcp_f16_e64 v221, v220
    v_rcp_f16_sdwa v218, v218 dst_sel:WORD_0 dst_unused:UNUSED_PAD src0_sel:WORD_1
    v_rcp_f16_sdwa v220, v220 dst_sel:WORD_0 dst_unused:UNUSED_PAD src0_sel:WORD_1
    v_mfma_f32_32x32x16_bf16 v[172:187], a[176:179], a[8:11], v[172:187]
    buffer_load_dwordx4 v241, s[12:15], s40 offen offset:3072  lds
    v_fma_mix_f32 v219, v196, v219, 0 op_sel_hi:[0,1,0]
    v_fma_mix_f32 v221, v198, v221, 0 op_sel_hi:[0,1,0]
    v_fma_mix_f32 v218, v197, v218, 0 op_sel_hi:[0,1,0]
    v_fma_mix_f32 v220, v199, v220, 0 op_sel_hi:[0,1,0]
    v_cvt_pk_bf16_f32 v212, v219, v218
    v_mfma_f32_32x32x16_bf16 v[172:187], a[180:183], a[12:15], v[172:187]
    ds_read_b64_tr_b16 a[204:205], v1 offset:43008
    ds_read_b64_tr_b16 a[206:207], v1 offset:43520
    v_cvt_pk_bf16_f32 v213, v221, v220
    v_cvt_pk_f16_f32 v222, v200, v201
    v_cvt_pk_f16_f32 v224, v202, v203
    v_pk_fma_f16 v223, v222, v222, s36
    v_pk_fma_f16 v225, v224, v224, s36
    v_mfma_f32_32x32x16_bf16 v[172:187], a[184:187], a[16:19], v[172:187]
L_pg8:
    s_cbranch_execz L_wu1
    ds_read_b64_tr_b16 a[208:209], v1 offset:45056
    ds_read_b64_tr_b16 a[210:211], v1 offset:45568
    v_pk_mul_f16 v223, v223, v222
    v_pk_mul_f16 v225, v225, v224
    v_exp_f16 v222, v223
    v_mfma_f32_32x32x16_bf16 v[172:187], a[188:191], a[20:23], v[172:187]
    ds_read_b64_tr_b16 a[244:245], v3 offset:18432
    ds_read_b64_tr_b16 a[212:213], v1 offset:47104
    v_exp_f16 v224, v225
    v_exp_f16_sdwa v222, v223 dst_sel:WORD_1 dst_unused:UNUSED_PRESERVE src0_sel:WORD_1
    v_exp_f16_sdwa v224, v225 dst_sel:WORD_1 dst_unused:UNUSED_PRESERVE src0_sel:WORD_1
    v_mfma_f32_32x32x16_bf16 v[172:187], a[192:195], a[24:27], v[172:187]
    s_waitcnt lgkmcnt(4)
    ds_read_b64_tr_b16 a[246:247], v3 offset:21504
    ds_read_b128 a[220:223], v9 offset:3072
    v_pk_fma_f16 v222, v222, s101, s101
    v_pk_fma_f16 v224, v224, s101, s101
    v_rcp_f16 v223, v222
    v_mfma_f32_32x32x16_bf16 v[172:187], a[196:199], a[28:31], v[172:187]
    ds_read_b64_tr_b16 a[248:249], v4 offset:18432
    ds_read_b64_tr_b16 a[250:251], v4 offset:21504
    v_rcp_f16 v225, v224
    v_rcp_f16_sdwa v222, v222 dst_sel:WORD_0 dst_unused:UNUSED_PAD src0_sel:WORD_1
    v_rcp_f16_sdwa v224, v224 dst_sel:WORD_0 dst_unused:UNUSED_PAD src0_sel:WORD_1
    v_mfma_f32_32x32x16_bf16 v[172:187], a[200:203], a[32:35], v[172:187]
    ds_read_b64_tr_b16 a[252:253], v5 offset:18432
    ds_read_b64_tr_b16 a[254:255], v5 offset:21504
    v_fma_mix_f32 v223, v200, v223, 0 op_sel_hi:[0,1,0]
    v_fma_mix_f32 v225, v202, v225, 0 op_sel_hi:[0,1,0]
    v_fma_mix_f32 v222, v201, v222, 0 op_sel_hi:[0,1,0]
    v_fma_mix_f32 v224, v203, v224, 0 op_sel_hi:[0,1,0]
    v_cvt_pk_bf16_f32 v214, v223, v222
    v_mfma_f32_32x32x16_bf16 v[172:187], a[204:207], a[36:39], v[172:187]
    s_waitcnt lgkmcnt(4)
    ds_read_b128 a[224:227], v9 offset:7168
    ds_read_b128 a[228:231], v9 offset:11264
    v_cvt_pk_bf16_f32 v215, v225, v224
    v_cvt_pk_f16_f32 v218, v204, v205
    v_cvt_pk_f16_f32 v220, v206, v207
    v_pk_fma_f16 v219, v218, v218, s36
    v_pk_fma_f16 v221, v220, v220, s36
    v_mfma_f32_32x32x16_bf16 v[172:187], a[208:211], a[40:43], v[172:187]
    ds_write_b128 v10, v[212:215] offset:33792
    v_pk_mul_f16 v219, v219, v218
    v_pk_mul_f16 v221, v221, v220
    v_mfma_f32_32x32x16_bf16 v[172:187], a[212:215], a[44:47], v[172:187]
    v_exp_f16 v218, v219
    v_exp_f16_e64 v220, v221
    v_exp_f16_sdwa v218, v219 dst_sel:WORD_1 dst_unused:UNUSED_PRESERVE src0_sel:WORD_1
    v_mfma_f32_32x32x16_bf16 v[16:31], a[244:247], a[220:223], v[16:31]
    s_waitcnt lgkmcnt(1)
    v_exp_f16_sdwa v220, v221 dst_sel:WORD_1 dst_unused:UNUSED_PRESERVE src0_sel:WORD_1
    v_pk_fma_f16 v218, v218, s101, s101
    v_pk_fma_f16 v220, v220, s101, s101
    v_rcp_f16 v219, v218
    v_rcp_f16_e64 v221, v220
    v_mfma_f32_32x32x16_bf16 v[32:47], a[248:251], a[220:223], v[32:47]
    v_rcp_f16_sdwa v218, v218 dst_sel:WORD_0 dst_unused:UNUSED_PAD src0_sel:WORD_1
    v_rcp_f16_sdwa v220, v220 dst_sel:WORD_0 dst_unused:UNUSED_PAD src0_sel:WORD_1
    v_fma_mix_f32 v219, v204, v219, 0 op_sel_hi:[0,1,0]
    v_fma_mix_f32 v221, v206, v221, 0 op_sel_hi:[0,1,0]
    v_fma_mix_f32 v218, v205, v218, 0 op_sel_hi:[0,1,0]
    v_mfma_f32_32x32x16_bf16 v[48:63], a[252:255], a[220:223], v[48:63]
    v_fma_mix_f32 v220, v207, v220, 0 op_sel_hi:[0,1,0]
    v_cvt_pk_bf16_f32 v216, v219, v218
    v_cvt_pk_bf16_f32 v217, v221, v220
    v_cvt_pk_f16_f32 v218, v172, v173
    v_cvt_pk_f16_f32 v220, v174, v175
    v_pk_fma_f16 v219, v218, v218, s36
    v_pk_fma_f16 v221, v220, v220, s36
    v_mfma_f32_32x32x16_bf16 v[96:111], a[252:255], a[224:227], v[96:111]
    v_pk_mul_f16 v219, v219, v218
    v_pk_mul_f16 v221, v221, v220
    v_exp_f16 v218, v219
    v_exp_f16 v220, v221
    v_mfma_f32_32x32x16_bf16 v[80:95], a[248:251], a[224:227], v[80:95]
    s_add_u32 s39, s39, 128
    v_exp_f16_sdwa v218, v219 dst_sel:WORD_1 dst_unused:UNUSED_PRESERVE src0_sel:WORD_1
    v_exp_f16_sdwa v220, v221 dst_sel:WORD_1 dst_unused:UNUSED_PRESERVE src0_sel:WORD_1
    v_pk_fma_f16 v218, v218, s101, s101
    v_pk_fma_f16 v220, v220, s101, s101
    v_rcp_f16_e64 v219, v218
    v_mfma_f32_32x32x16_bf16 v[64:79], a[244:247], a[224:227], v[64:79]
    s_add_u32 s100, s100, 128
    v_rcp_f16 v221, v220
    v_rcp_f16_sdwa v218, v218 dst_sel:WORD_0 dst_unused:UNUSED_PAD src0_sel:WORD_1
    v_rcp_f16_sdwa v220, v220 dst_sel:WORD_0 dst_unused:UNUSED_PAD src0_sel:WORD_1
    v_fma_mix_f32 v219, v172, v219, 0 op_sel_hi:[0,1,0]
    v_mfma_f32_32x32x16_bf16 v[112:127], a[244:247], a[228:231], v[112:127]
    s_cmp_eq_u32 s38, 2
    s_cselect_b32 s57, 294912, 0
    v_fma_mix_f32 v221, v174, v221, 0 op_sel_hi:[0,1,0]
    v_fma_mix_f32 v218, v173, v218, 0 op_sel_hi:[0,1,0]
    v_fma_mix_f32 v220, v175, v220, 0 op_sel_hi:[0,1,0]
    v_cvt_pk_bf16_f32 v208, v219, v218
    v_cvt_pk_bf16_f32 v209, v221, v220
    v_cvt_pk_f16_f32 v222, v176, v177
    v_cvt_pk_f16_f32 v224, v178, v179
    v_mfma_f32_32x32x16_bf16 v[128:143], a[248:251], a[228:231], v[128:143]
    s_sub_u32 s57, 24576, s57
    v_pk_fma_f16 v223, v222, v222, s36
    v_pk_fma_f16 v225, v224, v224, s36
    v_pk_mul_f16 v223, v223, v222
    v_pk_mul_f16 v225, v225, v224
    v_exp_f16 v222, v223
    v_mfma_f32_32x32x16_bf16 v[144:159], a[252:255], a[228:231], v[144:159]
    s_add_u32 s40, s40, s57
    v_exp_f16_e64 v224, v225
    v_exp_f16_sdwa v222, v223 dst_sel:WORD_1 dst_unused:UNUSED_PRESERVE src0_sel:WORD_1
    v_exp_f16_sdwa v224, v225 dst_sel:WORD_1 dst_unused:UNUSED_PRESERVE src0_sel:WORD_1
    v_pk_fma_f16 v222, v222, s101, s101
    s_waitcnt vmcnt(0) lgkmcnt(0)
    s_barrier
    v_mfma_f32_32x32x16_bf16 v[188:203], a[168:171], a[48:51], 0
    ds_read_b64_tr_b16 a[232:233], v3 offset:24576
    ds_read_b64_tr_b16 a[234:235], v3 offset:27648
    ds_read_b128 a[216:219], v9 offset:24576
    v_pk_fma_f16 v224, v224, s101, s101
    v_rcp_f16 v223, v222
    v_mfma_f32_32x32x16_bf16 v[188:203], a[172:175], a[52:55], v[188:203]
    s_add_u32 m0, s41, 126464
    ds_write_b64 v12, v[216:217] offset:0
    buffer_load_dwordx4 v13, s[8:11], s39 offen offset:0  lds
    v_rcp_f16 v225, v224
    v_mfma_f32_32x32x16_bf16 v[188:203], a[176:179], a[56:59], v[188:203]
    v_rcp_f16_sdwa v222, v222 dst_sel:WORD_0 dst_unused:UNUSED_PAD src0_sel:WORD_1
    v_rcp_f16_sdwa v224, v224 dst_sel:WORD_0 dst_unused:UNUSED_PAD src0_sel:WORD_1
    v_fma_mix_f32 v223, v176, v223, 0 op_sel_hi:[0,1,0]
    v_fma_mix_f32 v225, v178, v225, 0 op_sel_hi:[0,1,0]
    v_fma_mix_f32 v222, v177, v222, 0 op_sel_hi:[0,1,0]
    v_mfma_f32_32x32x16_bf16 v[188:203], a[180:183], a[60:63], v[188:203]
    ds_read_b64_tr_b16 v[226:227], v6 offset:24576
    ds_read_b64_tr_b16 v[228:229], v6 offset:30720
    ds_read_b128 v[234:237], v11 offset:2048
    v_fma_mix_f32 v224, v179, v224, 0 op_sel_hi:[0,1,0]
    v_cvt_pk_bf16_f32 v210, v223, v222
    v_cvt_pk_bf16_f32 v211, v225, v224
    v_cvt_pk_f16_f32 v218, v180, v181
    v_mfma_f32_32x32x16_bf16 v[188:203], a[184:187], a[64:67], v[188:203]
    ds_write_b128 v10, v[208:211] offset:0
    v_cvt_pk_f16_f32 v220, v182, v183
    v_pk_fma_f16 v219, v218, v218, s36
    v_mfma_f32_32x32x16_bf16 v[188:203], a[188:191], a[68:71], v[188:203]
    v_pk_fma_f16 v221, v220, v220, s36
    v_pk_mul_f16 v219, v219, v218
    v_pk_mul_f16 v221, v221, v220
    v_exp_f16_e64 v218, v219
    v_exp_f16_e64 v220, v221
    v_mfma_f32_32x32x16_bf16 v[188:203], a[192:195], a[72:75], v[188:203]
    buffer_load_dwordx4 v14, s[8:11], s39 offen offset:1024  lds
    v_exp_f16_sdwa v218, v219 dst_sel:WORD_1 dst_unused:UNUSED_PRESERVE src0_sel:WORD_1
    v_exp_f16_sdwa v220, v221 dst_sel:WORD_1 dst_unused:UNUSED_PRESERVE src0_sel:WORD_1
    v_pk_fma_f16 v218, v218, s101, s101
    v_mfma_f32_32x32x16_bf16 v[188:203], a[196:199], a[76:79], v[188:203]
    ds_read_b64_tr_b16 v[230:231], v7 offset:24576
    ds_read_b64_tr_b16 v[232:233], v7 offset:30720
    v_pk_fma_f16 v220, v220, s101, s101
    v_rcp_f16_e64 v219, v218
    v_rcp_f16 v221, v220
    v_mfma_f32_32x32x16_bf16 v[188:203], a[200:203], a[80:83], v[188:203]
    s_waitcnt lgkmcnt(3)
    ds_read_b64_tr_b16 a[236:237], v4 offset:24576
    ds_read_b64_tr_b16 a[238:239], v4 offset:27648
    v_rcp_f16_sdwa v218, v218 dst_sel:WORD_0 dst_unused:UNUSED_PAD src0_sel:WORD_1
    v_rcp_f16_sdwa v220, v220 dst_sel:WORD_0 dst_unused:UNUSED_PAD src0_sel:WORD_1
    v_fma_mix_f32 v219, v180, v219, 0 op_sel_hi:[0,1,0]
    v_mfma_f32_16x16x32_bf16 v[160:163], v[226:229], v[234:237], 0
    ds_read_b64_tr_b16 a[240:241], v5 offset:24576
    ds_read_b64_tr_b16 a[242:243], v5 offset:27648
    v_fma_mix_f32 v221, v182, v221, 0 op_sel_hi:[0,1,0]
    v_mfma_f32_32x32x16_bf16 v[188:203], a[204:207], a[84:87], v[188:203]
    ds_read_b128 a[220:223], v9 offset:28672
    v_fma_mix_f32 v218, v181, v218, 0 op_sel_hi:[0,1,0]
    v_fma_mix_f32 v220, v183, v220, 0 op_sel_hi:[0,1,0]
    v_cvt_pk_bf16_f32 v212, v219, v218
    v_cvt_pk_bf16_f32 v213, v221, v220
    v_cvt_pk_f16_f32 v222, v184, v185
    v_cvt_pk_f16_f32 v224, v186, v187
    v_mfma_f32_32x32x16_bf16 v[188:203], a[208:211], a[88:91], v[188:203]
    v_pk_fma_f16 v223, v222, v222, s36
    v_pk_fma_f16 v225, v224, v224, s36
    v_pk_mul_f16 v223, v223, v222
    v_pk_mul_f16 v225, v225, v224
    v_exp_f16 v222, v223
    v_mfma_f32_32x32x16_bf16 v[188:203], a[212:215], a[92:95], v[188:203]
    ds_read_b64_tr_b16 v[226:227], v8 offset:24576
    ds_read_b64_tr_b16 v[228:229], v8 offset:30720
    v_exp_f16_e64 v224, v225
    v_exp_f16_sdwa v222, v223 dst_sel:WORD_1 dst_unused:UNUSED_PRESERVE src0_sel:WORD_1
    v_exp_f16_sdwa v224, v225 dst_sel:WORD_1 dst_unused:UNUSED_PRESERVE src0_sel:WORD_1
    v_mfma_f32_32x32x16_bf16 v[16:31], a[232:235], a[216:219], v[16:31]
    s_waitcnt lgkmcnt(2)
    buffer_load_dwordx4 v254, s[8:11], s39 offen offset:2048  lds
    v_pk_fma_f16 v222, v222, s101, s101
    v_pk_fma_f16 v224, v224, s101, s101
    v_rcp_f16 v223, v222
    v_mfma_f32_16x16x32_bf16 v[164:167], v[230:233], v[234:237], 0
    ds_read_b128 a[224:227], v9 offset:32768
    v_rcp_f16 v225, v224
    v_mfma_f32_32x32x16_bf16 v[32:47], a[236:239], a[216:219], v[32:47]
    v_rcp_f16_sdwa v222, v222 dst_sel:WORD_0 dst_unused:UNUSED_PAD src0_sel:WORD_1
    v_rcp_f16_sdwa v224, v224 dst_sel:WORD_0 dst_unused:UNUSED_PAD src0_sel:WORD_1
    v_fma_mix_f32 v223, v184, v223, 0 op_sel_hi:[0,1,0]
    v_fma_mix_f32 v225, v186, v225, 0 op_sel_hi:[0,1,0]
    v_fma_mix_f32 v222, v185, v222, 0 op_sel_hi:[0,1,0]
    v_mfma_f32_32x32x16_bf16 v[48:63], a[240:243], a[216:219], v[48:63]
    ds_read_b64_tr_b16 v[230:231], v6 offset:36864
    ds_read_b64_tr_b16 v[232:233], v6 offset:43008
    v_fma_mix_f32 v224, v187, v224, 0 op_sel_hi:[0,1,0]
    v_cvt_pk_bf16_f32 v214, v223, v222
    v_cvt_pk_bf16_f32 v215, v225, v224
    v_cvt_pk_f16_f32 v218, v188, v189
    v_cvt_pk_f16_f32 v220, v190, v191
    v_mfma_f32_32x32x16_bf16 v[96:111], a[240:243], a[220:223], v[96:111]
    ds_write_b128 v10, v[212:215] offset:1024
    v_pk_fma_f16 v219, v218, v218, s36
    v_pk_fma_f16 v221, v220, v220, s36
    v_mfma_f32_32x32x16_bf16 v[80:95], a[236:239], a[220:223], v[80:95]
    s_waitcnt lgkmcnt(3)
    v_pk_mul_f16 v219, v219, v218
    v_pk_mul_f16 v221, v221, v220
    v_exp_f16 v218, v219
    v_exp_f16_e64 v220, v221
    v_exp_f16_sdwa v218, v219 dst_sel:WORD_1 dst_unused:UNUSED_PRESERVE src0_sel:WORD_1
    v_mfma_f32_16x16x32_bf16 v[168:171], v[226:229], v[234:237], 0
    v_exp_f16_sdwa v220, v221 dst_sel:WORD_1 dst_unused:UNUSED_PRESERVE src0_sel:WORD_1
    v_mfma_f32_32x32x16_bf16 v[64:79], a[232:235], a[220:223], v[64:79]
    v_pk_fma_f16 v218, v218, s101, s101
    v_pk_fma_f16 v220, v220, s101, s101
    v_rcp_f16 v219, v218
    v_rcp_f16 v221, v220
    v_mfma_f32_32x32x16_bf16 v[112:127], a[232:235], a[224:227], v[112:127]
    buffer_load_dwordx4 v255, s[8:11], s39 offen offset:3072  lds
    ds_read_b128 v[234:237], v11 offset:3072
    v_rcp_f16_sdwa v218, v218 dst_sel:WORD_0 dst_unused:UNUSED_PAD src0_sel:WORD_1
    v_rcp_f16_sdwa v220, v220 dst_sel:WORD_0 dst_unused:UNUSED_PAD src0_sel:WORD_1
    v_mfma_f32_32x32x16_bf16 v[128:143], a[236:239], a[224:227], v[128:143]
    s_add_u32 m0, s41, 130560
    ds_read_b64_tr_b16 v[226:227], v7 offset:36864
    ds_read_b64_tr_b16 v[228:229], v7 offset:43008
    v_fma_mix_f32 v219, v188, v219, 0 op_sel_hi:[0,1,0]
    v_fma_mix_f32 v221, v190, v221, 0 op_sel_hi:[0,1,0]
    v_fma_mix_f32 v218, v189, v218, 0 op_sel_hi:[0,1,0]
    v_fma_mix_f32 v220, v191, v220, 0 op_sel_hi:[0,1,0]
    v_cvt_pk_bf16_f32 v208, v219, v218
    v_mfma_f32_32x32x16_bf16 v[144:159], a[240:243], a[224:227], v[144:159]
    s_waitcnt lgkmcnt(2)
    buffer_load_dwordx4 v13, s[8:11], s100 offen offset:0  lds
    v_cvt_pk_bf16_f32 v209, v221, v220
    v_cvt_pk_f16_f32 v222, v192, v193
    v_cvt_pk_f16_f32 v224, v194, v195
    v_pk_fma_f16 v223, v222, v222, s36
    v_pk_fma_f16 v225, v224, v224, s36
    v_mfma_f32_16x16x32_bf16 v[160:163], v[230:233], v[234:237], v[160:163]
    v_pk_mul_f16 v223, v223, v222
    v_pk_mul_f16 v225, v225, v224
    v_mfma_f32_32x32x16_bf16 v[172:187], a[168:171], a[96:99], 0
    ds_read_b64_tr_b16 a[168:169], v1 offset:0
    v_exp_f16 v222, v223
    v_exp_f16_e64 v224, v225
    v_exp_f16_sdwa v222, v223 dst_sel:WORD_1 dst_unused:UNUSED_PRESERVE src0_sel:WORD_1
    v_mfma_f32_32x32x16_bf16 v[172:187], a[172:175], a[100:103], v[172:187]
    ds_read_b64_tr_b16 a[170:171], v1 offset:512
    v_exp_f16_sdwa v224, v225 dst_sel:WORD_1 dst_unused:UNUSED_PRESERVE src0_sel:WORD_1
    v_pk_fma_f16 v222, v222, s101, s101
    v_pk_fma_f16 v224, v224, s101, s101
    v_rcp_f16_e64 v223, v222
    v_mfma_f32_32x32x16_bf16 v[172:187], a[176:179], a[104:107], v[172:187]
    ds_read_b64_tr_b16 v[230:231], v8 offset:36864
    ds_read_b64_tr_b16 v[232:233], v8 offset:43008
    v_rcp_f16 v225, v224
    v_rcp_f16_sdwa v222, v222 dst_sel:WORD_0 dst_unused:UNUSED_PAD src0_sel:WORD_1
    v_rcp_f16_sdwa v224, v224 dst_sel:WORD_0 dst_unused:UNUSED_PAD src0_sel:WORD_1
    v_mfma_f32_32x32x16_bf16 v[172:187], a[180:183], a[108:111], v[172:187]
    s_waitcnt lgkmcnt(4)
    ds_read_b64_tr_b16 a[244:245], v3 offset:30720
    v_fma_mix_f32 v223, v192, v223, 0 op_sel_hi:[0,1,0]
    v_fma_mix_f32 v225, v194, v225, 0 op_sel_hi:[0,1,0]
    v_fma_mix_f32 v222, v193, v222, 0 op_sel_hi:[0,1,0]
    v_fma_mix_f32 v224, v195, v224, 0 op_sel_hi:[0,1,0]
    v_cvt_pk_bf16_f32 v210, v223, v222
    v_cvt_pk_bf16_f32 v211, v225, v224
    v_mfma_f32_16x16x32_bf16 v[164:167], v[226:229], v[234:237], v[164:167]
    buffer_load_dwordx4 v14, s[8:11], s100 offen offset:1024  lds
    ds_read_b64_tr_b16 a[246:247], v3 offset:33792
    ds_read_b128 a[228:231], v9 offset:25600
    v_mfma_f32_32x32x16_bf16 v[172:187], a[184:187], a[112:115], v[172:187]
    ds_write_b128 v10, v[208:211] offset:4096
    v_cvt_pk_f16_f32 v218, v196, v197
    v_cvt_pk_f16_f32 v220, v198, v199
    v_mfma_f32_32x32x16_bf16 v[172:187], a[188:191], a[116:119], v[172:187]
    v_pk_fma_f16 v219, v218, v218, s36
    v_pk_fma_f16 v221, v220, v220, s36
    v_pk_mul_f16 v219, v219, v218
    v_pk_mul_f16 v221, v221, v220
    v_exp_f16 v218, v219
    v_mfma_f32_32x32x16_bf16 v[172:187], a[192:195], a[120:123], v[172:187]
    v_exp_f16 v220, v221
    v_exp_f16_sdwa v218, v219 dst_sel:WORD_1 dst_unused:UNUSED_PRESERVE src0_sel:WORD_1
    v_exp_f16_sdwa v220, v221 dst_sel:WORD_1 dst_unused:UNUSED_PRESERVE src0_sel:WORD_1
    v_pk_fma_f16 v218, v218, s101, s101
    v_mfma_f32_32x32x16_bf16 v[172:187], a[196:199], a[124:127], v[172:187]
    s_waitcnt lgkmcnt(1)
    ds_read_b64_tr_b16 a[248:249], v4 offset:30720
    ds_read_b64_tr_b16 a[186:187], v1 offset:8704
    v_pk_fma_f16 v220, v220, s101, s101
    v_rcp_f16 v219, v218
    v_rcp_f16_e64 v221, v220
    v_mfma_f32_16x16x32_bf16 v[168:171], v[230:233], v[234:237], v[168:171]
    ds_read_b64_tr_b16 a[250:251], v4 offset:33792
    ds_read_b64_tr_b16 a[252:253], v5 offset:30720
    v_mfma_f32_32x32x16_bf16 v[172:187], a[200:203], a[128:131], v[172:187]
    s_nop 0
    ds_read_b64_tr_b16 a[254:255], v5 offset:33792
    ds_read_b64_tr_b16 v[226:227], v2 offset:0
    v_rcp_f16_sdwa v218, v218 dst_sel:WORD_0 dst_unused:UNUSED_PAD src0_sel:WORD_1
    v_rcp_f16_sdwa v220, v220 dst_sel:WORD_0 dst_unused:UNUSED_PAD src0_sel:WORD_1
    v_fma_mix_f32 v219, v196, v219, 0 op_sel_hi:[0,1,0]
    v_mfma_f32_32x32x16_bf16 v[172:187], a[204:207], a[132:135], v[172:187]
    s_add_u32 m0, s41, 0
    ds_read_b64_tr_b16 v[228:229], v2 offset:512
    ds_read_b128 a[216:219], v9 offset:29696
    v_fma_mix_f32 v221, v198, v221, 0 op_sel_hi:[0,1,0]
    v_fma_mix_f32 v218, v197, v218, 0 op_sel_hi:[0,1,0]
    v_fma_mix_f32 v220, v199, v220, 0 op_sel_hi:[0,1,0]
    v_cvt_pk_bf16_f32 v212, v219, v218
    v_cvt_pk_bf16_f32 v213, v221, v220
    v_mfma_f32_32x32x16_bf16 v[172:187], a[208:211], a[136:139], v[172:187]
    buffer_load_dwordx4 v15, s[12:15], s40 offen offset:0  lds
    v_cvt_pk_f16_f32 v222, v200, v201
    v_cvt_pk_f16_f32 v224, v202, v203
    v_pk_fma_f16 v223, v222, v222, s36
    v_pk_fma_f16 v225, v224, v224, s36
    v_pk_mul_f16 v223, v223, v222
    v_mfma_f32_32x32x16_bf16 v[172:187], a[212:215], a[140:143], v[172:187]
    ds_read_b64_tr_b16 v[230:231], v2 offset:4096
    ds_read_b64_tr_b16 v[232:233], v2 offset:4608
    v_pk_mul_f16 v225, v225, v224
    v_exp_f16 v222, v223
    v_exp_f16_e64 v224, v225
    v_mfma_f32_32x32x16_bf16 v[16:31], a[244:247], a[228:231], v[16:31]
    s_waitcnt lgkmcnt(2)
    ds_read_b64_tr_b16 a[172:173], v1 offset:2048
    ds_read_b64_tr_b16 a[188:189], v1 offset:10240
    v_exp_f16_sdwa v222, v223 dst_sel:WORD_1 dst_unused:UNUSED_PRESERVE src0_sel:WORD_1
    v_exp_f16_sdwa v224, v225 dst_sel:WORD_1 dst_unused:UNUSED_PRESERVE src0_sel:WORD_1
    v_pk_fma_f16 v222, v222, s101, s101
    v_mfma_f32_32x32x16_bf16 v[32:47], a[248:251], a[228:231], v[32:47]
    ds_read_b128 a[220:223], v9 offset:33792
    ds_read_b64_tr_b16 a[190:191], v1 offset:10752
    v_pk_fma_f16 v224, v224, s101, s101
    v_rcp_f16_e64 v223, v222
    v_rcp_f16_e64 v225, v224
    v_mfma_f32_32x32x16_bf16 v[48:63], a[252:255], a[228:231], v[48:63]
    buffer_load_dwordx4 v15, s[12:15], s40 offen offset:3072  lds
    v_rcp_f16_sdwa v222, v222 dst_sel:WORD_0 dst_unused:UNUSED_PAD src0_sel:WORD_1
    v_rcp_f16_sdwa v224, v224 dst_sel:WORD_0 dst_unused:UNUSED_PAD src0_sel:WORD_1
    v_fma_mix_f32 v223, v200, v223, 0 op_sel_hi:[0,1,0]
    v_mfma_f32_16x16x32_bf16 v[204:207], v[226:229], a[144:147], 0
    ds_read_b64_tr_b16 v[226:227], v2 offset:8192
    ds_read_b64_tr_b16 v[228:229], v2 offset:8704
    ds_read_b64_tr_b16 a[232:233], v3 offset:36864
    ds_read_b64_tr_b16 a[234:235], v3 offset:39936
    v_mfma_f32_32x32x16_bf16 v[96:111], a[252:255], a[216:219], v[96:111]
    ds_read_b128 a[224:227], v9 offset:26624
    ds_read_b64_tr_b16 a[236:237], v4 offset:36864
    v_fma_mix_f32 v225, v202, v225, 0 op_sel_hi:[0,1,0]
    v_fma_mix_f32 v222, v201, v222, 0 op_sel_hi:[0,1,0]
    v_fma_mix_f32 v224, v203, v224, 0 op_sel_hi:[0,1,0]
    v_cvt_pk_bf16_f32 v214, v223, v222
    v_cvt_pk_bf16_f32 v215, v225, v224
    v_mfma_f32_32x32x16_bf16 v[80:95], a[248:251], a[216:219], v[80:95]
    s_waitcnt lgkmcnt(7)
    ds_read_b64_tr_b16 a[238:239], v4 offset:39936
    ds_read_b64_tr_b16 a[240:241], v5 offset:36864
    v_cvt_pk_f16_f32 v218, v172, v173
    v_cvt_pk_f16_f32 v220, v174, v175
    v_pk_fma_f16 v219, v218, v218, s36
    v_pk_fma_f16 v221, v220, v220, s36
    v_pk_mul_f16 v219, v219, v218
    v_mfma_f32_16x16x32_bf16 v[204:207], v[230:233], a[148:151], v[204:207]
    s_nop 0
    ds_read_b64_tr_b16 v[230:231], v2 offset:12288
    ds_read_b64_tr_b16 v[232:233], v2 offset:12800
    ds_read_b64_tr_b16 a[242:243], v5 offset:39936
    ds_read_b128 a[228:231], v9 offset:30720
    v_mfma_f32_32x32x16_bf16 v[64:79], a[244:247], a[216:219], v[64:79]
    s_add_u32 m0, s41, 1024
    ds_write_b128 v10, v[212:215] offset:5120
    buffer_load_dwordx4 v240, s[12:15], s40 offen offset:0  lds
    v_mfma_f32_32x32x16_bf16 v[112:127], a[244:247], a[220:223], v[112:127]
    s_waitcnt lgkmcnt(6)
    v_pk_mul_f16 v221, v221, v220
    v_exp_f16 v218, v219
    v_exp_f16_e64 v220, v221
    v_exp_f16_sdwa v218, v219 dst_sel:WORD_1 dst_unused:UNUSED_PRESERVE src0_sel:WORD_1
    v_mfma_f32_16x16x32_bf16 v[204:207], v[226:229], a[152:155], v[204:207]
    v_exp_f16_sdwa v220, v221 dst_sel:WORD_1 dst_unused:UNUSED_PRESERVE src0_sel:WORD_1
    v_mfma_f32_32x32x16_bf16 v[128:143], a[248:251], a[220:223], v[128:143]
    v_pk_fma_f16 v218, v218, s101, s101
    v_pk_fma_f16 v220, v220, s101, s101
    v_rcp_f16_e64 v219, v218
    v_rcp_f16_e64 v221, v220
    v_mfma_f32_32x32x16_bf16 v[144:159], a[252:255], a[220:223], v[144:159]
    s_nop 0
    ds_read_b64_tr_b16 v[226:227], v2 offset:16384
    ds_read_b64_tr_b16 v[228:229], v2 offset:16896
    v_rcp_f16_sdwa v218, v218 dst_sel:WORD_0 dst_unused:UNUSED_PAD src0_sel:WORD_1
    v_rcp_f16_sdwa v220, v220 dst_sel:WORD_0 dst_unused:UNUSED_PAD src0_sel:WORD_1
    v_fma_mix_f32 v219, v172, v219, 0 op_sel_hi:[0,1,0]
    v_mfma_f32_32x32x16_bf16 v[16:31], a[232:235], a[224:227], v[16:31]
    s_waitcnt lgkmcnt(3)
    ds_read_b64_tr_b16 a[174:175], v1 offset:2560
    ds_read_b64_tr_b16 a[192:193], v1 offset:12288
    v_fma_mix_f32 v221, v174, v221, 0 op_sel_hi:[0,1,0]
    v_fma_mix_f32 v218, v173, v218, 0 op_sel_hi:[0,1,0]
    v_fma_mix_f32 v220, v175, v220, 0 op_sel_hi:[0,1,0]
    v_cvt_pk_bf16_f32 v208, v219, v218
    v_cvt_pk_bf16_f32 v209, v221, v220
    v_mfma_f32_16x16x32_bf16 v[204:207], v[230:233], a[156:159], v[204:207]
    ds_read_b64_tr_b16 v[230:231], v2 offset:20480
    ds_read_b64_tr_b16 v[232:233], v2 offset:20992
    v_mfma_f32_32x32x16_bf16 v[32:47], a[236:239], a[224:227], v[32:47]
    ds_read_b128 a[216:219], v9 offset:34816
    ds_read_b64_tr_b16 a[194:195], v1 offset:12800
    v_cvt_pk_f16_f32 v222, v176, v177
    v_cvt_pk_f16_f32 v224, v178, v179
    v_pk_fma_f16 v223, v222, v222, s36
    v_pk_fma_f16 v225, v224, v224, s36
    v_pk_mul_f16 v223, v223, v222
    v_mfma_f32_32x32x16_bf16 v[48:63], a[240:243], a[224:227], v[48:63]
    s_waitcnt lgkmcnt(6)
    buffer_load_dwordx4 v240, s[12:15], s40 offen offset:3072  lds
    v_pk_mul_f16 v225, v225, v224
    v_exp_f16 v222, v223
    v_exp_f16_e64 v224, v225
    v_mfma_f32_16x16x32_bf16 v[204:207], v[226:229], a[160:163], v[204:207]
    ds_read_b64_tr_b16 a[176:177], v1 offset:4096
    ds_read_b64_tr_b16 a[196:197], v1 offset:14336
    v_mfma_f32_32x32x16_bf16 v[96:111], a[240:243], a[228:231], v[96:111]
    s_add_u32 m0, s41, 2048
    ds_read_b64_tr_b16 a[178:179], v1 offset:4608
    ds_read_b64_tr_b16 a[198:199], v1 offset:14848
    v_exp_f16_sdwa v222, v223 dst_sel:WORD_1 dst_unused:UNUSED_PRESERVE src0_sel:WORD_1
    v_exp_f16_sdwa v224, v225 dst_sel:WORD_1 dst_unused:UNUSED_PRESERVE src0_sel:WORD_1
    v_pk_fma_f16 v222, v222, s101, s101
    v_mfma_f32_32x32x16_bf16 v[80:95], a[236:239], a[228:231], v[80:95]
    s_waitcnt lgkmcnt(5)
    ds_read_b64_tr_b16 a[180:181], v1 offset:6144
    ds_read_b64_tr_b16 a[202:203], v1 offset:16896
    v_pk_fma_f16 v224, v224, s101, s101
    v_rcp_f16 v223, v222
    v_rcp_f16_e64 v225, v224
    v_mfma_f32_16x16x32_bf16 v[204:207], v[230:233], a[164:167], v[204:207]
    buffer_load_dwordx4 v241, s[12:15], s40 offen offset:0  lds
    v_mfma_f32_32x32x16_bf16 v[64:79], a[232:235], a[228:231], v[64:79]
    ds_read_b64_tr_b16 a[182:183], v1 offset:6656
    ds_read_b64_tr_b16 a[206:207], v1 offset:18944
    v_rcp_f16_sdwa v222, v222 dst_sel:WORD_0 dst_unused:UNUSED_PAD src0_sel:WORD_1
    v_rcp_f16_sdwa v224, v224 dst_sel:WORD_0 dst_unused:UNUSED_PAD src0_sel:WORD_1
    v_fma_mix_f32 v223, v176, v223, 0 op_sel_hi:[0,1,0]
    v_mfma_f32_32x32x16_bf16 v[112:127], a[232:235], a[216:219], v[112:127]
    ds_read_b64_tr_b16 a[184:185], v1 offset:8192
    ds_read_b64_tr_b16 a[210:211], v1 offset:20992
    v_fma_mix_f32 v225, v178, v225, 0 op_sel_hi:[0,1,0]
    v_fma_mix_f32 v222, v177, v222, 0 op_sel_hi:[0,1,0]
    v_fma_mix_f32 v224, v179, v224, 0 op_sel_hi:[0,1,0]
    v_cvt_pk_bf16_f32 v210, v223, v222
    v_cvt_pk_bf16_f32 v211, v225, v224
    v_mfma_f32_32x32x16_bf16 v[128:143], a[236:239], a[216:219], v[128:143]
    ds_write_b128 v10, v[208:211] offset:8192
    v_cvt_pk_f16_f32 v218, v180, v181
    v_cvt_pk_f16_f32 v220, v182, v183
    v_mfma_f32_32x32x16_bf16 v[144:159], a[240:243], a[216:219], v[144:159]
    v_pk_fma_f16 v219, v218, v218, s36
    v_pk_fma_f16 v221, v220, v220, s36
    v_pk_mul_f16 v219, v219, v218
    v_pk_mul_f16 v221, v221, v220
    v_exp_f16 v218, v219
    v_exp_f16_e64 v220, v221
    v_mfma_f32_32x32x16_bf16 v[188:203], a[168:171], a[0:3], 0
    v_exp_f16_sdwa v218, v219 dst_sel:WORD_1 dst_unused:UNUSED_PRESERVE src0_sel:WORD_1
    v_exp_f16_sdwa v220, v221 dst_sel:WORD_1 dst_unused:UNUSED_PRESERVE src0_sel:WORD_1
    v_pk_fma_f16 v218, v218, s101, s101
    v_pk_fma_f16 v220, v220, s101, s101
    v_mfma_f32_32x32x16_bf16 v[188:203], a[172:175], a[4:7], v[188:203]
    s_waitcnt lgkmcnt(2)
    buffer_load_dwordx4 v241, s[12:15], s40 offen offset:3072  lds
    v_rcp_f16_e64 v219, v218
    v_rcp_f16_e64 v221, v220
    v_rcp_f16_sdwa v218, v218 dst_sel:WORD_0 dst_unused:UNUSED_PAD src0_sel:WORD_1
    v_mfma_f32_32x32x16_bf16 v[188:203], a[176:179], a[8:11], v[188:203]
    ds_read_b64_tr_b16 a[200:201], v1 offset:16384
    ds_read_b64_tr_b16 a[212:213], v1 offset:22528
    v_rcp_f16_sdwa v220, v220 dst_sel:WORD_0 dst_unused:UNUSED_PAD src0_sel:WORD_1
    v_fma_mix_f32 v219, v180, v219, 0 op_sel_hi:[0,1,0]
    v_fma_mix_f32 v221, v182, v221, 0 op_sel_hi:[0,1,0]
    v_fma_mix_f32 v218, v181, v218, 0 op_sel_hi:[0,1,0]
    v_mfma_f32_32x32x16_bf16 v[188:203], a[180:183], a[12:15], v[188:203]
    ds_read_b64_tr_b16 a[204:205], v1 offset:18432
    ds_read_b64_tr_b16 a[214:215], v1 offset:23040
    v_fma_mix_f32 v220, v183, v220, 0 op_sel_hi:[0,1,0]
    v_cvt_pk_bf16_f32 v212, v219, v218
    v_cvt_pk_bf16_f32 v213, v221, v220
    v_cvt_pk_f16_f32 v222, v184, v185
    v_cvt_pk_f16_f32 v224, v186, v187
    v_mfma_f32_32x32x16_bf16 v[188:203], a[184:187], a[16:19], v[188:203]
    ds_read_b64_tr_b16 a[208:209], v1 offset:20480
    v_pk_fma_f16 v223, v222, v222, s36
    v_pk_fma_f16 v225, v224, v224, s36
    v_pk_mul_f16 v223, v223, v222
    v_pk_mul_f16 v225, v225, v224
    v_exp_f16_e64 v222, v223
    v_mfma_f32_32x32x16_bf16 v[188:203], a[188:191], a[20:23], v[188:203]
    ds_read_b64_tr_b16 a[244:245], v3 offset:43008
    v_exp_f16_e64 v224, v225
    v_exp_f16_sdwa v222, v223 dst_sel:WORD_1 dst_unused:UNUSED_PRESERVE src0_sel:WORD_1
    v_exp_f16_sdwa v224, v225 dst_sel:WORD_1 dst_unused:UNUSED_PRESERVE src0_sel:WORD_1
    v_mfma_f32_32x32x16_bf16 v[188:203], a[192:195], a[24:27], v[188:203]
    ds_read_b64_tr_b16 a[246:247], v3 offset:46080
    ds_read_b128 a[220:223], v9 offset:27648
    v_pk_fma_f16 v222, v222, s101, s101
    v_pk_fma_f16 v224, v224, s101, s101
    v_rcp_f16 v223, v222
    v_mfma_f32_32x32x16_bf16 v[188:203], a[196:199], a[28:31], v[188:203]
    s_waitcnt lgkmcnt(3)
    ds_read_b64_tr_b16 a[248:249], v4 offset:43008
    ds_read_b64_tr_b16 a[250:251], v4 offset:46080
    v_rcp_f16_e64 v225, v224
    v_rcp_f16_sdwa v222, v222 dst_sel:WORD_0 dst_unused:UNUSED_PAD src0_sel:WORD_1
    v_rcp_f16_sdwa v224, v224 dst_sel:WORD_0 dst_unused:UNUSED_PAD src0_sel:WORD_1
    v_mfma_f32_32x32x16_bf16 v[188:203], a[200:203], a[32:35], v[188:203]
    ds_read_b64_tr_b16 a[252:253], v5 offset:43008
    ds_read_b64_tr_b16 a[254:255], v5 offset:46080
    v_fma_mix_f32 v223, v184, v223, 0 op_sel_hi:[0,1,0]
    v_fma_mix_f32 v225, v186, v225, 0 op_sel_hi:[0,1,0]
    v_fma_mix_f32 v222, v185, v222, 0 op_sel_hi:[0,1,0]
    v_fma_mix_f32 v224, v187, v224, 0 op_sel_hi:[0,1,0]
    v_cvt_pk_bf16_f32 v214, v223, v222
    v_mfma_f32_32x32x16_bf16 v[188:203], a[204:207], a[36:39], v[188:203]
L_pg9:
    s_cbranch_execz L_wu2
    ds_read_b128 a[224:227], v9 offset:31744
    ds_read_b128 a[228:231], v9 offset:35840
    v_cvt_pk_bf16_f32 v215, v225, v224
    v_cvt_pk_f16_f32 v218, v204, v205
    v_cvt_pk_f16_f32 v220, v206, v207
    v_pk_fma_f16 v219, v218, v218, s36
    v_pk_fma_f16 v221, v220, v220, s36
    v_mfma_f32_32x32x16_bf16 v[188:203], a[208:211], a[40:43], v[188:203]
    s_nop 0
    ds_write_b128 v10, v[212:215] offset:9216
    v_pk_mul_f16 v219, v219, v218
    v_pk_mul_f16 v221, v221, v220
    v_mfma_f32_32x32x16_bf16 v[188:203], a[212:215], a[44:47], v[188:203]
    s_waitcnt lgkmcnt(3)
    v_exp_f16 v218, v219
    v_exp_f16 v220, v221
    v_exp_f16_sdwa v218, v219 dst_sel:WORD_1 dst_unused:UNUSED_PRESERVE src0_sel:WORD_1
    v_mfma_f32_32x32x16_bf16 v[16:31], a[244:247], a[220:223], v[16:31]
    v_exp_f16_sdwa v220, v221 dst_sel:WORD_1 dst_unused:UNUSED_PRESERVE src0_sel:WORD_1
    v_pk_fma_f16 v218, v218, s101, s101
    v_pk_fma_f16 v220, v220, s101, s101
    v_rcp_f16 v219, v218
    v_rcp_f16 v221, v220
    v_mfma_f32_32x32x16_bf16 v[32:47], a[248:251], a[220:223], v[32:47]
    v_rcp_f16_sdwa v218, v218 dst_sel:WORD_0 dst_unused:UNUSED_PAD src0_sel:WORD_1
    v_rcp_f16_sdwa v220, v220 dst_sel:WORD_0 dst_unused:UNUSED_PAD src0_sel:WORD_1
    v_fma_mix_f32 v219, v204, v219, 0 op_sel_hi:[0,1,0]
    v_fma_mix_f32 v221, v206, v221, 0 op_sel_hi:[0,1,0]
    v_fma_mix_f32 v218, v205, v218, 0 op_sel_hi:[0,1,0]
    v_mfma_f32_32x32x16_bf16 v[48:63], a[252:255], a[220:223], v[48:63]
    s_waitcnt lgkmcnt(1)
    v_fma_mix_f32 v220, v207, v220, 0 op_sel_hi:[0,1,0]
    v_cvt_pk_bf16_f32 v216, v219, v218
    v_cvt_pk_bf16_f32 v217, v221, v220
    v_cvt_pk_f16_f32 v218, v188, v189
    v_cvt_pk_f16_f32 v220, v190, v191
    v_pk_fma_f16 v219, v218, v218, s36
    v_pk_fma_f16 v221, v220, v220, s36
    v_mfma_f32_32x32x16_bf16 v[96:111], a[252:255], a[224:227], v[96:111]
    v_pk_mul_f16 v219, v219, v218
    v_pk_mul_f16 v221, v221, v220
    v_exp_f16 v218, v219
    v_exp_f16_e64 v220, v221
    v_mfma_f32_32x32x16_bf16 v[80:95], a[248:251], a[224:227], v[80:95]
    s_cmp_eq_u32 s38, 1
    s_cselect_b32 s56, 1536, 0
    v_exp_f16_sdwa v218, v219 dst_sel:WORD_1 dst_unused:UNUSED_PRESERVE src0_sel:WORD_1
    v_exp_f16_sdwa v220, v221 dst_sel:WORD_1 dst_unused:UNUSED_PRESERVE src0_sel:WORD_1
    v_pk_fma_f16 v218, v218, s101, s101
    v_pk_fma_f16 v220, v220, s101, s101
    v_rcp_f16 v219, v218
    v_mfma_f32_32x32x16_bf16 v[64:79], a[244:247], a[224:227], v[64:79]
    s_sub_u32 s56, 128, s56
    v_rcp_f16 v221, v220
    v_rcp_f16_sdwa v218, v218 dst_sel:WORD_0 dst_unused:UNUSED_PAD src0_sel:WORD_1
    v_rcp_f16_sdwa v220, v220 dst_sel:WORD_0 dst_unused:UNUSED_PAD src0_sel:WORD_1
    v_fma_mix_f32 v219, v188, v219, 0 op_sel_hi:[0,1,0]
    v_mfma_f32_32x32x16_bf16 v[112:127], a[244:247], a[228:231], v[112:127]
    s_add_u32 s39, s39, s56
    v_fma_mix_f32 v221, v190, v221, 0 op_sel_hi:[0,1,0]
    v_fma_mix_f32 v218, v189, v218, 0 op_sel_hi:[0,1,0]
    v_fma_mix_f32 v220, v191, v220, 0 op_sel_hi:[0,1,0]
    v_cvt_pk_bf16_f32 v208, v219, v218
    v_cvt_pk_bf16_f32 v209, v221, v220
    v_cvt_pk_f16_f32 v222, v192, v193
    v_cvt_pk_f16_f32 v224, v194, v195
    v_mfma_f32_32x32x16_bf16 v[128:143], a[248:251], a[228:231], v[128:143]
    s_add_u32 s100, s100, s56
    v_pk_fma_f16 v223, v222, v222, s36
    v_pk_fma_f16 v225, v224, v224, s36
    v_pk_mul_f16 v223, v223, v222
    v_pk_mul_f16 v225, v225, v224
    v_exp_f16_e64 v222, v223
    v_mfma_f32_32x32x16_bf16 v[144:159], a[252:255], a[228:231], v[144:159]
    s_add_u32 s40, s40, 24576
    v_exp_f16_e64 v224, v225
    v_exp_f16_sdwa v222, v223 dst_sel:WORD_1 dst_unused:UNUSED_PRESERVE src0_sel:WORD_1
    v_exp_f16_sdwa v224, v225 dst_sel:WORD_1 dst_unused:UNUSED_PRESERVE src0_sel:WORD_1
    v_pk_fma_f16 v222, v222, s101, s101
    s_waitcnt vmcnt(0) lgkmcnt(0)
    s_barrier
    v_mfma_f32_32x32x16_bf16 v[172:187], a[168:171], a[48:51], 0
    ds_read_b64_tr_b16 a[232:233], v3 offset:0
    ds_read_b64_tr_b16 a[234:235], v3 offset:3072
    ds_read_b128 a[216:219], v9 offset:0
    v_pk_fma_f16 v224, v224, s101, s101
    v_rcp_f16 v223, v222
    v_mfma_f32_32x32x16_bf16 v[172:187], a[172:175], a[52:55], v[172:187]
    s_add_u32 m0, s41, 101888
    ds_write_b64 v12, v[216:217] offset:2048
    buffer_load_dwordx4 v13, s[8:11], s39 offen offset:0  lds
    v_rcp_f16 v225, v224
    v_mfma_f32_32x32x16_bf16 v[172:187], a[176:179], a[56:59], v[172:187]
    v_rcp_f16_sdwa v222, v222 dst_sel:WORD_0 dst_unused:UNUSED_PAD src0_sel:WORD_1
    v_rcp_f16_sdwa v224, v224 dst_sel:WORD_0 dst_unused:UNUSED_PAD src0_sel:WORD_1
    v_fma_mix_f32 v223, v192, v223, 0 op_sel_hi:[0,1,0]
    v_fma_mix_f32 v225, v194, v225, 0 op_sel_hi:[0,1,0]
    v_fma_mix_f32 v222, v193, v222, 0 op_sel_hi:[0,1,0]
    v_mfma_f32_32x32x16_bf16 v[172:187], a[180:183], a[60:63], v[172:187]
    ds_read_b64_tr_b16 v[226:227], v6 offset:0
    ds_read_b64_tr_b16 v[228:229], v6 offset:6144
    ds_read_b128 v[234:237], v11 offset:0
    v_fma_mix_f32 v224, v195, v224, 0 op_sel_hi:[0,1,0]
    v_cvt_pk_bf16_f32 v210, v223, v222
    v_cvt_pk_bf16_f32 v211, v225, v224
    v_cvt_pk_f16_f32 v218, v196, v197
    v_mfma_f32_32x32x16_bf16 v[172:187], a[184:187], a[64:67], v[172:187]
    ds_write_b128 v10, v[208:211] offset:24576
    v_cvt_pk_f16_f32 v220, v198, v199
    v_pk_fma_f16 v219, v218, v218, s36
    v_mfma_f32_32x32x16_bf16 v[172:187], a[188:191], a[68:71], v[172:187]
    v_pk_fma_f16 v221, v220, v220, s36
    v_pk_mul_f16 v219, v219, v218
    v_pk_mul_f16 v221, v221, v220
    v_exp_f16 v218, v219
    v_exp_f16 v220, v221
    v_mfma_f32_32x32x16_bf16 v[172:187], a[192:195], a[72:75], v[172:187]
    buffer_load_dwordx4 v14, s[8:11], s39 offen offset:1024  lds
    v_exp_f16_sdwa v218, v219 dst_sel:WORD_1 dst_unused:UNUSED_PRESERVE src0_sel:WORD_1
    v_exp_f16_sdwa v220, v221 dst_sel:WORD_1 dst_unused:UNUSED_PRESERVE src0_sel:WORD_1
    v_pk_fma_f16 v218, v218, s101, s101
    v_mfma_f32_32x32x16_bf16 v[172:187], a[196:199], a[76:79], v[172:187]
    ds_read_b64_tr_b16 v[230:231], v7 offset:0
    ds_read_b64_tr_b16 v[232:233], v7 offset:6144
    v_pk_fma_f16 v220, v220, s101, s101
    v_rcp_f16 v219, v218
    v_rcp_f16_e64 v221, v220
    v_mfma_f32_32x32x16_bf16 v[172:187], a[200:203], a[80:83], v[172:187]
    s_waitcnt lgkmcnt(3)
    ds_read_b64_tr_b16 a[236:237], v4 offset:0
    ds_read_b64_tr_b16 a[238:239], v4 offset:3072
    v_rcp_f16_sdwa v218, v218 dst_sel:WORD_0 dst_unused:UNUSED_PAD src0_sel:WORD_1
    v_rcp_f16_sdwa v220, v220 dst_sel:WORD_0 dst_unused:UNUSED_PAD src0_sel:WORD_1
    v_fma_mix_f32 v219, v196, v219, 0 op_sel_hi:[0,1,0]
    v_mfma_f32_16x16x32_bf16 v[160:163], v[226:229], v[234:237], v[160:163]
    ds_read_b64_tr_b16 a[240:241], v5 offset:0
    ds_read_b64_tr_b16 a[242:243], v5 offset:3072
    v_mfma_f32_32x32x16_bf16 v[172:187], a[204:207], a[84:87], v[172:187]
    ds_read_b128 a[220:223], v9 offset:4096
    v_fma_mix_f32 v221, v198, v221, 0 op_sel_hi:[0,1,0]
    v_fma_mix_f32 v218, v197, v218, 0 op_sel_hi:[0,1,0]
    v_fma_mix_f32 v220, v199, v220, 0 op_sel_hi:[0,1,0]
    v_cvt_pk_bf16_f32 v212, v219, v218
    v_cvt_pk_bf16_f32 v213, v221, v220
    v_cvt_pk_f16_f32 v222, v200, v201
    v_mfma_f32_32x32x16_bf16 v[172:187], a[208:211], a[88:91], v[172:187]
    buffer_load_dwordx4 v254, s[8:11], s39 offen offset:2048  lds
    v_cvt_pk_f16_f32 v224, v202, v203
    v_pk_fma_f16 v223, v222, v222, s36
    v_pk_fma_f16 v225, v224, v224, s36
    v_pk_mul_f16 v223, v223, v222
    v_pk_mul_f16 v225, v225, v224
    v_mfma_f32_32x32x16_bf16 v[172:187], a[212:215], a[92:95], v[172:187]
    ds_read_b64_tr_b16 v[226:227], v8 offset:0
    ds_read_b64_tr_b16 v[228:229], v8 offset:6144
    v_exp_f16 v222, v223
    v_exp_f16_e64 v224, v225
    v_mfma_f32_32x32x16_bf16 v[16:31], a[232:235], a[216:219], v[16:31]
    s_waitcnt lgkmcnt(2)
    v_exp_f16_sdwa v222, v223 dst_sel:WORD_1 dst_unused:UNUSED_PRESERVE src0_sel:WORD_1
    v_exp_f16_sdwa v224, v225 dst_sel:WORD_1 dst_unused:UNUSED_PRESERVE src0_sel:WORD_1
    v_pk_fma_f16 v222, v222, s101, s101
    v_pk_fma_f16 v224, v224, s101, s101
    v_mfma_f32_16x16x32_bf16 v[164:167], v[230:233], v[234:237], v[164:167]
    ds_read_b128 a[224:227], v9 offset:8192
    v_rcp_f16 v223, v222
    v_mfma_f32_32x32x16_bf16 v[32:47], a[236:239], a[216:219], v[32:47]
    v_rcp_f16 v225, v224
    v_rcp_f16_sdwa v222, v222 dst_sel:WORD_0 dst_unused:UNUSED_PAD src0_sel:WORD_1
    v_rcp_f16_sdwa v224, v224 dst_sel:WORD_0 dst_unused:UNUSED_PAD src0_sel:WORD_1
    v_fma_mix_f32 v223, v200, v223, 0 op_sel_hi:[0,1,0]
    v_mfma_f32_32x32x16_bf16 v[48:63], a[240:243], a[216:219], v[48:63]
    buffer_load_dwordx4 v255, s[8:11], s39 offen offset:3072  lds
    v_fma_mix_f32 v225, v202, v225, 0 op_sel_hi:[0,1,0]
    v_fma_mix_f32 v222, v201, v222, 0 op_sel_hi:[0,1,0]
    v_fma_mix_f32 v224, v203, v224, 0 op_sel_hi:[0,1,0]
    v_cvt_pk_bf16_f32 v214, v223, v222
    v_cvt_pk_bf16_f32 v215, v225, v224
    v_mfma_f32_32x32x16_bf16 v[96:111], a[240:243], a[220:223], v[96:111]
    ds_read_b64_tr_b16 v[230:231], v6 offset:12288
    ds_read_b64_tr_b16 v[232:233], v6 offset:18432
    v_cvt_pk_f16_f32 v218, v172, v173
    v_cvt_pk_f16_f32 v220, v174, v175
    v_pk_fma_f16 v219, v218, v218, s36
    v_pk_fma_f16 v221, v220, v220, s36
    v_pk_mul_f16 v219, v219, v218
    v_mfma_f32_32x32x16_bf16 v[80:95], a[236:239], a[220:223], v[80:95]
    s_waitcnt lgkmcnt(2)
    ds_write_b128 v10, v[212:215] offset:25600
    v_pk_mul_f16 v221, v221, v220
    v_mfma_f32_16x16x32_bf16 v[168:171], v[226:229], v[234:237], v[168:171]
    ds_read_b128 v[234:237], v11 offset:1024
    v_exp_f16 v218, v219
    v_mfma_f32_32x32x16_bf16 v[64:79], a[232:235], a[220:223], v[64:79]
    v_exp_f16 v220, v221
    v_exp_f16_sdwa v218, v219 dst_sel:WORD_1 dst_unused:UNUSED_PRESERVE src0_sel:WORD_1
    v_exp_f16_sdwa v220, v221 dst_sel:WORD_1 dst_unused:UNUSED_PRESERVE src0_sel:WORD_1
    v_pk_fma_f16 v218, v218, s101, s101
    v_mfma_f32_32x32x16_bf16 v[112:127], a[232:235], a[224:227], v[112:127]
    v_pk_fma_f16 v220, v220, s101, s101
    v_rcp_f16 v219, v218
    v_rcp_f16_e64 v221, v220
    v_rcp_f16_sdwa v218, v218 dst_sel:WORD_0 dst_unused:UNUSED_PAD src0_sel:WORD_1
    v_mfma_f32_32x32x16_bf16 v[128:143], a[236:239], a[224:227], v[128:143]
    s_add_u32 m0, s41, 105984
    ds_read_b64_tr_b16 v[226:227], v7 offset:12288
    ds_read_b64_tr_b16 v[228:229], v7 offset:18432
    v_rcp_f16_sdwa v220, v220 dst_sel:WORD_0 dst_unused:UNUSED_PAD src0_sel:WORD_1
    v_fma_mix_f32 v219, v172, v219, 0 op_sel_hi:[0,1,0]
    v_fma_mix_f32 v221, v174, v221, 0 op_sel_hi:[0,1,0]
    v_fma_mix_f32 v218, v173, v218, 0 op_sel_hi:[0,1,0]
    v_mfma_f32_32x32x16_bf16 v[144:159], a[240:243], a[224:227], v[144:159]
    s_waitcnt lgkmcnt(2)
    buffer_load_dwordx4 v13, s[8:11], s100 offen offset:0  lds
    v_fma_mix_f32 v220, v175, v220, 0 op_sel_hi:[0,1,0]
    v_cvt_pk_bf16_f32 v208, v219, v218
    v_cvt_pk_bf16_f32 v209, v221, v220
    v_cvt_pk_f16_f32 v222, v176, v177
    v_cvt_pk_f16_f32 v224, v178, v179
    v_mfma_f32_16x16x32_bf16 v[160:163], v[230:233], v[234:237], v[160:163]
    v_pk_fma_f16 v223, v222, v222, s36
    v_pk_fma_f16 v225, v224, v224, s36
    v_mfma_f32_32x32x16_bf16 v[188:203], a[168:171], a[96:99], 0
    ds_read_b64_tr_b16 a[168:169], v1 offset:24576
    v_pk_mul_f16 v223, v223, v222
    v_pk_mul_f16 v225, v225, v224
    v_exp_f16 v222, v223
    v_exp_f16_e64 v224, v225
    v_mfma_f32_32x32x16_bf16 v[188:203], a[172:175], a[100:103], v[188:203]
    ds_read_b64_tr_b16 a[170:171], v1 offset:25088
    v_exp_f16_sdwa v222, v223 dst_sel:WORD_1 dst_unused:UNUSED_PRESERVE src0_sel:WORD_1
    v_exp_f16_sdwa v224, v225 dst_sel:WORD_1 dst_unused:UNUSED_PRESERVE src0_sel:WORD_1
    v_pk_fma_f16 v222, v222, s101, s101
    v_pk_fma_f16 v224, v224, s101, s101
    v_mfma_f32_32x32x16_bf16 v[188:203], a[176:179], a[104:107], v[188:203]
    ds_read_b64_tr_b16 v[230:231], v8 offset:12288
    ds_read_b64_tr_b16 v[232:233], v8 offset:18432
    v_rcp_f16 v223, v222
    v_rcp_f16_e64 v225, v224
    v_mfma_f32_32x32x16_bf16 v[188:203], a[180:183], a[108:111], v[188:203]
    s_waitcnt lgkmcnt(4)
    buffer_load_dwordx4 v14, s[8:11], s100 offen offset:1024  lds
    ds_read_b64_tr_b16 a[244:245], v3 offset:6144
    v_rcp_f16_sdwa v222, v222 dst_sel:WORD_0 dst_unused:UNUSED_PAD src0_sel:WORD_1
    v_rcp_f16_sdwa v224, v224 dst_sel:WORD_0 dst_unused:UNUSED_PAD src0_sel:WORD_1
    v_mfma_f32_16x16x32_bf16 v[164:167], v[226:229], v[234:237], v[164:167]
    ds_read_b64_tr_b16 a[246:247], v3 offset:9216
    ds_read_b128 a[228:231], v9 offset:1024
    v_mfma_f32_32x32x16_bf16 v[188:203], a[184:187], a[112:115], v[188:203]
    ds_read_b64_tr_b16 a[248:249], v4 offset:6144
    ds_read_b64_tr_b16 a[250:251], v4 offset:9216
    v_fma_mix_f32 v223, v176, v223, 0 op_sel_hi:[0,1,0]
    v_fma_mix_f32 v225, v178, v225, 0 op_sel_hi:[0,1,0]
    v_fma_mix_f32 v222, v177, v222, 0 op_sel_hi:[0,1,0]
    v_fma_mix_f32 v224, v179, v224, 0 op_sel_hi:[0,1,0]
    v_cvt_pk_bf16_f32 v210, v223, v222
    v_mfma_f32_32x32x16_bf16 v[188:203], a[188:191], a[116:119], v[188:203]
    ds_read_b64_tr_b16 a[252:253], v5 offset:6144
    ds_read_b64_tr_b16 a[254:255], v5 offset:9216
    v_cvt_pk_bf16_f32 v211, v225, v224
    v_cvt_pk_f16_f32 v218, v180, v181
    v_cvt_pk_f16_f32 v220, v182, v183
    v_pk_fma_f16 v219, v218, v218, s36
    v_pk_fma_f16 v221, v220, v220, s36
    v_mfma_f32_32x32x16_bf16 v[188:203], a[192:195], a[120:123], v[188:203]
    s_add_u32 m0, s41, 24576
    ds_write_b128 v10, v[208:211] offset:28672
    buffer_load_dwordx4 v15, s[12:15], s40 offen offset:0  lds
    v_mfma_f32_32x32x16_bf16 v[188:203], a[196:199], a[124:127], v[188:203]
    s_waitcnt lgkmcnt(5)
    v_pk_mul_f16 v219, v219, v218
    v_pk_mul_f16 v221, v221, v220
    v_exp_f16 v218, v219
    v_exp_f16_e64 v220, v221
    v_mfma_f32_16x16x32_bf16 v[168:171], v[230:233], v[234:237], v[168:171]
    v_exp_f16_sdwa v218, v219 dst_sel:WORD_1 dst_unused:UNUSED_PRESERVE src0_sel:WORD_1
    v_mfma_f32_32x32x16_bf16 v[188:203], a[200:203], a[128:131], v[188:203]
    v_exp_f16_sdwa v220, v221 dst_sel:WORD_1 dst_unused:UNUSED_PRESERVE src0_sel:WORD_1
    v_pk_fma_f16 v218, v218, s101, s101
    v_pk_fma_f16 v220, v220, s101, s101
    v_rcp_f16_e64 v219, v218
    v_mfma_f32_32x32x16_bf16 v[188:203], a[204:207], a[132:135], v[188:203]
    ds_read_b128 a[216:219], v9 offset:5120
    ds_read_b64_tr_b16 a[186:187], v1 offset:33280
    v_rcp_f16_e64 v221, v220
    v_rcp_f16_sdwa v218, v218 dst_sel:WORD_0 dst_unused:UNUSED_PAD src0_sel:WORD_1
    v_mfma_f32_32x32x16_bf16 v[188:203], a[208:211], a[136:139], v[188:203]
    ds_read_b64_tr_b16 a[172:173], v1 offset:26624
    ds_read_b64_tr_b16 a[190:191], v1 offset:35328
    v_rcp_f16_sdwa v220, v220 dst_sel:WORD_0 dst_unused:UNUSED_PAD src0_sel:WORD_1
    v_fma_mix_f32 v219, v180, v219, 0 op_sel_hi:[0,1,0]
    v_fma_mix_f32 v221, v182, v221, 0 op_sel_hi:[0,1,0]
    v_fma_mix_f32 v218, v181, v218, 0 op_sel_hi:[0,1,0]
    v_mfma_f32_32x32x16_bf16 v[188:203], a[212:215], a[140:143], v[188:203]
    buffer_load_dwordx4 v15, s[12:15], s40 offen offset:3072  lds
    v_fma_mix_f32 v220, v183, v220, 0 op_sel_hi:[0,1,0]
    v_cvt_pk_bf16_f32 v212, v219, v218
    v_cvt_pk_bf16_f32 v213, v221, v220
    v_cvt_pk_f16_f32 v222, v184, v185
    v_cvt_pk_f16_f32 v224, v186, v187
    v_mfma_f32_32x32x16_bf16 v[16:31], a[244:247], a[228:231], v[16:31]
    s_waitcnt lgkmcnt(3)
    ds_read_b128 a[220:223], v9 offset:9216
    ds_read_b64_tr_b16 a[194:195], v1 offset:37376
    v_pk_fma_f16 v223, v222, v222, s36
    v_pk_fma_f16 v225, v224, v224, s36
    v_pk_mul_f16 v223, v223, v222
    v_pk_mul_f16 v225, v225, v224
    v_mfma_f32_32x32x16_bf16 v[32:47], a[248:251], a[228:231], v[32:47]
    s_nop 0
    ds_read_b64_tr_b16 a[174:175], v1 offset:27136
    ds_read_b64_tr_b16 a[198:199], v1 offset:39424
    v_exp_f16_e64 v222, v223
    v_exp_f16_e64 v224, v225
    v_mfma_f32_32x32x16_bf16 v[48:63], a[252:255], a[228:231], v[48:63]
    ds_read_b64_tr_b16 a[232:233], v3 offset:12288
    ds_read_b64_tr_b16 a[200:201], v1 offset:40960
    v_exp_f16_sdwa v222, v223 dst_sel:WORD_1 dst_unused:UNUSED_PRESERVE src0_sel:WORD_1
    v_exp_f16_sdwa v224, v225 dst_sel:WORD_1 dst_unused:UNUSED_PRESERVE src0_sel:WORD_1
    v_pk_fma_f16 v222, v222, s101, s101
    v_mfma_f32_32x32x16_bf16 v[96:111], a[252:255], a[216:219], v[96:111]
    s_add_u32 m0, s41, 25600
    ds_read_b64_tr_b16 a[234:235], v3 offset:15360
    ds_read_b128 a[224:227], v9 offset:2048
    v_pk_fma_f16 v224, v224, s101, s101
    v_rcp_f16_e64 v223, v222
    v_rcp_f16 v225, v224
    v_mfma_f32_32x32x16_bf16 v[80:95], a[248:251], a[216:219], v[80:95]
    buffer_load_dwordx4 v240, s[12:15], s40 offen offset:0  lds
    ds_read_b64_tr_b16 a[236:237], v4 offset:12288
    ds_read_b64_tr_b16 a[238:239], v4 offset:15360
    v_rcp_f16_sdwa v222, v222 dst_sel:WORD_0 dst_unused:UNUSED_PAD src0_sel:WORD_1
    v_mfma_f32_32x32x16_bf16 v[64:79], a[244:247], a[216:219], v[64:79]
    s_waitcnt lgkmcnt(9)
    ds_read_b64_tr_b16 a[240:241], v5 offset:12288
    ds_read_b64_tr_b16 a[242:243], v5 offset:15360
    v_rcp_f16_sdwa v224, v224 dst_sel:WORD_0 dst_unused:UNUSED_PAD src0_sel:WORD_1
    v_fma_mix_f32 v223, v184, v223, 0 op_sel_hi:[0,1,0]
    v_fma_mix_f32 v225, v186, v225, 0 op_sel_hi:[0,1,0]
    v_fma_mix_f32 v222, v185, v222, 0 op_sel_hi:[0,1,0]
    v_mfma_f32_32x32x16_bf16 v[112:127], a[244:247], a[220:223], v[112:127]
    ds_read_b128 a[228:231], v9 offset:6144
    ds_read_b128 a[216:219], v9 offset:10240
    v_fma_mix_f32 v224, v187, v224, 0 op_sel_hi:[0,1,0]
    v_cvt_pk_bf16_f32 v214, v223, v222
    v_cvt_pk_bf16_f32 v215, v225, v224
    v_cvt_pk_f16_f32 v218, v188, v189
    v_cvt_pk_f16_f32 v220, v190, v191
    v_mfma_f32_32x32x16_bf16 v[128:143], a[248:251], a[220:223], v[128:143]
    ds_write_b128 v10, v[212:215] offset:29696
    v_pk_fma_f16 v219, v218, v218, s36
    v_pk_fma_f16 v221, v220, v220, s36
    v_mfma_f32_32x32x16_bf16 v[144:159], a[252:255], a[220:223], v[144:159]
    s_waitcnt lgkmcnt(3)
    v_pk_mul_f16 v219, v219, v218
    v_pk_mul_f16 v221, v221, v220
    v_exp_f16 v218, v219
    v_exp_f16_e64 v220, v221
    v_mfma_f32_32x32x16_bf16 v[16:31], a[232:235], a[224:227], v[16:31]
    v_exp_f16_sdwa v218, v219 dst_sel:WORD_1 dst_unused:UNUSED_PRESERVE src0_sel:WORD_1
    v_exp_f16_sdwa v220, v221 dst_sel:WORD_1 dst_unused:UNUSED_PRESERVE src0_sel:WORD_1
    v_pk_fma_f16 v218, v218, s101, s101
    v_pk_fma_f16 v220, v220, s101, s101
    v_mfma_f32_32x32x16_bf16 v[32:47], a[236:239], a[224:227], v[32:47]
    buffer_load_dwordx4 v240, s[12:15], s40 offen offset:3072  lds
    v_rcp_f16 v219, v218
    v_rcp_f16_e64 v221, v220
    v_mfma_f32_32x32x16_bf16 v[48:63], a[240:243], a[224:227], v[48:63]
    s_waitcnt lgkmcnt(1)
    ds_read_b64_tr_b16 a[176:177], v1 offset:28672
    ds_read_b64_tr_b16 a[202:203], v1 offset:41472
    v_rcp_f16_sdwa v218, v218 dst_sel:WORD_0 dst_unused:UNUSED_PAD src0_sel:WORD_1
    v_rcp_f16_sdwa v220, v220 dst_sel:WORD_0 dst_unused:UNUSED_PAD src0_sel:WORD_1
    v_fma_mix_f32 v219, v188, v219, 0 op_sel_hi:[0,1,0]
    v_mfma_f32_32x32x16_bf16 v[96:111], a[240:243], a[228:231], v[96:111]
    ds_read_b64_tr_b16 a[178:179], v1 offset:29184
    ds_read_b64_tr_b16 a[204:205], v1 offset:43008
    v_fma_mix_f32 v221, v190, v221, 0 op_sel_hi:[0,1,0]
    v_fma_mix_f32 v218, v189, v218, 0 op_sel_hi:[0,1,0]
    v_fma_mix_f32 v220, v191, v220, 0 op_sel_hi:[0,1,0]
    v_cvt_pk_bf16_f32 v208, v219, v218
    v_cvt_pk_bf16_f32 v209, v221, v220
    v_mfma_f32_32x32x16_bf16 v[80:95], a[236:239], a[228:231], v[80:95]
    s_add_u32 m0, s41, 26624
    ds_read_b64_tr_b16 a[180:181], v1 offset:30720
    ds_read_b64_tr_b16 a[206:207], v1 offset:43520
    v_cvt_pk_f16_f32 v222, v192, v193
    v_cvt_pk_f16_f32 v224, v194, v195
    v_pk_fma_f16 v223, v222, v222, s36
    v_pk_fma_f16 v225, v224, v224, s36
    v_pk_mul_f16 v223, v223, v222
    v_mfma_f32_32x32x16_bf16 v[64:79], a[232:235], a[228:231], v[64:79]
    buffer_load_dwordx4 v241, s[12:15], s40 offen offset:0  lds
    v_pk_mul_f16 v225, v225, v224
    v_exp_f16_e64 v222, v223
    v_exp_f16_e64 v224, v225
    v_mfma_f32_32x32x16_bf16 v[112:127], a[232:235], a[216:219], v[112:127]
    ds_read_b64_tr_b16 a[182:183], v1 offset:31232
    ds_read_b64_tr_b16 a[208:209], v1 offset:45056
    v_exp_f16_sdwa v222, v223 dst_sel:WORD_1 dst_unused:UNUSED_PRESERVE src0_sel:WORD_1
    v_exp_f16_sdwa v224, v225 dst_sel:WORD_1 dst_unused:UNUSED_PRESERVE src0_sel:WORD_1
    v_mfma_f32_32x32x16_bf16 v[128:143], a[236:239], a[216:219], v[128:143]
    ds_read_b64_tr_b16 a[184:185], v1 offset:32768
    ds_read_b64_tr_b16 a[210:211], v1 offset:45568
    v_pk_fma_f16 v222, v222, s101, s101
    v_pk_fma_f16 v224, v224, s101, s101
    v_rcp_f16_e64 v223, v222
    v_mfma_f32_32x32x16_bf16 v[144:159], a[240:243], a[216:219], v[144:159]
    ds_read_b64_tr_b16 a[188:189], v1 offset:34816
    ds_read_b64_tr_b16 a[212:213], v1 offset:47104
    v_rcp_f16 v225, v224
    v_rcp_f16_sdwa v222, v222 dst_sel:WORD_0 dst_unused:UNUSED_PAD src0_sel:WORD_1
    v_mfma_f32_32x32x16_bf16 v[172:187], a[168:171], a[0:3], 0
    ds_read_b64_tr_b16 a[192:193], v1 offset:36864
    ds_read_b64_tr_b16 a[214:215], v1 offset:47616
    v_rcp_f16_sdwa v224, v224 dst_sel:WORD_0 dst_unused:UNUSED_PAD src0_sel:WORD_1
    v_fma_mix_f32 v223, v192, v223, 0 op_sel_hi:[0,1,0]
    v_fma_mix_f32 v225, v194, v225, 0 op_sel_hi:[0,1,0]
    v_fma_mix_f32 v222, v193, v222, 0 op_sel_hi:[0,1,0]
    v_mfma_f32_32x32x16_bf16 v[172:187], a[172:175], a[4:7], v[172:187]
    s_waitcnt lgkmcnt(5)
    ds_read_b64_tr_b16 a[196:197], v1 offset:38912
    v_fma_mix_f32 v224, v195, v224, 0 op_sel_hi:[0,1,0]
    v_cvt_pk_bf16_f32 v210, v223, v222
    v_cvt_pk_bf16_f32 v211, v225, v224
    v_cvt_pk_f16_f32 v218, v196, v197
    v_cvt_pk_f16_f32 v220, v198, v199
    v_pk_fma_f16 v219, v218, v218, s36
    v_mfma_f32_32x32x16_bf16 v[172:187], a[176:179], a[8:11], v[172:187]
    ds_write_b128 v10, v[208:211] offset:32768
    v_pk_fma_f16 v221, v220, v220, s36
    v_mfma_f32_32x32x16_bf16 v[172:187], a[180:183], a[12:15], v[172:187]
    v_pk_mul_f16 v219, v219, v218
    v_pk_mul_f16 v221, v221, v220
    v_exp_f16 v218, v219
    v_exp_f16_e64 v220, v221
    v_mfma_f32_32x32x16_bf16 v[172:187], a[184:187], a[16:19], v[172:187]
    s_waitcnt lgkmcnt(1)
    v_exp_f16_sdwa v218, v219 dst_sel:WORD_1 dst_unused:UNUSED_PRESERVE src0_sel:WORD_1
    v_exp_f16_sdwa v220, v221 dst_sel:WORD_1 dst_unused:UNUSED_PRESERVE src0_sel:WORD_1
    v_pk_fma_f16 v218, v218, s101, s101
    v_pk_fma_f16 v220, v220, s101, s101
    v_mfma_f32_32x32x16_bf16 v[172:187], a[188:191], a[20:23], v[172:187]
    buffer_load_dwordx4 v241, s[12:15], s40 offen offset:3072  lds
    ds_read_b64_tr_b16 a[244:245], v3 offset:18432
    v_rcp_f16_e64 v219, v218
    v_rcp_f16_e64 v221, v220
    v_mfma_f32_32x32x16_bf16 v[172:187], a[192:195], a[24:27], v[172:187]
    ds_read_b64_tr_b16 a[246:247], v3 offset:21504
    ds_read_b128 a[220:223], v9 offset:3072
    v_rcp_f16_sdwa v218, v218 dst_sel:WORD_0 dst_unused:UNUSED_PAD src0_sel:WORD_1
    v_rcp_f16_sdwa v220, v220 dst_sel:WORD_0 dst_unused:UNUSED_PAD src0_sel:WORD_1
    v_fma_mix_f32 v219, v196, v219, 0 op_sel_hi:[0,1,0]
    v_mfma_f32_32x32x16_bf16 v[172:187], a[196:199], a[28:31], v[172:187]
    ds_read_b64_tr_b16 a[248:249], v4 offset:18432
    ds_read_b64_tr_b16 a[250:251], v4 offset:21504
    v_fma_mix_f32 v221, v198, v221, 0 op_sel_hi:[0,1,0]
    v_fma_mix_f32 v218, v197, v218, 0 op_sel_hi:[0,1,0]
    v_fma_mix_f32 v220, v199, v220, 0 op_sel_hi:[0,1,0]
    v_cvt_pk_bf16_f32 v212, v219, v218
    v_cvt_pk_bf16_f32 v213, v221, v220
    v_mfma_f32_32x32x16_bf16 v[172:187], a[200:203], a[32:35], v[172:187]
    ds_read_b64_tr_b16 a[252:253], v5 offset:18432
    ds_read_b64_tr_b16 a[254:255], v5 offset:21504
    v_cvt_pk_f16_f32 v222, v200, v201
    v_cvt_pk_f16_f32 v224, v202, v203
    v_pk_fma_f16 v223, v222, v222, s36
    v_pk_fma_f16 v225, v224, v224, s36
    v_mfma_f32_32x32x16_bf16 v[172:187], a[204:207], a[36:39], v[172:187]
    ds_read_b128 a[224:227], v9 offset:7168
    v_pk_mul_f16 v223, v223, v222
    v_pk_mul_f16 v225, v225, v224
    v_exp_f16_e64 v222, v223
    v_exp_f16_e64 v224, v225
    v_mfma_f32_32x32x16_bf16 v[172:187], a[208:211], a[40:43], v[172:187]
    v_exp_f16_sdwa v222, v223 dst_sel:WORD_1 dst_unused:UNUSED_PRESERVE src0_sel:WORD_1
    v_exp_f16_sdwa v224, v225 dst_sel:WORD_1 dst_unused:UNUSED_PRESERVE src0_sel:WORD_1
    v_pk_fma_f16 v222, v222, s101, s101
    v_pk_fma_f16 v224, v224, s101, s101
    v_mfma_f32_32x32x16_bf16 v[172:187], a[212:215], a[44:47], v[172:187]
    s_waitcnt lgkmcnt(1)
    v_rcp_f16 v223, v222
    v_rcp_f16_e64 v225, v224
    v_rcp_f16_sdwa v222, v222 dst_sel:WORD_0 dst_unused:UNUSED_PAD src0_sel:WORD_1
    v_mfma_f32_32x32x16_bf16 v[16:31], a[244:247], a[220:223], v[16:31]
    ds_read_b128 a[228:231], v9 offset:11264
    v_rcp_f16_sdwa v224, v224 dst_sel:WORD_0 dst_unused:UNUSED_PAD src0_sel:WORD_1
    v_fma_mix_f32 v223, v200, v223, 0 op_sel_hi:[0,1,0]
    v_fma_mix_f32 v225, v202, v225, 0 op_sel_hi:[0,1,0]
    v_fma_mix_f32 v222, v201, v222, 0 op_sel_hi:[0,1,0]
    v_fma_mix_f32 v224, v203, v224, 0 op_sel_hi:[0,1,0]
    v_mfma_f32_32x32x16_bf16 v[32:47], a[248:251], a[220:223], v[32:47]
    v_cvt_pk_bf16_f32 v214, v223, v222
    v_cvt_pk_bf16_f32 v215, v225, v224
    v_cvt_pk_f16_f32 v218, v172, v173
    v_cvt_pk_f16_f32 v220, v174, v175
    v_pk_fma_f16 v219, v218, v218, s36
    v_pk_fma_f16 v221, v220, v220, s36
    v_pk_mul_f16 v219, v219, v218
    v_mfma_f32_32x32x16_bf16 v[48:63], a[252:255], a[220:223], v[48:63]
    s_waitcnt lgkmcnt(1)
    ds_write_b128 v10, v[212:215] offset:33792
    v_pk_mul_f16 v221, v221, v220
    v_mfma_f32_32x32x16_bf16 v[96:111], a[252:255], a[224:227], v[96:111]
    v_exp_f16 v218, v219
    v_exp_f16_e64 v220, v221
    v_exp_f16_sdwa v218, v219 dst_sel:WORD_1 dst_unused:UNUSED_PRESERVE src0_sel:WORD_1
    v_mfma_f32_32x32x16_bf16 v[80:95], a[248:251], a[224:227], v[80:95]
    v_exp_f16_sdwa v220, v221 dst_sel:WORD_1 dst_unused:UNUSED_PRESERVE src0_sel:WORD_1
    v_pk_fma_f16 v218, v218, s101, s101
    v_pk_fma_f16 v220, v220, s101, s101
    v_rcp_f16 v219, v218
    v_mfma_f32_32x32x16_bf16 v[64:79], a[244:247], a[224:227], v[64:79]
    s_waitcnt lgkmcnt(1)
    v_rcp_f16_e64 v221, v220
    v_rcp_f16_sdwa v218, v218 dst_sel:WORD_0 dst_unused:UNUSED_PAD src0_sel:WORD_1
    v_rcp_f16_sdwa v220, v220 dst_sel:WORD_0 dst_unused:UNUSED_PAD src0_sel:WORD_1
    v_fma_mix_f32 v219, v172, v219, 0 op_sel_hi:[0,1,0]
    v_mfma_f32_32x32x16_bf16 v[112:127], a[244:247], a[228:231], v[112:127]
    s_add_u32 s39, s39, 128
    v_fma_mix_f32 v221, v174, v221, 0 op_sel_hi:[0,1,0]
    v_fma_mix_f32 v218, v173, v218, 0 op_sel_hi:[0,1,0]
    v_fma_mix_f32 v220, v175, v220, 0 op_sel_hi:[0,1,0]
    v_cvt_pk_bf16_f32 v208, v219, v218
    v_cvt_pk_bf16_f32 v209, v221, v220
    v_cvt_pk_f16_f32 v222, v176, v177
    v_cvt_pk_f16_f32 v224, v178, v179
    v_mfma_f32_32x32x16_bf16 v[128:143], a[248:251], a[228:231], v[128:143]
    s_add_u32 s100, s100, 128
    v_pk_fma_f16 v223, v222, v222, s36
    v_pk_fma_f16 v225, v224, v224, s36
    v_pk_mul_f16 v223, v223, v222
    v_pk_mul_f16 v225, v225, v224
    v_exp_f16_e64 v222, v223
L_pg10:
    s_cbranch_execz L_wu2
    v_mfma_f32_32x32x16_bf16 v[144:159], a[252:255], a[228:231], v[144:159]
    s_add_u32 s40, s40, 24576
    v_exp_f16 v224, v225
    v_exp_f16_sdwa v222, v223 dst_sel:WORD_1 dst_unused:UNUSED_PRESERVE src0_sel:WORD_1
    v_exp_f16_sdwa v224, v225 dst_sel:WORD_1 dst_unused:UNUSED_PRESERVE src0_sel:WORD_1
    v_pk_fma_f16 v222, v222, s101, s101
    s_waitcnt vmcnt(0) lgkmcnt(0)
    s_barrier
    v_mfma_f32_32x32x16_bf16 v[188:203], a[168:171], a[48:51], 0
    s_add_u32 m0, s41, 126464
    ds_read_b64_tr_b16 v[226:227], v6 offset:24576
    ds_read_b64_tr_b16 v[228:229], v6 offset:30720
    ds_read_b128 v[234:237], v11 offset:2048
    v_pk_fma_f16 v224, v224, s101, s101
    v_rcp_f16 v223, v222
    v_mfma_f32_32x32x16_bf16 v[188:203], a[172:175], a[52:55], v[188:203]
    buffer_load_dwordx4 v13, s[8:11], s39 offen offset:0  lds
    v_rcp_f16 v225, v224
    v_rcp_f16_sdwa v222, v222 dst_sel:WORD_0 dst_unused:UNUSED_PAD src0_sel:WORD_1
    v_mfma_f32_32x32x16_bf16 v[188:203], a[176:179], a[56:59], v[188:203]
    ds_read_b64_tr_b16 v[230:231], v7 offset:24576
    ds_read_b64_tr_b16 v[232:233], v7 offset:30720
    v_rcp_f16_sdwa v224, v224 dst_sel:WORD_0 dst_unused:UNUSED_PAD src0_sel:WORD_1
    v_fma_mix_f32 v223, v176, v223, 0 op_sel_hi:[0,1,0]
    v_fma_mix_f32 v225, v178, v225, 0 op_sel_hi:[0,1,0]
    v_fma_mix_f32 v222, v177, v222, 0 op_sel_hi:[0,1,0]
    v_mfma_f32_32x32x16_bf16 v[188:203], a[180:183], a[60:63], v[188:203]
    ds_read_b64_tr_b16 a[232:233], v3 offset:24576
    v_fma_mix_f32 v224, v179, v224, 0 op_sel_hi:[0,1,0]
    v_cvt_pk_bf16_f32 v210, v223, v222
    v_cvt_pk_bf16_f32 v211, v225, v224
    v_cvt_pk_f16_f32 v218, v180, v181
    v_cvt_pk_f16_f32 v220, v182, v183
    v_pk_fma_f16 v219, v218, v218, s36
    v_mfma_f32_32x32x16_bf16 v[188:203], a[184:187], a[64:67], v[188:203]
    s_waitcnt lgkmcnt(3)
    ds_write_b128 v10, v[208:211] offset:0
    v_pk_fma_f16 v221, v220, v220, s36
    v_pk_mul_f16 v219, v219, v218
    v_mfma_f32_16x16x32_bf16 v[160:163], v[226:229], v[234:237], v[160:163]
    v_pk_mul_f16 v221, v221, v220
    v_exp_f16 v218, v219
    v_mfma_f32_32x32x16_bf16 v[188:203], a[188:191], a[68:71], v[188:203]
    buffer_load_dwordx4 v14, s[8:11], s39 offen offset:1024  lds
    ds_read_b64_tr_b16 v[226:227], v8 offset:24576
    ds_read_b64_tr_b16 v[228:229], v8 offset:30720
    v_exp_f16_e64 v220, v221
    v_mfma_f32_32x32x16_bf16 v[188:203], a[192:195], a[72:75], v[188:203]
    v_exp_f16_sdwa v218, v219 dst_sel:WORD_1 dst_unused:UNUSED_PRESERVE src0_sel:WORD_1
    v_exp_f16_sdwa v220, v221 dst_sel:WORD_1 dst_unused:UNUSED_PRESERVE src0_sel:WORD_1
    v_pk_fma_f16 v218, v218, s101, s101
    v_pk_fma_f16 v220, v220, s101, s101
    v_mfma_f32_32x32x16_bf16 v[188:203], a[196:199], a[76:79], v[188:203]
    s_waitcnt lgkmcnt(4)
    ds_read_b64_tr_b16 a[234:235], v3 offset:27648
    ds_read_b128 a[216:219], v9 offset:24576
    v_rcp_f16 v219, v218
    v_rcp_f16_e64 v221, v220
    v_mfma_f32_16x16x32_bf16 v[164:167], v[230:233], v[234:237], v[164:167]
    ds_read_b64_tr_b16 a[236:237], v4 offset:24576
    ds_read_b64_tr_b16 a[238:239], v4 offset:27648
    v_mfma_f32_32x32x16_bf16 v[188:203], a[200:203], a[80:83], v[188:203]
    ds_read_b64_tr_b16 v[230:231], v6 offset:36864
    ds_read_b64_tr_b16 v[232:233], v6 offset:43008
    v_rcp_f16_sdwa v218, v218 dst_sel:WORD_0 dst_unused:UNUSED_PAD src0_sel:WORD_1
    v_rcp_f16_sdwa v220, v220 dst_sel:WORD_0 dst_unused:UNUSED_PAD src0_sel:WORD_1
    v_fma_mix_f32 v219, v180, v219, 0 op_sel_hi:[0,1,0]
    v_mfma_f32_32x32x16_bf16 v[188:203], a[204:207], a[84:87], v[188:203]
    ds_read_b64_tr_b16 a[240:241], v5 offset:24576
    ds_read_b64_tr_b16 a[242:243], v5 offset:27648
    v_fma_mix_f32 v221, v182, v221, 0 op_sel_hi:[0,1,0]
    v_fma_mix_f32 v218, v181, v218, 0 op_sel_hi:[0,1,0]
    v_fma_mix_f32 v220, v183, v220, 0 op_sel_hi:[0,1,0]
    v_cvt_pk_bf16_f32 v212, v219, v218
    v_cvt_pk_bf16_f32 v213, v221, v220
    v_mfma_f32_32x32x16_bf16 v[188:203], a[208:211], a[88:91], v[188:203]
    s_waitcnt lgkmcnt(4)
    buffer_load_dwordx4 v254, s[8:11], s39 offen offset:2048  lds
    ds_read_b128 a[220:223], v9 offset:28672
    v_cvt_pk_f16_f32 v222, v184, v185
    v_cvt_pk_f16_f32 v224, v186, v187
    v_pk_fma_f16 v223, v222, v222, s36
    v_pk_fma_f16 v225, v224, v224, s36
    v_mfma_f32_16x16x32_bf16 v[168:171], v[226:229], v[234:237], v[168:171]
    s_nop 0
    ds_read_b128 v[234:237], v11 offset:3072
    v_pk_mul_f16 v223, v223, v222
    v_mfma_f32_32x32x16_bf16 v[188:203], a[212:215], a[92:95], v[188:203]
    ds_read_b64_tr_b16 v[226:227], v7 offset:36864
    ds_read_b64_tr_b16 v[228:229], v7 offset:43008
    v_pk_mul_f16 v225, v225, v224
    v_exp_f16 v222, v223
    v_exp_f16 v224, v225
    v_mfma_f32_32x32x16_bf16 v[16:31], a[232:235], a[216:219], v[16:31]
    v_exp_f16_sdwa v222, v223 dst_sel:WORD_1 dst_unused:UNUSED_PRESERVE src0_sel:WORD_1
    v_exp_f16_sdwa v224, v225 dst_sel:WORD_1 dst_unused:UNUSED_PRESERVE src0_sel:WORD_1
    v_pk_fma_f16 v222, v222, s101, s101
    v_pk_fma_f16 v224, v224, s101, s101
    v_mfma_f32_32x32x16_bf16 v[32:47], a[236:239], a[216:219], v[32:47]
    s_waitcnt lgkmcnt(2)
    ds_read_b128 a[224:227], v9 offset:32768
    v_rcp_f16 v223, v222
    v_rcp_f16_e64 v225, v224
    v_rcp_f16_sdwa v222, v222 dst_sel:WORD_0 dst_unused:UNUSED_PAD src0_sel:WORD_1
    v_mfma_f32_16x16x32_bf16 v[160:163], v[230:233], v[234:237], v[160:163]
    buffer_load_dwordx4 v255, s[8:11], s39 offen offset:3072  lds
    v_mfma_f32_32x32x16_bf16 v[48:63], a[240:243], a[216:219], v[48:63]
    ds_read_b64_tr_b16 v[230:231], v8 offset:36864
    ds_read_b64_tr_b16 v[232:233], v8 offset:43008
    v_rcp_f16_sdwa v224, v224 dst_sel:WORD_0 dst_unused:UNUSED_PAD src0_sel:WORD_1
    v_fma_mix_f32 v223, v184, v223, 0 op_sel_hi:[0,1,0]
    v_fma_mix_f32 v225, v186, v225, 0 op_sel_hi:[0,1,0]
    v_fma_mix_f32 v222, v185, v222, 0 op_sel_hi:[0,1,0]
    v_mfma_f32_32x32x16_bf16 v[96:111], a[240:243], a[220:223], v[96:111]
    v_fma_mix_f32 v224, v187, v224, 0 op_sel_hi:[0,1,0]
    v_cvt_pk_bf16_f32 v214, v223, v222
    v_cvt_pk_bf16_f32 v215, v225, v224
    v_cvt_pk_f16_f32 v218, v188, v189
    v_cvt_pk_f16_f32 v220, v190, v191
    v_pk_fma_f16 v219, v218, v218, s36
    v_pk_fma_f16 v221, v220, v220, s36
    v_mfma_f32_32x32x16_bf16 v[80:95], a[236:239], a[220:223], v[80:95]
    s_waitcnt lgkmcnt(2)
    ds_write_b128 v10, v[212:215] offset:1024
    v_pk_mul_f16 v219, v219, v218
    v_pk_mul_f16 v221, v221, v220
    v_mfma_f32_16x16x32_bf16 v[164:167], v[226:229], v[234:237], v[164:167]
    v_exp_f16 v218, v219
    v_mfma_f32_32x32x16_bf16 v[64:79], a[232:235], a[220:223], v[64:79]
    v_exp_f16_e64 v220, v221
    v_exp_f16_sdwa v218, v219 dst_sel:WORD_1 dst_unused:UNUSED_PRESERVE src0_sel:WORD_1
    v_exp_f16_sdwa v220, v221 dst_sel:WORD_1 dst_unused:UNUSED_PRESERVE src0_sel:WORD_1
    v_pk_fma_f16 v218, v218, s101, s101
    v_mfma_f32_32x32x16_bf16 v[112:127], a[232:235], a[224:227], v[112:127]
    s_add_u32 m0, s41, 130560
    v_pk_fma_f16 v220, v220, s101, s101
    v_rcp_f16 v219, v218
    v_rcp_f16_e64 v221, v220
    v_rcp_f16_sdwa v218, v218 dst_sel:WORD_0 dst_unused:UNUSED_PAD src0_sel:WORD_1
    v_mfma_f32_32x32x16_bf16 v[128:143], a[236:239], a[224:227], v[128:143]
    s_waitcnt lgkmcnt(1)
    buffer_load_dwordx4 v13, s[8:11], s100 offen offset:0  lds
    v_rcp_f16_sdwa v220, v220 dst_sel:WORD_0 dst_unused:UNUSED_PAD src0_sel:WORD_1
    v_fma_mix_f32 v219, v188, v219, 0 op_sel_hi:[0,1,0]
    v_fma_mix_f32 v221, v190, v221, 0 op_sel_hi:[0,1,0]
    v_fma_mix_f32 v218, v189, v218, 0 op_sel_hi:[0,1,0]
    v_mfma_f32_16x16x32_bf16 v[168:171], v[230:233], v[234:237], v[168:171]
    v_fma_mix_f32 v220, v191, v220, 0 op_sel_hi:[0,1,0]
    v_cvt_pk_bf16_f32 v208, v219, v218
    v_mfma_f32_32x32x16_bf16 v[144:159], a[240:243], a[224:227], v[144:159]
    v_cvt_pk_bf16_f32 v209, v221, v220
    v_cvt_pk_f16_f32 v222, v192, v193
    v_cvt_pk_f16_f32 v224, v194, v195
    v_pk_fma_f16 v223, v222, v222, s36
    v_pk_fma_f16 v225, v224, v224, s36
    v_pk_mul_f16 v223, v223, v222
    v_pk_mul_f16 v225, v225, v224
    v_mfma_f32_32x32x16_bf16 v[172:187], a[168:171], a[96:99], 0
    buffer_load_dwordx4 v14, s[8:11], s100 offen offset:1024  lds
    v_exp_f16_e64 v222, v223
    v_exp_f16_e64 v224, v225
    v_mfma_f32_32x32x16_bf16 v[172:187], a[172:175], a[100:103], v[172:187]
    s_mul_i32 s33, s3, 49152
    ds_read_b64_tr_b16 a[168:169], v1 offset:0
    v_exp_f16_sdwa v222, v223 dst_sel:WORD_1 dst_unused:UNUSED_PRESERVE src0_sel:WORD_1
    v_exp_f16_sdwa v224, v225 dst_sel:WORD_1 dst_unused:UNUSED_PRESERVE src0_sel:WORD_1
    v_pk_fma_f16 v222, v222, s101, s101
    v_pk_fma_f16 v224, v224, s101, s101
    v_mfma_f32_32x32x16_bf16 v[172:187], a[176:179], a[104:107], v[172:187]
    s_mul_i32 s34, s38, 12288
    s_add_u32 s33, s33, s34
    s_mul_i32 s34, s28, 192
    s_add_u32 s33, s33, s34
    s_add_u32 s42, s33, 393216
    buffer_store_dwordx4 v[160:163], v252, s[24:27], s42 offen offset:0 sc1
    ds_read_b64_tr_b16 a[170:171], v1 offset:512
    v_mfma_f32_32x32x16_bf16 v[172:187], a[180:183], a[108:111], v[172:187]
    ds_read_b64_tr_b16 a[244:245], v3 offset:30720
    ds_read_b64_tr_b16 a[246:247], v3 offset:33792
    v_rcp_f16_e64 v223, v222
    v_rcp_f16_e64 v225, v224
    v_mfma_f32_32x32x16_bf16 v[172:187], a[184:187], a[112:115], v[172:187]
    ds_read_b128 a[228:231], v9 offset:25600
    ds_read_b64_tr_b16 a[248:249], v4 offset:30720
    v_rcp_f16_sdwa v222, v222 dst_sel:WORD_0 dst_unused:UNUSED_PAD src0_sel:WORD_1
    v_rcp_f16_sdwa v224, v224 dst_sel:WORD_0 dst_unused:UNUSED_PAD src0_sel:WORD_1
    v_fma_mix_f32 v223, v192, v223, 0 op_sel_hi:[0,1,0]
    v_mfma_f32_32x32x16_bf16 v[172:187], a[188:191], a[116:119], v[172:187]
    s_add_u32 m0, s41, 0
    buffer_store_dwordx4 v[164:167], v252, s[24:27], s42 offen offset:64 sc1
    buffer_load_dwordx4 v15, s[12:15], s40 offen offset:0  lds
    ds_read_b64_tr_b16 a[250:251], v4 offset:33792
    ds_read_b64_tr_b16 a[252:253], v5 offset:30720
    v_mfma_f32_32x32x16_bf16 v[172:187], a[192:195], a[120:123], v[172:187]
    s_nop 0
    ds_read_b64_tr_b16 a[254:255], v5 offset:33792
    ds_read_b128 a[216:219], v9 offset:29696
    v_fma_mix_f32 v225, v194, v225, 0 op_sel_hi:[0,1,0]
    v_fma_mix_f32 v222, v193, v222, 0 op_sel_hi:[0,1,0]
    v_fma_mix_f32 v224, v195, v224, 0 op_sel_hi:[0,1,0]
    v_cvt_pk_bf16_f32 v210, v223, v222
    v_cvt_pk_bf16_f32 v211, v225, v224
    v_mfma_f32_32x32x16_bf16 v[172:187], a[196:199], a[124:127], v[172:187]
    ds_write_b128 v10, v[208:211] offset:4096
    v_cvt_pk_f16_f32 v218, v196, v197
    v_cvt_pk_f16_f32 v220, v198, v199
    v_mfma_f32_32x32x16_bf16 v[172:187], a[200:203], a[128:131], v[172:187]
    buffer_store_dwordx4 v[168:171], v252, s[24:27], s42 offen offset:128 sc1
    v_pk_fma_f16 v219, v218, v218, s36
    v_mfma_f32_32x32x16_bf16 v[172:187], a[204:207], a[132:135], v[172:187]
    v_pk_fma_f16 v221, v220, v220, s36
    v_pk_mul_f16 v219, v219, v218
    v_pk_mul_f16 v221, v221, v220
    v_exp_f16 v218, v219
    v_exp_f16 v220, v221
    v_mfma_f32_32x32x16_bf16 v[172:187], a[208:211], a[136:139], v[172:187]
    ds_read_b64_tr_b16 a[172:173], v1 offset:2048
    ds_read_b64_tr_b16 a[186:187], v1 offset:8704
    v_exp_f16_sdwa v218, v219 dst_sel:WORD_1 dst_unused:UNUSED_PRESERVE src0_sel:WORD_1
    v_exp_f16_sdwa v220, v221 dst_sel:WORD_1 dst_unused:UNUSED_PRESERVE src0_sel:WORD_1
    v_pk_fma_f16 v218, v218, s101, s101
    v_mfma_f32_32x32x16_bf16 v[172:187], a[212:215], a[140:143], v[172:187]
    s_waitcnt lgkmcnt(3)
    buffer_load_dwordx4 v15, s[12:15], s40 offen offset:3072  lds
    v_pk_fma_f16 v220, v220, s101, s101
    v_rcp_f16 v219, v218
    v_rcp_f16_e64 v221, v220
    v_mfma_f32_32x32x16_bf16 v[16:31], a[244:247], a[228:231], v[16:31]
    ds_read_b128 a[220:223], v9 offset:33792
    ds_read_b64_tr_b16 a[190:191], v1 offset:10752
    v_rcp_f16_sdwa v218, v218 dst_sel:WORD_0 dst_unused:UNUSED_PAD src0_sel:WORD_1
    v_rcp_f16_sdwa v220, v220 dst_sel:WORD_0 dst_unused:UNUSED_PAD src0_sel:WORD_1
    v_fma_mix_f32 v219, v196, v219, 0 op_sel_hi:[0,1,0]
    v_mfma_f32_32x32x16_bf16 v[32:47], a[248:251], a[228:231], v[32:47]
    ds_read_b64_tr_b16 a[174:175], v1 offset:2560
    ds_read_b64_tr_b16 a[194:195], v1 offset:12800
    v_fma_mix_f32 v221, v198, v221, 0 op_sel_hi:[0,1,0]
    v_fma_mix_f32 v218, v197, v218, 0 op_sel_hi:[0,1,0]
    v_fma_mix_f32 v220, v199, v220, 0 op_sel_hi:[0,1,0]
    v_cvt_pk_bf16_f32 v212, v219, v218
    v_cvt_pk_bf16_f32 v213, v221, v220
    v_mfma_f32_32x32x16_bf16 v[48:63], a[252:255], a[228:231], v[48:63]
    ds_read_b64_tr_b16 a[232:233], v3 offset:36864
    ds_read_b64_tr_b16 a[198:199], v1 offset:14848
    v_cvt_pk_f16_f32 v222, v200, v201
    v_cvt_pk_f16_f32 v224, v202, v203
    v_pk_fma_f16 v223, v222, v222, s36
    v_pk_fma_f16 v225, v224, v224, s36
    v_pk_mul_f16 v223, v223, v222
    v_mfma_f32_32x32x16_bf16 v[96:111], a[252:255], a[216:219], v[96:111]
    ds_read_b64_tr_b16 a[234:235], v3 offset:39936
    ds_read_b128 a[224:227], v9 offset:26624
    v_pk_mul_f16 v225, v225, v224
    v_exp_f16_e64 v222, v223
    v_exp_f16_e64 v224, v225
    v_mfma_f32_32x32x16_bf16 v[80:95], a[248:251], a[216:219], v[80:95]
    s_add_u32 m0, s41, 1024
    ds_read_b64_tr_b16 a[236:237], v4 offset:36864
    ds_read_b64_tr_b16 a[238:239], v4 offset:39936
    v_exp_f16_sdwa v222, v223 dst_sel:WORD_1 dst_unused:UNUSED_PRESERVE src0_sel:WORD_1
    v_exp_f16_sdwa v224, v225 dst_sel:WORD_1 dst_unused:UNUSED_PRESERVE src0_sel:WORD_1
    v_pk_fma_f16 v222, v222, s101, s101
    v_mfma_f32_32x32x16_bf16 v[64:79], a[244:247], a[216:219], v[64:79]
    s_waitcnt lgkmcnt(9)
    ds_read_b64_tr_b16 a[240:241], v5 offset:36864
    ds_read_b64_tr_b16 a[242:243], v5 offset:39936
    v_pk_fma_f16 v224, v224, s101, s101
    v_rcp_f16 v223, v222
    v_rcp_f16_e64 v225, v224
    v_mfma_f32_32x32x16_bf16 v[112:127], a[244:247], a[220:223], v[112:127]
    buffer_load_dwordx4 v240, s[12:15], s40 offen offset:0  lds
    ds_read_b128 a[228:231], v9 offset:30720
    v_rcp_f16_sdwa v222, v222 dst_sel:WORD_0 dst_unused:UNUSED_PAD src0_sel:WORD_1
    v_rcp_f16_sdwa v224, v224 dst_sel:WORD_0 dst_unused:UNUSED_PAD src0_sel:WORD_1
    v_mfma_f32_32x32x16_bf16 v[128:143], a[248:251], a[220:223], v[128:143]
    ds_read_b64_tr_b16 a[176:177], v1 offset:4096
    ds_read_b64_tr_b16 a[200:201], v1 offset:16384
    v_fma_mix_f32 v223, v200, v223, 0 op_sel_hi:[0,1,0]
    v_fma_mix_f32 v225, v202, v225, 0 op_sel_hi:[0,1,0]
    v_fma_mix_f32 v222, v201, v222, 0 op_sel_hi:[0,1,0]
    v_fma_mix_f32 v224, v203, v224, 0 op_sel_hi:[0,1,0]
    v_cvt_pk_bf16_f32 v214, v223, v222
    v_mfma_f32_32x32x16_bf16 v[144:159], a[252:255], a[220:223], v[144:159]
    s_waitcnt lgkmcnt(3)
    ds_read_b64_tr_b16 a[178:179], v1 offset:4608
    ds_read_b64_tr_b16 a[202:203], v1 offset:16896
    v_cvt_pk_bf16_f32 v215, v225, v224
    v_cvt_pk_f16_f32 v218, v172, v173
    v_cvt_pk_f16_f32 v220, v174, v175
    v_pk_fma_f16 v219, v218, v218, s36
    v_pk_fma_f16 v221, v220, v220, s36
    v_mfma_f32_32x32x16_bf16 v[16:31], a[232:235], a[224:227], v[16:31]
    s_nop 0
    buffer_load_dwordx4 v240, s[12:15], s40 offen offset:3072  lds
    ds_read_b128 a[216:219], v9 offset:34816
    v_pk_mul_f16 v219, v219, v218
    v_pk_mul_f16 v221, v221, v220
    v_exp_f16 v218, v219
    v_mfma_f32_32x32x16_bf16 v[32:47], a[236:239], a[224:227], v[32:47]
    ds_write_b128 v10, v[212:215] offset:5120
    v_exp_f16_e64 v220, v221
    v_mfma_f32_32x32x16_bf16 v[48:63], a[240:243], a[224:227], v[48:63]
    s_waitcnt lgkmcnt(6)
    v_exp_f16_sdwa v218, v219 dst_sel:WORD_1 dst_unused:UNUSED_PRESERVE src0_sel:WORD_1
    v_exp_f16_sdwa v220, v221 dst_sel:WORD_1 dst_unused:UNUSED_PRESERVE src0_sel:WORD_1
    v_pk_fma_f16 v218, v218, s101, s101
    v_pk_fma_f16 v220, v220, s101, s101
    v_mfma_f32_32x32x16_bf16 v[96:111], a[240:243], a[228:231], v[96:111]
    v_rcp_f16_e64 v219, v218
    v_rcp_f16_e64 v221, v220
    v_rcp_f16_sdwa v218, v218 dst_sel:WORD_0 dst_unused:UNUSED_PAD src0_sel:WORD_1
    v_mfma_f32_32x32x16_bf16 v[80:95], a[236:239], a[228:231], v[80:95]
    s_add_u32 m0, s41, 2048
    ds_read_b64_tr_b16 a[180:181], v1 offset:6144
    ds_read_b64_tr_b16 a[204:205], v1 offset:18432
    v_rcp_f16_sdwa v220, v220 dst_sel:WORD_0 dst_unused:UNUSED_PAD src0_sel:WORD_1
    v_fma_mix_f32 v219, v172, v219, 0 op_sel_hi:[0,1,0]
    v_fma_mix_f32 v221, v174, v221, 0 op_sel_hi:[0,1,0]
    v_fma_mix_f32 v218, v173, v218, 0 op_sel_hi:[0,1,0]
    v_mfma_f32_32x32x16_bf16 v[64:79], a[232:235], a[228:231], v[64:79]
    s_waitcnt lgkmcnt(3)
    buffer_load_dwordx4 v241, s[12:15], s40 offen offset:0  lds
    v_fma_mix_f32 v220, v175, v220, 0 op_sel_hi:[0,1,0]
    v_cvt_pk_bf16_f32 v208, v219, v218
    v_cvt_pk_bf16_f32 v209, v221, v220
    v_cvt_pk_f16_f32 v222, v176, v177
    v_cvt_pk_f16_f32 v224, v178, v179
    v_mfma_f32_32x32x16_bf16 v[112:127], a[232:235], a[216:219], v[112:127]
    s_nop 0
    ds_read_b64_tr_b16 a[182:183], v1 offset:6656
    ds_read_b64_tr_b16 a[206:207], v1 offset:18944
    v_pk_fma_f16 v223, v222, v222, s36
    v_pk_fma_f16 v225, v224, v224, s36
    v_pk_mul_f16 v223, v223, v222
    v_pk_mul_f16 v225, v225, v224
    v_mfma_f32_32x32x16_bf16 v[128:143], a[236:239], a[216:219], v[128:143]
    ds_read_b64_tr_b16 a[184:185], v1 offset:8192
    ds_read_b64_tr_b16 a[208:209], v1 offset:20480
    v_exp_f16_e64 v222, v223
    v_exp_f16_e64 v224, v225
    v_mfma_f32_32x32x16_bf16 v[144:159], a[240:243], a[216:219], v[144:159]
    ds_read_b64_tr_b16 a[188:189], v1 offset:10240
    ds_read_b64_tr_b16 a[210:211], v1 offset:20992
    v_exp_f16_sdwa v222, v223 dst_sel:WORD_1 dst_unused:UNUSED_PRESERVE src0_sel:WORD_1
    v_exp_f16_sdwa v224, v225 dst_sel:WORD_1 dst_unused:UNUSED_PRESERVE src0_sel:WORD_1
    v_pk_fma_f16 v222, v222, s101, s101
    v_mfma_f32_32x32x16_bf16 v[188:203], a[168:171], a[0:3], 0
    ds_read_b64_tr_b16 a[192:193], v1 offset:12288
    ds_read_b64_tr_b16 a[212:213], v1 offset:22528
    v_pk_fma_f16 v224, v224, s101, s101
    v_rcp_f16_e64 v223, v222
    v_rcp_f16_e64 v225, v224
    v_mfma_f32_32x32x16_bf16 v[188:203], a[172:175], a[4:7], v[188:203]
    s_nop 0
    ds_read_b64_tr_b16 a[196:197], v1 offset:14336
    ds_read_b64_tr_b16 a[214:215], v1 offset:23040
    v_rcp_f16_sdwa v222, v222 dst_sel:WORD_0 dst_unused:UNUSED_PAD src0_sel:WORD_1
    v_rcp_f16_sdwa v224, v224 dst_sel:WORD_0 dst_unused:UNUSED_PAD src0_sel:WORD_1
    v_fma_mix_f32 v223, v176, v223, 0 op_sel_hi:[0,1,0]
    v_mfma_f32_32x32x16_bf16 v[188:203], a[176:179], a[8:11], v[188:203]
    s_waitcnt lgkmcnt(5)
    buffer_load_dwordx4 v241, s[12:15], s40 offen offset:3072  lds
    ds_read_b64_tr_b16 a[244:245], v3 offset:43008
    v_fma_mix_f32 v225, v178, v225, 0 op_sel_hi:[0,1,0]
    v_fma_mix_f32 v222, v177, v222, 0 op_sel_hi:[0,1,0]
    v_fma_mix_f32 v224, v179, v224, 0 op_sel_hi:[0,1,0]
    v_cvt_pk_bf16_f32 v210, v223, v222
    v_mfma_f32_32x32x16_bf16 v[188:203], a[180:183], a[12:15], v[188:203]
    ds_read_b64_tr_b16 a[246:247], v3 offset:46080
    ds_read_b128 a[220:223], v9 offset:27648
    v_cvt_pk_bf16_f32 v211, v225, v224
    v_cvt_pk_f16_f32 v218, v180, v181
    v_cvt_pk_f16_f32 v220, v182, v183
    v_pk_fma_f16 v219, v218, v218, s36
    v_pk_fma_f16 v221, v220, v220, s36
    v_mfma_f32_32x32x16_bf16 v[188:203], a[184:187], a[16:19], v[188:203]
    ds_write_b128 v10, v[208:211] offset:8192
    v_pk_mul_f16 v219, v219, v218
    v_pk_mul_f16 v221, v221, v220
    v_mfma_f32_32x32x16_bf16 v[188:203], a[188:191], a[20:23], v[188:203]
    s_waitcnt lgkmcnt(4)
    v_exp_f16 v218, v219
    v_exp_f16_e64 v220, v221
    v_exp_f16_sdwa v218, v219 dst_sel:WORD_1 dst_unused:UNUSED_PRESERVE src0_sel:WORD_1
    v_mfma_f32_32x32x16_bf16 v[188:203], a[192:195], a[24:27], v[188:203]
    v_exp_f16_sdwa v220, v221 dst_sel:WORD_1 dst_unused:UNUSED_PRESERVE src0_sel:WORD_1
    v_pk_fma_f16 v218, v218, s101, s101
    v_pk_fma_f16 v220, v220, s101, s101
    v_rcp_f16_e64 v219, v218
    v_mfma_f32_32x32x16_bf16 v[188:203], a[196:199], a[28:31], v[188:203]
    ds_read_b64_tr_b16 a[248:249], v4 offset:43008
    ds_read_b64_tr_b16 a[250:251], v4 offset:46080
    v_rcp_f16_e64 v221, v220
    v_rcp_f16_sdwa v218, v218 dst_sel:WORD_0 dst_unused:UNUSED_PAD src0_sel:WORD_1
    v_rcp_f16_sdwa v220, v220 dst_sel:WORD_0 dst_unused:UNUSED_PAD src0_sel:WORD_1
    v_mfma_f32_32x32x16_bf16 v[188:203], a[200:203], a[32:35], v[188:203]
    ds_read_b64_tr_b16 a[252:253], v5 offset:43008
    ds_read_b64_tr_b16 a[254:255], v5 offset:46080
    v_fma_mix_f32 v219, v180, v219, 0 op_sel_hi:[0,1,0]
    v_fma_mix_f32 v221, v182, v221, 0 op_sel_hi:[0,1,0]
    v_fma_mix_f32 v218, v181, v218, 0 op_sel_hi:[0,1,0]
    v_fma_mix_f32 v220, v183, v220, 0 op_sel_hi:[0,1,0]
    v_cvt_pk_bf16_f32 v212, v219, v218
    v_mfma_f32_32x32x16_bf16 v[188:203], a[204:207], a[36:39], v[188:203]
    ds_read_b128 a[224:227], v9 offset:31744
    v_cvt_pk_bf16_f32 v213, v221, v220
    v_cvt_pk_f16_f32 v222, v184, v185
    v_cvt_pk_f16_f32 v224, v186, v187
    v_pk_fma_f16 v223, v222, v222, s36
    v_pk_fma_f16 v225, v224, v224, s36
    v_pk_mul_f16 v223, v223, v222
    v_mfma_f32_32x32x16_bf16 v[188:203], a[208:211], a[40:43], v[188:203]
    v_pk_mul_f16 v225, v225, v224
    v_exp_f16 v222, v223
    v_exp_f16_e64 v224, v225
    v_exp_f16_sdwa v222, v223 dst_sel:WORD_1 dst_unused:UNUSED_PRESERVE src0_sel:WORD_1
    v_mfma_f32_32x32x16_bf16 v[188:203], a[212:215], a[44:47], v[188:203]
    s_waitcnt lgkmcnt(1)
    v_exp_f16_sdwa v224, v225 dst_sel:WORD_1 dst_unused:UNUSED_PRESERVE src0_sel:WORD_1
    v_pk_fma_f16 v222, v222, s101, s101
    v_pk_fma_f16 v224, v224, s101, s101
    v_rcp_f16 v223, v222
    v_mfma_f32_32x32x16_bf16 v[16:31], a[244:247], a[220:223], v[16:31]
    ds_read_b128 a[228:231], v9 offset:35840
    v_rcp_f16_e64 v225, v224
    v_rcp_f16_sdwa v222, v222 dst_sel:WORD_0 dst_unused:UNUSED_PAD src0_sel:WORD_1
    v_rcp_f16_sdwa v224, v224 dst_sel:WORD_0 dst_unused:UNUSED_PAD src0_sel:WORD_1
    v_mfma_f32_32x32x16_bf16 v[32:47], a[248:251], a[220:223], v[32:47]
    v_fma_mix_f32 v223, v184, v223, 0 op_sel_hi:[0,1,0]
    v_fma_mix_f32 v225, v186, v225, 0 op_sel_hi:[0,1,0]
    v_fma_mix_f32 v222, v185, v222, 0 op_sel_hi:[0,1,0]
    v_fma_mix_f32 v224, v187, v224, 0 op_sel_hi:[0,1,0]
    v_cvt_pk_bf16_f32 v214, v223, v222
    v_cvt_pk_bf16_f32 v215, v225, v224
    v_cvt_pk_f16_f32 v218, v188, v189
    v_mfma_f32_32x32x16_bf16 v[48:63], a[252:255], a[220:223], v[48:63]
    s_waitcnt lgkmcnt(1)
    ds_write_b128 v10, v[212:215] offset:9216
    v_cvt_pk_f16_f32 v220, v190, v191
    v_pk_fma_f16 v219, v218, v218, s36
    v_mfma_f32_32x32x16_bf16 v[96:111], a[252:255], a[224:227], v[96:111]
    s_add_u32 s39, s39, 128
    v_pk_fma_f16 v221, v220, v220, s36
    v_pk_mul_f16 v219, v219, v218
    v_pk_mul_f16 v221, v221, v220
    v_exp_f16_e64 v218, v219
    v_exp_f16_e64 v220, v221
    v_mfma_f32_32x32x16_bf16 v[80:95], a[248:251], a[224:227], v[80:95]
    s_add_u32 s100, s100, 128
    v_exp_f16_sdwa v218, v219 dst_sel:WORD_1 dst_unused:UNUSED_PRESERVE src0_sel:WORD_1
    v_exp_f16_sdwa v220, v221 dst_sel:WORD_1 dst_unused:UNUSED_PRESERVE src0_sel:WORD_1
    v_pk_fma_f16 v218, v218, s101, s101
    v_pk_fma_f16 v220, v220, s101, s101
    v_rcp_f16_e64 v219, v218
    v_mfma_f32_32x32x16_bf16 v[64:79], a[244:247], a[224:227], v[64:79]
    s_waitcnt lgkmcnt(1)
    v_rcp_f16_e64 v221, v220
    v_rcp_f16_sdwa v218, v218 dst_sel:WORD_0 dst_unused:UNUSED_PAD src0_sel:WORD_1
    v_rcp_f16_sdwa v220, v220 dst_sel:WORD_0 dst_unused:UNUSED_PAD src0_sel:WORD_1
    v_fma_mix_f32 v219, v188, v219, 0 op_sel_hi:[0,1,0]
    v_mfma_f32_32x32x16_bf16 v[112:127], a[244:247], a[228:231], v[112:127]
    s_cmp_eq_u32 s38, 1
    s_cselect_b32 s57, 294912, 0
    v_fma_mix_f32 v221, v190, v221, 0 op_sel_hi:[0,1,0]
    v_fma_mix_f32 v218, v189, v218, 0 op_sel_hi:[0,1,0]
    v_fma_mix_f32 v220, v191, v220, 0 op_sel_hi:[0,1,0]
    v_cvt_pk_bf16_f32 v208, v219, v218
    v_cvt_pk_bf16_f32 v209, v221, v220
    v_cvt_pk_f16_f32 v222, v192, v193
    v_cvt_pk_f16_f32 v224, v194, v195
    v_mfma_f32_32x32x16_bf16 v[128:143], a[248:251], a[228:231], v[128:143]
    s_sub_u32 s57, 24576, s57
    v_pk_fma_f16 v223, v222, v222, s36
    v_pk_fma_f16 v225, v224, v224, s36
    v_pk_mul_f16 v223, v223, v222
    v_pk_mul_f16 v225, v225, v224
    v_exp_f16 v222, v223
    v_mfma_f32_32x32x16_bf16 v[144:159], a[252:255], a[228:231], v[144:159]
    s_add_u32 s40, s40, s57
    v_exp_f16_e64 v224, v225
    v_exp_f16_sdwa v222, v223 dst_sel:WORD_1 dst_unused:UNUSED_PRESERVE src0_sel:WORD_1
    v_exp_f16_sdwa v224, v225 dst_sel:WORD_1 dst_unused:UNUSED_PRESERVE src0_sel:WORD_1
    v_pk_fma_f16 v222, v222, s101, s101
    s_waitcnt vmcnt(0) lgkmcnt(0)
    s_barrier
    v_mfma_f32_32x32x16_bf16 v[172:187], a[168:171], a[48:51], 0
    s_mul_i32 s33, s3, 49152
    v_mov_b32 v251, 256
    v_pk_fma_f16 v224, v224, s101, s101
    v_rcp_f16_e64 v223, v222
    v_rcp_f16_e64 v225, v224
    v_mfma_f32_32x32x16_bf16 v[172:187], a[172:175], a[52:55], v[172:187]
    s_add_u32 m0, s41, 101888
    buffer_atomic_add v251, v250, s[20:23], 0 offen sc1
    buffer_load_dwordx4 v13, s[8:11], s39 offen offset:0  lds
    v_mfma_f32_32x32x16_bf16 v[172:187], a[176:179], a[56:59], v[172:187]
    s_lshl_b32 s34, s38, 2
    ds_read_b64_tr_b16 a[232:233], v3 offset:0
    v_rcp_f16_sdwa v222, v222 dst_sel:WORD_0 dst_unused:UNUSED_PAD src0_sel:WORD_1
    v_rcp_f16_sdwa v224, v224 dst_sel:WORD_0 dst_unused:UNUSED_PAD src0_sel:WORD_1
    v_fma_mix_f32 v223, v192, v223, 0 op_sel_hi:[0,1,0]
    v_fma_mix_f32 v225, v194, v225, 0 op_sel_hi:[0,1,0]
    v_mfma_f32_32x32x16_bf16 v[172:187], a[180:183], a[60:63], v[172:187]
    s_add_u32 s34, s34, s28
    ds_read_b64_tr_b16 a[234:235], v3 offset:3072
    ds_read_b128 a[216:219], v9 offset:0
    v_fma_mix_f32 v222, v193, v222, 0 op_sel_hi:[0,1,0]
    v_fma_mix_f32 v224, v195, v224, 0 op_sel_hi:[0,1,0]
    v_cvt_pk_bf16_f32 v210, v223, v222
    v_cvt_pk_bf16_f32 v211, v225, v224
    v_cvt_pk_f16_f32 v218, v196, v197
    v_mfma_f32_32x32x16_bf16 v[172:187], a[184:187], a[64:67], v[172:187]
    s_mul_i32 s34, s34, 768
    ds_write_b128 v10, v[208:211] offset:24576
    v_cvt_pk_f16_f32 v220, v198, v199
    v_pk_fma_f16 v219, v218, v218, s36
    v_mfma_f32_32x32x16_bf16 v[172:187], a[188:191], a[68:71], v[172:187]
    s_add_u32 s33, s33, s34
    buffer_load_dwordx4 v14, s[8:11], s39 offen offset:1024  lds
    v_pk_fma_f16 v221, v220, v220, s36
    v_pk_mul_f16 v219, v219, v218
    v_pk_mul_f16 v221, v221, v220
    v_exp_f16 v218, v219
    v_mfma_f32_32x32x16_bf16 v[172:187], a[192:195], a[72:75], v[172:187]
    s_add_u32 s48, s33, 393216
    v_exp_f16_e64 v220, v221
    v_exp_f16_sdwa v218, v219 dst_sel:WORD_1 dst_unused:UNUSED_PRESERVE src0_sel:WORD_1
    v_exp_f16_sdwa v220, v221 dst_sel:WORD_1 dst_unused:UNUSED_PRESERVE src0_sel:WORD_1
    v_pk_fma_f16 v218, v218, s101, s101
    v_mfma_f32_32x32x16_bf16 v[172:187], a[196:199], a[76:79], v[172:187]
    s_add_u32 s49, s33, 405504
    ds_read_b64_tr_b16 a[236:237], v4 offset:0
    ds_read_b64_tr_b16 a[238:239], v4 offset:3072
    v_pk_fma_f16 v220, v220, s101, s101
    v_rcp_f16_e64 v219, v218
    v_rcp_f16_e64 v221, v220
    v_mfma_f32_32x32x16_bf16 v[172:187], a[200:203], a[80:83], v[172:187]
    s_add_u32 s50, s33, 417792
L_pg11:
    s_cbranch_execz L_wu2
    ds_read_b64_tr_b16 a[240:241], v5 offset:0
    ds_read_b64_tr_b16 a[242:243], v5 offset:3072
    v_rcp_f16_sdwa v218, v218 dst_sel:WORD_0 dst_unused:UNUSED_PAD src0_sel:WORD_1
    v_rcp_f16_sdwa v220, v220 dst_sel:WORD_0 dst_unused:UNUSED_PAD src0_sel:WORD_1
    v_fma_mix_f32 v219, v196, v219, 0 op_sel_hi:[0,1,0]
    v_mfma_f32_32x32x16_bf16 v[172:187], a[204:207], a[84:87], v[172:187]
    s_add_u32 s51, s33, 430080
    ds_read_b128 a[220:223], v9 offset:4096
    v_fma_mix_f32 v221, v198, v221, 0 op_sel_hi:[0,1,0]
    v_fma_mix_f32 v218, v197, v218, 0 op_sel_hi:[0,1,0]
    v_fma_mix_f32 v220, v199, v220, 0 op_sel_hi:[0,1,0]
    v_cvt_pk_bf16_f32 v212, v219, v218
    v_cvt_pk_bf16_f32 v213, v221, v220
    v_cvt_pk_f16_f32 v222, v200, v201
    v_mfma_f32_32x32x16_bf16 v[172:187], a[208:211], a[88:91], v[172:187]
    s_mul_i32 s33, s29, 602112
    buffer_load_dwordx4 v254, s[8:11], s39 offen offset:2048  lds
    v_cvt_pk_f16_f32 v224, v202, v203
    v_pk_fma_f16 v223, v222, v222, s36
    v_pk_fma_f16 v225, v224, v224, s36
    v_pk_mul_f16 v223, v223, v222
    v_pk_mul_f16 v225, v225, v224
    v_mfma_f32_32x32x16_bf16 v[172:187], a[212:215], a[92:95], v[172:187]
    s_waitcnt lgkmcnt(1)
    v_exp_f16 v222, v223
    v_exp_f16 v224, v225
    v_exp_f16_sdwa v222, v223 dst_sel:WORD_1 dst_unused:UNUSED_PRESERVE src0_sel:WORD_1
    v_mfma_f32_32x32x16_bf16 v[16:31], a[232:235], a[216:219], v[16:31]
    s_mul_i32 s34, s30, 384
    ds_read_b128 a[224:227], v9 offset:8192
    v_exp_f16_sdwa v224, v225 dst_sel:WORD_1 dst_unused:UNUSED_PRESERVE src0_sel:WORD_1
    v_pk_fma_f16 v222, v222, s101, s101
    v_pk_fma_f16 v224, v224, s101, s101
    v_rcp_f16_e64 v223, v222
    v_mfma_f32_32x32x16_bf16 v[32:47], a[236:239], a[216:219], v[32:47]
    s_add_u32 s33, s33, s34
    v_rcp_f16_e64 v225, v224
    v_rcp_f16_sdwa v222, v222 dst_sel:WORD_0 dst_unused:UNUSED_PAD src0_sel:WORD_1
    v_rcp_f16_sdwa v224, v224 dst_sel:WORD_0 dst_unused:UNUSED_PAD src0_sel:WORD_1
    v_fma_mix_f32 v223, v200, v223, 0 op_sel_hi:[0,1,0]
    v_mfma_f32_32x32x16_bf16 v[48:63], a[240:243], a[216:219], v[48:63]
    s_waitcnt lgkmcnt(1)
    v_fma_mix_f32 v225, v202, v225, 0 op_sel_hi:[0,1,0]
    v_fma_mix_f32 v222, v201, v222, 0 op_sel_hi:[0,1,0]
    v_fma_mix_f32 v224, v203, v224, 0 op_sel_hi:[0,1,0]
    v_cvt_pk_bf16_f32 v214, v223, v222
    v_cvt_pk_bf16_f32 v215, v225, v224
    v_cvt_pk_f16_f32 v218, v172, v173
    v_cvt_pk_f16_f32 v220, v174, v175
    v_mfma_f32_32x32x16_bf16 v[96:111], a[240:243], a[220:223], v[96:111]
    s_add_u32 s33, s33, s43
    ds_write_b128 v10, v[212:215] offset:25600
    v_pk_fma_f16 v219, v218, v218, s36
    v_pk_fma_f16 v221, v220, v220, s36
    v_mfma_f32_32x32x16_bf16 v[80:95], a[236:239], a[220:223], v[80:95]
    s_add_u32 s52, s33, 520704
    v_pk_mul_f16 v219, v219, v218
    v_pk_mul_f16 v221, v221, v220
    v_exp_f16 v218, v219
    v_exp_f16 v220, v221
    v_mfma_f32_32x32x16_bf16 v[64:79], a[232:235], a[220:223], v[64:79]
    s_waitcnt lgkmcnt(1)
    v_exp_f16_sdwa v218, v219 dst_sel:WORD_1 dst_unused:UNUSED_PRESERVE src0_sel:WORD_1
    v_exp_f16_sdwa v220, v221 dst_sel:WORD_1 dst_unused:UNUSED_PRESERVE src0_sel:WORD_1
    v_pk_fma_f16 v218, v218, s101, s101
    v_pk_fma_f16 v220, v220, s101, s101
    v_mfma_f32_32x32x16_bf16 v[112:127], a[232:235], a[224:227], v[112:127]
    s_mul_i32 s53, s28, 15360
    buffer_load_dwordx4 v255, s[8:11], s39 offen offset:3072  lds
    v_rcp_f16 v219, v218
    v_rcp_f16 v221, v220
    v_mfma_f32_32x32x16_bf16 v[128:143], a[236:239], a[224:227], v[128:143]
    s_add_u32 m0, s41, 105984
    v_rcp_f16_sdwa v218, v218 dst_sel:WORD_0 dst_unused:UNUSED_PAD src0_sel:WORD_1
    v_rcp_f16_sdwa v220, v220 dst_sel:WORD_0 dst_unused:UNUSED_PAD src0_sel:WORD_1
    v_fma_mix_f32 v219, v172, v219, 0 op_sel_hi:[0,1,0]
    v_fma_mix_f32 v221, v174, v221, 0 op_sel_hi:[0,1,0]
    v_fma_mix_f32 v218, v173, v218, 0 op_sel_hi:[0,1,0]
    v_mfma_f32_32x32x16_bf16 v[144:159], a[240:243], a[224:227], v[144:159]
    s_add_u32 s53, s53, 101888
    buffer_load_dwordx4 v13, s[8:11], s100 offen offset:0  lds
    v_fma_mix_f32 v220, v175, v220, 0 op_sel_hi:[0,1,0]
    v_cvt_pk_bf16_f32 v208, v219, v218
    v_cvt_pk_bf16_f32 v209, v221, v220
    v_cvt_pk_f16_f32 v222, v176, v177
    v_cvt_pk_f16_f32 v224, v178, v179
    v_mfma_f32_32x32x16_bf16 v[188:203], a[168:171], a[96:99], 0
    s_movk_i32 s31, 384
    ds_read_b64_tr_b16 a[168:169], v1 offset:24576
    v_pk_fma_f16 v223, v222, v222, s36
    v_pk_fma_f16 v225, v224, v224, s36
    v_pk_mul_f16 v223, v223, v222
    v_pk_mul_f16 v225, v225, v224
    v_exp_f16 v222, v223
    v_mfma_f32_32x32x16_bf16 v[188:203], a[172:175], a[100:103], v[188:203]
    s_mul_i32 s34, s29, 602112
    ds_read_b64_tr_b16 a[170:171], v1 offset:25088
    v_exp_f16_e64 v224, v225
    v_exp_f16_sdwa v222, v223 dst_sel:WORD_1 dst_unused:UNUSED_PRESERVE src0_sel:WORD_1
    v_exp_f16_sdwa v224, v225 dst_sel:WORD_1 dst_unused:UNUSED_PRESERVE src0_sel:WORD_1
    v_mfma_f32_32x32x16_bf16 v[188:203], a[176:179], a[104:107], v[188:203]
    s_mul_i32 s35, s30, 192
    ds_read_b64_tr_b16 a[244:245], v3 offset:6144
    v_pk_fma_f16 v222, v222, s101, s101
    v_pk_fma_f16 v224, v224, s101, s101
    v_rcp_f16_e64 v223, v222
    v_rcp_f16_e64 v225, v224
    v_mfma_f32_32x32x16_bf16 v[188:203], a[180:183], a[108:111], v[188:203]
    s_add_u32 s34, s34, s35
    ds_read_b64_tr_b16 a[246:247], v3 offset:9216
    ds_read_b128 a[228:231], v9 offset:1024
    v_rcp_f16_sdwa v222, v222 dst_sel:WORD_0 dst_unused:UNUSED_PAD src0_sel:WORD_1
    v_rcp_f16_sdwa v224, v224 dst_sel:WORD_0 dst_unused:UNUSED_PAD src0_sel:WORD_1
    v_fma_mix_f32 v223, v176, v223, 0 op_sel_hi:[0,1,0]
    v_mfma_f32_32x32x16_bf16 v[188:203], a[184:187], a[112:115], v[188:203]
    s_add_u32 s96, s43, s34
    buffer_load_dwordx4 v14, s[8:11], s100 offen offset:1024  lds
    ds_read_b64_tr_b16 a[248:249], v4 offset:6144
    ds_read_b64_tr_b16 a[250:251], v4 offset:9216
    v_fma_mix_f32 v225, v178, v225, 0 op_sel_hi:[0,1,0]
    v_fma_mix_f32 v222, v177, v222, 0 op_sel_hi:[0,1,0]
    v_fma_mix_f32 v224, v179, v224, 0 op_sel_hi:[0,1,0]
    v_mfma_f32_32x32x16_bf16 v[188:203], a[188:191], a[116:119], v[188:203]
    ds_read_b64_tr_b16 a[252:253], v5 offset:6144
    ds_read_b64_tr_b16 a[254:255], v5 offset:9216
    v_cvt_pk_bf16_f32 v210, v223, v222
    v_cvt_pk_bf16_f32 v211, v225, v224
    v_cvt_pk_f16_f32 v218, v180, v181
    v_cvt_pk_f16_f32 v220, v182, v183
    v_pk_fma_f16 v219, v218, v218, s36
    v_mfma_f32_32x32x16_bf16 v[188:203], a[192:195], a[120:123], v[188:203]
    ds_write_b128 v10, v[208:211] offset:28672
    v_pk_fma_f16 v221, v220, v220, s36
    v_pk_mul_f16 v219, v219, v218
    v_mfma_f32_32x32x16_bf16 v[188:203], a[196:199], a[124:127], v[188:203]
    v_pk_mul_f16 v221, v221, v220
    v_exp_f16_e64 v218, v219
    v_exp_f16_e64 v220, v221
    v_exp_f16_sdwa v218, v219 dst_sel:WORD_1 dst_unused:UNUSED_PRESERVE src0_sel:WORD_1
    v_mfma_f32_32x32x16_bf16 v[188:203], a[200:203], a[128:131], v[188:203]
    v_exp_f16_sdwa v220, v221 dst_sel:WORD_1 dst_unused:UNUSED_PRESERVE src0_sel:WORD_1
    v_pk_fma_f16 v218, v218, s101, s101
    v_pk_fma_f16 v220, v220, s101, s101
    v_rcp_f16_e64 v219, v218
    v_mfma_f32_32x32x16_bf16 v[188:203], a[204:207], a[132:135], v[188:203]
    s_add_u32 m0, s41, 24576
    ds_read_b128 a[216:219], v9 offset:5120
    ds_read_b64_tr_b16 a[184:185], v1 offset:32768
    v_rcp_f16_e64 v221, v220
    v_rcp_f16_sdwa v218, v218 dst_sel:WORD_0 dst_unused:UNUSED_PAD src0_sel:WORD_1
    v_mfma_f32_32x32x16_bf16 v[188:203], a[208:211], a[136:139], v[188:203]
    s_nop 0
    buffer_load_dwordx4 v15, s[12:15], s40 offen offset:0  lds
    v_rcp_f16_sdwa v220, v220 dst_sel:WORD_0 dst_unused:UNUSED_PAD src0_sel:WORD_1
    v_fma_mix_f32 v219, v180, v219, 0 op_sel_hi:[0,1,0]
    v_fma_mix_f32 v221, v182, v221, 0 op_sel_hi:[0,1,0]
    v_fma_mix_f32 v218, v181, v218, 0 op_sel_hi:[0,1,0]
    v_mfma_f32_32x32x16_bf16 v[188:203], a[212:215], a[140:143], v[188:203]
    s_waitcnt lgkmcnt(3)
    ds_read_b64_tr_b16 a[172:173], v1 offset:26624
    ds_read_b64_tr_b16 a[186:187], v1 offset:33280
    ds_read_b64_tr_b16 a[212:213], v1 offset:47104
    ds_read_b64_tr_b16 a[214:215], v1 offset:47616
    v_fma_mix_f32 v220, v183, v220, 0 op_sel_hi:[0,1,0]
    v_cvt_pk_bf16_f32 v212, v219, v218
    v_cvt_pk_bf16_f32 v213, v221, v220
    v_mfma_f32_32x32x16_bf16 v[16:31], a[244:247], a[228:231], v[16:31]
    ds_read_b128 a[220:223], v9 offset:9216
    ds_read_b64_tr_b16 a[190:191], v1 offset:35328
    v_cvt_pk_f16_f32 v222, v184, v185
    v_cvt_pk_f16_f32 v224, v186, v187
    v_pk_fma_f16 v223, v222, v222, s36
    v_pk_fma_f16 v225, v224, v224, s36
    v_pk_mul_f16 v223, v223, v222
    v_mfma_f32_32x32x16_bf16 v[32:47], a[248:251], a[228:231], v[32:47]
    ds_read_b64_tr_b16 a[174:175], v1 offset:27136
    ds_read_b64_tr_b16 a[194:195], v1 offset:37376
    v_pk_mul_f16 v225, v225, v224
    v_exp_f16 v222, v223
    v_exp_f16_e64 v224, v225
    v_mfma_f32_32x32x16_bf16 v[48:63], a[252:255], a[228:231], v[48:63]
    s_waitcnt lgkmcnt(9)
    buffer_load_dwordx4 v15, s[12:15], s40 offen offset:3072  lds
    ds_read_b64_tr_b16 a[232:233], v3 offset:12288
    v_exp_f16_sdwa v222, v223 dst_sel:WORD_1 dst_unused:UNUSED_PRESERVE src0_sel:WORD_1
    v_exp_f16_sdwa v224, v225 dst_sel:WORD_1 dst_unused:UNUSED_PRESERVE src0_sel:WORD_1
    v_mfma_f32_32x32x16_bf16 v[96:111], a[252:255], a[216:219], v[96:111]
    ds_read_b64_tr_b16 a[234:235], v3 offset:15360
    ds_read_b128 a[224:227], v9 offset:2048
    v_pk_fma_f16 v222, v222, s101, s101
    v_pk_fma_f16 v224, v224, s101, s101
    v_rcp_f16_e64 v223, v222
    v_mfma_f32_32x32x16_bf16 v[80:95], a[248:251], a[216:219], v[80:95]
    ds_read_b64_tr_b16 a[236:237], v4 offset:12288
    ds_read_b64_tr_b16 a[238:239], v4 offset:15360
    v_rcp_f16 v225, v224
    v_rcp_f16_sdwa v222, v222 dst_sel:WORD_0 dst_unused:UNUSED_PAD src0_sel:WORD_1
    v_mfma_f32_32x32x16_bf16 v[64:79], a[244:247], a[216:219], v[64:79]
    s_waitcnt lgkmcnt(8)
    ds_read_b64_tr_b16 a[240:241], v5 offset:12288
    ds_read_b64_tr_b16 a[242:243], v5 offset:15360
    v_rcp_f16_sdwa v224, v224 dst_sel:WORD_0 dst_unused:UNUSED_PAD src0_sel:WORD_1
    v_fma_mix_f32 v223, v184, v223, 0 op_sel_hi:[0,1,0]
    v_fma_mix_f32 v225, v186, v225, 0 op_sel_hi:[0,1,0]
    v_fma_mix_f32 v222, v185, v222, 0 op_sel_hi:[0,1,0]
    v_mfma_f32_32x32x16_bf16 v[112:127], a[244:247], a[220:223], v[112:127]
    ds_read_b128 a[228:231], v9 offset:6144
    ds_read_b128 a[216:219], v9 offset:10240
    v_fma_mix_f32 v224, v187, v224, 0 op_sel_hi:[0,1,0]
    v_cvt_pk_bf16_f32 v214, v223, v222
    v_cvt_pk_bf16_f32 v215, v225, v224
    v_cvt_pk_f16_f32 v218, v188, v189
    v_cvt_pk_f16_f32 v220, v190, v191
    v_mfma_f32_32x32x16_bf16 v[128:143], a[248:251], a[220:223], v[128:143]
    ds_write_b128 v10, v[212:215] offset:29696
    v_pk_fma_f16 v219, v218, v218, s36
    v_pk_fma_f16 v221, v220, v220, s36
    v_mfma_f32_32x32x16_bf16 v[144:159], a[252:255], a[220:223], v[144:159]
    s_waitcnt lgkmcnt(3)
    v_pk_mul_f16 v219, v219, v218
    v_pk_mul_f16 v221, v221, v220
    v_exp_f16 v218, v219
    v_exp_f16_e64 v220, v221
    v_mfma_f32_32x32x16_bf16 v[16:31], a[232:235], a[224:227], v[16:31]
    s_add_u32 m0, s41, 25600
    v_exp_f16_sdwa v218, v219 dst_sel:WORD_1 dst_unused:UNUSED_PRESERVE src0_sel:WORD_1
    v_exp_f16_sdwa v220, v221 dst_sel:WORD_1 dst_unused:UNUSED_PRESERVE src0_sel:WORD_1
    v_pk_fma_f16 v218, v218, s101, s101
    v_pk_fma_f16 v220, v220, s101, s101
    v_mfma_f32_32x32x16_bf16 v[32:47], a[236:239], a[224:227], v[32:47]
    buffer_load_dwordx4 v240, s[12:15], s40 offen offset:0  lds
    v_rcp_f16 v219, v218
    v_rcp_f16_e64 v221, v220
    v_mfma_f32_32x32x16_bf16 v[48:63], a[240:243], a[224:227], v[48:63]
    s_waitcnt lgkmcnt(1)
    buffer_load_dwordx4 v240, s[12:15], s40 offen offset:3072  lds
    v_rcp_f16_sdwa v218, v218 dst_sel:WORD_0 dst_unused:UNUSED_PAD src0_sel:WORD_1
    v_rcp_f16_sdwa v220, v220 dst_sel:WORD_0 dst_unused:UNUSED_PAD src0_sel:WORD_1
    v_fma_mix_f32 v219, v188, v219, 0 op_sel_hi:[0,1,0]
    v_mfma_f32_32x32x16_bf16 v[96:111], a[240:243], a[228:231], v[96:111]
    ds_read_b64_tr_b16 a[176:177], v1 offset:28672
    ds_read_b64_tr_b16 a[198:199], v1 offset:39424
    v_fma_mix_f32 v221, v190, v221, 0 op_sel_hi:[0,1,0]
    v_fma_mix_f32 v218, v189, v218, 0 op_sel_hi:[0,1,0]
    v_fma_mix_f32 v220, v191, v220, 0 op_sel_hi:[0,1,0]
    v_cvt_pk_bf16_f32 v208, v219, v218
    v_cvt_pk_bf16_f32 v209, v221, v220
    v_mfma_f32_32x32x16_bf16 v[80:95], a[236:239], a[228:231], v[80:95]
    ds_read_b64_tr_b16 a[178:179], v1 offset:29184
    ds_read_b64_tr_b16 a[200:201], v1 offset:40960
    v_cvt_pk_f16_f32 v222, v192, v193
    v_cvt_pk_f16_f32 v224, v194, v195
    v_pk_fma_f16 v223, v222, v222, s36
    v_pk_fma_f16 v225, v224, v224, s36
    v_pk_mul_f16 v223, v223, v222
    v_mfma_f32_32x32x16_bf16 v[64:79], a[232:235], a[228:231], v[64:79]
    ds_read_b64_tr_b16 a[180:181], v1 offset:30720
    ds_read_b64_tr_b16 a[202:203], v1 offset:41472
    v_pk_mul_f16 v225, v225, v224
    v_exp_f16 v222, v223
    v_exp_f16 v224, v225
    v_mfma_f32_32x32x16_bf16 v[112:127], a[232:235], a[216:219], v[112:127]
    s_add_u32 m0, s41, 26624
    ds_read_b64_tr_b16 a[182:183], v1 offset:31232
    ds_read_b64_tr_b16 a[204:205], v1 offset:43008
    v_exp_f16_sdwa v222, v223 dst_sel:WORD_1 dst_unused:UNUSED_PRESERVE src0_sel:WORD_1
    v_exp_f16_sdwa v224, v225 dst_sel:WORD_1 dst_unused:UNUSED_PRESERVE src0_sel:WORD_1
    v_pk_fma_f16 v222, v222, s101, s101
    v_mfma_f32_32x32x16_bf16 v[128:143], a[236:239], a[216:219], v[128:143]
    buffer_load_dwordx4 v241, s[12:15], s40 offen offset:0  lds
    v_pk_fma_f16 v224, v224, s101, s101
    v_rcp_f16 v223, v222
    v_rcp_f16 v225, v224
    v_mfma_f32_32x32x16_bf16 v[144:159], a[240:243], a[216:219], v[144:159]
    ds_read_b64_tr_b16 a[188:189], v1 offset:34816
    ds_read_b64_tr_b16 a[206:207], v1 offset:43520
    v_rcp_f16_sdwa v222, v222 dst_sel:WORD_0 dst_unused:UNUSED_PAD src0_sel:WORD_1
    v_rcp_f16_sdwa v224, v224 dst_sel:WORD_0 dst_unused:UNUSED_PAD src0_sel:WORD_1
    v_mfma_f32_32x32x16_bf16 v[172:187], a[168:171], a[0:3], 0
    ds_read_b64_tr_b16 a[192:193], v1 offset:36864
    ds_read_b64_tr_b16 a[208:209], v1 offset:45056
    v_fma_mix_f32 v223, v192, v223, 0 op_sel_hi:[0,1,0]
    v_fma_mix_f32 v225, v194, v225, 0 op_sel_hi:[0,1,0]
    v_fma_mix_f32 v222, v193, v222, 0 op_sel_hi:[0,1,0]
    v_fma_mix_f32 v224, v195, v224, 0 op_sel_hi:[0,1,0]
    v_mfma_f32_32x32x16_bf16 v[172:187], a[172:175], a[4:7], v[172:187]
    s_waitcnt lgkmcnt(5)
    ds_read_b64_tr_b16 a[196:197], v1 offset:38912
    ds_read_b64_tr_b16 a[210:211], v1 offset:45568
    v_cvt_pk_bf16_f32 v210, v223, v222
    v_cvt_pk_bf16_f32 v211, v225, v224
    v_cvt_pk_f16_f32 v218, v196, v197
    v_cvt_pk_f16_f32 v220, v198, v199
    v_pk_fma_f16 v219, v218, v218, s36
    v_mfma_f32_32x32x16_bf16 v[172:187], a[176:179], a[8:11], v[172:187]
    ds_write_b128 v10, v[208:211] offset:32768
    v_pk_fma_f16 v221, v220, v220, s36
    v_mfma_f32_32x32x16_bf16 v[172:187], a[180:183], a[12:15], v[172:187]
    v_pk_mul_f16 v219, v219, v218
    v_pk_mul_f16 v221, v221, v220
    v_exp_f16 v218, v219
    v_exp_f16 v220, v221
    v_mfma_f32_32x32x16_bf16 v[172:187], a[184:187], a[16:19], v[172:187]
    s_waitcnt lgkmcnt(1)
    v_exp_f16_sdwa v218, v219 dst_sel:WORD_1 dst_unused:UNUSED_PRESERVE src0_sel:WORD_1
    v_exp_f16_sdwa v220, v221 dst_sel:WORD_1 dst_unused:UNUSED_PRESERVE src0_sel:WORD_1
    v_pk_fma_f16 v218, v218, s101, s101
    v_pk_fma_f16 v220, v220, s101, s101
    v_mfma_f32_32x32x16_bf16 v[172:187], a[188:191], a[20:23], v[172:187]
    buffer_load_dwordx4 v241, s[12:15], s40 offen offset:3072  lds
    ds_read_b64_tr_b16 a[244:245], v3 offset:18432
    v_rcp_f16 v219, v218
    v_rcp_f16 v221, v220
    v_mfma_f32_32x32x16_bf16 v[172:187], a[192:195], a[24:27], v[172:187]
    ds_read_b64_tr_b16 a[246:247], v3 offset:21504
    ds_read_b128 a[220:223], v9 offset:3072
    v_rcp_f16_sdwa v218, v218 dst_sel:WORD_0 dst_unused:UNUSED_PAD src0_sel:WORD_1
    v_rcp_f16_sdwa v220, v220 dst_sel:WORD_0 dst_unused:UNUSED_PAD src0_sel:WORD_1
    v_fma_mix_f32 v219, v196, v219, 0 op_sel_hi:[0,1,0]
    v_mfma_f32_32x32x16_bf16 v[172:187], a[196:199], a[28:31], v[172:187]
    ds_read_b64_tr_b16 a[248:249], v4 offset:18432
    ds_read_b64_tr_b16 a[250:251], v4 offset:21504
    v_fma_mix_f32 v221, v198, v221, 0 op_sel_hi:[0,1,0]
    v_fma_mix_f32 v218, v197, v218, 0 op_sel_hi:[0,1,0]
    v_fma_mix_f32 v220, v199, v220, 0 op_sel_hi:[0,1,0]
    v_cvt_pk_bf16_f32 v212, v219, v218
    v_cvt_pk_bf16_f32 v213, v221, v220
    v_mfma_f32_32x32x16_bf16 v[172:187], a[200:203], a[32:35], v[172:187]
    ds_read_b64_tr_b16 a[252:253], v5 offset:18432
    ds_read_b64_tr_b16 a[254:255], v5 offset:21504
    v_cvt_pk_f16_f32 v222, v200, v201
    v_cvt_pk_f16_f32 v224, v202, v203
    v_pk_fma_f16 v223, v222, v222, s36
    v_pk_fma_f16 v225, v224, v224, s36
    v_mfma_f32_32x32x16_bf16 v[172:187], a[204:207], a[36:39], v[172:187]
    ds_read_b128 a[224:227], v9 offset:7168
    v_pk_mul_f16 v223, v223, v222
    v_pk_mul_f16 v225, v225, v224
    v_exp_f16 v222, v223
    v_exp_f16 v224, v225
    v_mfma_f32_32x32x16_bf16 v[172:187], a[208:211], a[40:43], v[172:187]
    v_exp_f16_sdwa v222, v223 dst_sel:WORD_1 dst_unused:UNUSED_PRESERVE src0_sel:WORD_1
    v_exp_f16_sdwa v224, v225 dst_sel:WORD_1 dst_unused:UNUSED_PRESERVE src0_sel:WORD_1
    v_pk_fma_f16 v222, v222, s101, s101
    v_pk_fma_f16 v224, v224, s101, s101
    v_mfma_f32_32x32x16_bf16 v[172:187], a[212:215], a[44:47], v[172:187]
    s_waitcnt lgkmcnt(1)
    v_rcp_f16 v223, v222
    v_rcp_f16_e64 v225, v224
    v_rcp_f16_sdwa v222, v222 dst_sel:WORD_0 dst_unused:UNUSED_PAD src0_sel:WORD_1
    v_mfma_f32_32x32x16_bf16 v[16:31], a[244:247], a[220:223], v[16:31]
    ds_read_b128 a[228:231], v9 offset:11264
    v_rcp_f16_sdwa v224, v224 dst_sel:WORD_0 dst_unused:UNUSED_PAD src0_sel:WORD_1
    v_fma_mix_f32 v223, v200, v223, 0 op_sel_hi:[0,1,0]
    v_fma_mix_f32 v225, v202, v225, 0 op_sel_hi:[0,1,0]
    v_fma_mix_f32 v222, v201, v222, 0 op_sel_hi:[0,1,0]
    v_fma_mix_f32 v224, v203, v224, 0 op_sel_hi:[0,1,0]
    v_mfma_f32_32x32x16_bf16 v[32:47], a[248:251], a[220:223], v[32:47]
    v_cvt_pk_bf16_f32 v214, v223, v222
    v_cvt_pk_bf16_f32 v215, v225, v224
    v_cvt_pk_f16_f32 v218, v172, v173
    v_cvt_pk_f16_f32 v220, v174, v175
    v_pk_fma_f16 v219, v218, v218, s36
    v_pk_fma_f16 v221, v220, v220, s36
    v_pk_mul_f16 v219, v219, v218
    v_mfma_f32_32x32x16_bf16 v[48:63], a[252:255], a[220:223], v[48:63]
    s_waitcnt lgkmcnt(1)
    ds_write_b128 v10, v[212:215] offset:33792
    v_pk_mul_f16 v221, v221, v220
    v_mfma_f32_32x32x16_bf16 v[96:111], a[252:255], a[224:227], v[96:111]
    v_exp_f16 v218, v219
    v_exp_f16_e64 v220, v221
    v_exp_f16_sdwa v218, v219 dst_sel:WORD_1 dst_unused:UNUSED_PRESERVE src0_sel:WORD_1
    v_mfma_f32_32x32x16_bf16 v[80:95], a[248:251], a[224:227], v[80:95]
    v_exp_f16_sdwa v220, v221 dst_sel:WORD_1 dst_unused:UNUSED_PRESERVE src0_sel:WORD_1
    v_pk_fma_f16 v218, v218, s101, s101
    v_pk_fma_f16 v220, v220, s101, s101
    v_rcp_f16 v219, v218
    v_mfma_f32_32x32x16_bf16 v[64:79], a[244:247], a[224:227], v[64:79]
    s_waitcnt lgkmcnt(1)
    v_rcp_f16_e64 v221, v220
    v_rcp_f16_sdwa v218, v218 dst_sel:WORD_0 dst_unused:UNUSED_PAD src0_sel:WORD_1
    v_rcp_f16_sdwa v220, v220 dst_sel:WORD_0 dst_unused:UNUSED_PAD src0_sel:WORD_1
    v_fma_mix_f32 v219, v172, v219, 0 op_sel_hi:[0,1,0]
    v_mfma_f32_32x32x16_bf16 v[112:127], a[244:247], a[228:231], v[112:127]
    v_fma_mix_f32 v221, v174, v221, 0 op_sel_hi:[0,1,0]
    v_fma_mix_f32 v218, v173, v218, 0 op_sel_hi:[0,1,0]
    v_fma_mix_f32 v220, v175, v220, 0 op_sel_hi:[0,1,0]
    v_cvt_pk_bf16_f32 v208, v219, v218
    v_cvt_pk_bf16_f32 v209, v221, v220
    v_cvt_pk_f16_f32 v222, v176, v177
    v_cvt_pk_f16_f32 v224, v178, v179
    v_mfma_f32_32x32x16_bf16 v[128:143], a[248:251], a[228:231], v[128:143]
    v_pk_fma_f16 v223, v222, v222, s36
    v_pk_fma_f16 v225, v224, v224, s36
    v_pk_mul_f16 v223, v223, v222
    v_pk_mul_f16 v225, v225, v224
    v_exp_f16_e64 v222, v223
    v_mfma_f32_32x32x16_bf16 v[144:159], a[252:255], a[228:231], v[144:159]
    s_add_u32 s40, s40, 24576
    v_exp_f16_e64 v224, v225
    v_exp_f16_sdwa v222, v223 dst_sel:WORD_1 dst_unused:UNUSED_PRESERVE src0_sel:WORD_1
    v_exp_f16_sdwa v224, v225 dst_sel:WORD_1 dst_unused:UNUSED_PRESERVE src0_sel:WORD_1
    v_pk_fma_f16 v222, v222, s101, s101
    s_waitcnt vmcnt(0) lgkmcnt(0)
    s_barrier
    v_mfma_f32_32x32x16_bf16 v[188:203], a[168:171], a[48:51], 0
    s_add_u32 m0, s41, 0
    v_pk_fma_f16 v224, v224, s101, s101
    v_rcp_f16 v223, v222
    v_rcp_f16_e64 v225, v224
    v_rcp_f16_sdwa v222, v222 dst_sel:WORD_0 dst_unused:UNUSED_PAD src0_sel:WORD_1
    v_mfma_f32_32x32x16_bf16 v[188:203], a[172:175], a[52:55], v[188:203]
    buffer_load_dwordx4 v15, s[12:15], s40 offen offset:0  lds
    v_rcp_f16_sdwa v224, v224 dst_sel:WORD_0 dst_unused:UNUSED_PAD src0_sel:WORD_1
    v_fma_mix_f32 v223, v176, v223, 0 op_sel_hi:[0,1,0]
    v_fma_mix_f32 v225, v178, v225, 0 op_sel_hi:[0,1,0]
    v_mfma_f32_32x32x16_bf16 v[188:203], a[176:179], a[56:59], v[188:203]
    ds_read_b64_tr_b16 a[232:233], v3 offset:24576
    v_fma_mix_f32 v222, v177, v222, 0 op_sel_hi:[0,1,0]
    v_fma_mix_f32 v224, v179, v224, 0 op_sel_hi:[0,1,0]
    v_cvt_pk_bf16_f32 v210, v223, v222
    v_cvt_pk_bf16_f32 v211, v225, v224
    v_cvt_pk_f16_f32 v218, v180, v181
    v_mfma_f32_32x32x16_bf16 v[188:203], a[180:183], a[60:63], v[188:203]
    ds_write_b128 v10, v[208:211] offset:0
    v_cvt_pk_f16_f32 v220, v182, v183
    v_mfma_f32_32x32x16_bf16 v[188:203], a[184:187], a[64:67], v[188:203]
    v_pk_fma_f16 v219, v218, v218, s36
    v_pk_fma_f16 v221, v220, v220, s36
    v_pk_mul_f16 v219, v219, v218
    v_pk_mul_f16 v221, v221, v220
    v_exp_f16_e64 v218, v219
    v_mfma_f32_32x32x16_bf16 v[188:203], a[188:191], a[68:71], v[188:203]
    v_exp_f16_e64 v220, v221
    v_exp_f16_sdwa v218, v219 dst_sel:WORD_1 dst_unused:UNUSED_PRESERVE src0_sel:WORD_1
    v_exp_f16_sdwa v220, v221 dst_sel:WORD_1 dst_unused:UNUSED_PRESERVE src0_sel:WORD_1
    v_mfma_f32_32x32x16_bf16 v[188:203], a[192:195], a[72:75], v[188:203]
    ds_read_b64_tr_b16 a[234:235], v3 offset:27648
    ds_read_b128 a[216:219], v9 offset:24576
    v_pk_fma_f16 v218, v218, s101, s101
    v_pk_fma_f16 v220, v220, s101, s101
    v_rcp_f16_e64 v219, v218
    v_mfma_f32_32x32x16_bf16 v[188:203], a[196:199], a[76:79], v[188:203]
    ds_read_b64_tr_b16 a[236:237], v4 offset:24576
    ds_read_b64_tr_b16 a[238:239], v4 offset:27648
    v_rcp_f16_e64 v221, v220
    v_rcp_f16_sdwa v218, v218 dst_sel:WORD_0 dst_unused:UNUSED_PAD src0_sel:WORD_1
    v_mfma_f32_32x32x16_bf16 v[188:203], a[200:203], a[80:83], v[188:203]
    ds_read_b64_tr_b16 a[240:241], v5 offset:24576
    ds_read_b64_tr_b16 a[242:243], v5 offset:27648
    v_rcp_f16_sdwa v220, v220 dst_sel:WORD_0 dst_unused:UNUSED_PAD src0_sel:WORD_1
    v_fma_mix_f32 v219, v180, v219, 0 op_sel_hi:[0,1,0]
    v_fma_mix_f32 v221, v182, v221, 0 op_sel_hi:[0,1,0]
    v_mfma_f32_32x32x16_bf16 v[188:203], a[204:207], a[84:87], v[188:203]
    ds_read_b128 a[220:223], v9 offset:28672
    v_fma_mix_f32 v218, v181, v218, 0 op_sel_hi:[0,1,0]
    v_fma_mix_f32 v220, v183, v220, 0 op_sel_hi:[0,1,0]
    v_cvt_pk_bf16_f32 v212, v219, v218
    v_cvt_pk_bf16_f32 v213, v221, v220
    v_cvt_pk_f16_f32 v222, v184, v185
    v_mfma_f32_32x32x16_bf16 v[188:203], a[208:211], a[88:91], v[188:203]
    buffer_load_dwordx4 v15, s[12:15], s40 offen offset:3072  lds
    v_cvt_pk_f16_f32 v224, v186, v187
    v_pk_fma_f16 v223, v222, v222, s36
    v_pk_fma_f16 v225, v224, v224, s36
    v_pk_mul_f16 v223, v223, v222
    v_mfma_f32_32x32x16_bf16 v[188:203], a[212:215], a[92:95], v[188:203]
    s_waitcnt lgkmcnt(1)
    v_pk_mul_f16 v225, v225, v224
    v_exp_f16 v222, v223
    v_exp_f16_e64 v224, v225
    v_exp_f16_sdwa v222, v223 dst_sel:WORD_1 dst_unused:UNUSED_PRESERVE src0_sel:WORD_1
    v_mfma_f32_32x32x16_bf16 v[16:31], a[232:235], a[216:219], v[16:31]
    ds_read_b128 a[224:227], v9 offset:32768
    v_exp_f16_sdwa v224, v225 dst_sel:WORD_1 dst_unused:UNUSED_PRESERVE src0_sel:WORD_1
    v_pk_fma_f16 v222, v222, s101, s101
    v_pk_fma_f16 v224, v224, s101, s101
    v_rcp_f16_e64 v223, v222
    v_mfma_f32_32x32x16_bf16 v[32:47], a[236:239], a[216:219], v[32:47]
    v_rcp_f16 v225, v224
    v_rcp_f16_sdwa v222, v222 dst_sel:WORD_0 dst_unused:UNUSED_PAD src0_sel:WORD_1
    v_rcp_f16_sdwa v224, v224 dst_sel:WORD_0 dst_unused:UNUSED_PAD src0_sel:WORD_1
    v_mfma_f32_32x32x16_bf16 v[48:63], a[240:243], a[216:219], v[48:63]
    s_waitcnt lgkmcnt(1)
    v_fma_mix_f32 v223, v184, v223, 0 op_sel_hi:[0,1,0]
    v_fma_mix_f32 v225, v186, v225, 0 op_sel_hi:[0,1,0]
    v_fma_mix_f32 v222, v185, v222, 0 op_sel_hi:[0,1,0]
    v_fma_mix_f32 v224, v187, v224, 0 op_sel_hi:[0,1,0]
    v_cvt_pk_bf16_f32 v214, v223, v222
    v_cvt_pk_bf16_f32 v215, v225, v224
    v_mfma_f32_32x32x16_bf16 v[96:111], a[240:243], a[220:223], v[96:111]
    ds_write_b128 v10, v[212:215] offset:1024
    v_cvt_pk_f16_f32 v218, v188, v189
    v_mfma_f32_32x32x16_bf16 v[80:95], a[236:239], a[220:223], v[80:95]
    v_cvt_pk_f16_f32 v220, v190, v191
    v_pk_fma_f16 v219, v218, v218, s36
    v_pk_fma_f16 v221, v220, v220, s36
    v_pk_mul_f16 v219, v219, v218
    v_pk_mul_f16 v221, v221, v220
    v_exp_f16 v218, v219
    v_mfma_f32_32x32x16_bf16 v[64:79], a[232:235], a[220:223], v[64:79]
    s_waitcnt lgkmcnt(1)
    v_exp_f16_e64 v220, v221
    v_exp_f16_sdwa v218, v219 dst_sel:WORD_1 dst_unused:UNUSED_PRESERVE src0_sel:WORD_1
    v_exp_f16_sdwa v220, v221 dst_sel:WORD_1 dst_unused:UNUSED_PRESERVE src0_sel:WORD_1
    v_mfma_f32_32x32x16_bf16 v[112:127], a[232:235], a[224:227], v[112:127]
    v_pk_fma_f16 v218, v218, s101, s101
    v_pk_fma_f16 v220, v220, s101, s101
    v_rcp_f16 v219, v218
    v_rcp_f16 v221, v220
    v_mfma_f32_32x32x16_bf16 v[128:143], a[236:239], a[224:227], v[128:143]
    s_add_u32 m0, s41, 1024
    v_rcp_f16_sdwa v218, v218 dst_sel:WORD_0 dst_unused:UNUSED_PAD src0_sel:WORD_1
    v_rcp_f16_sdwa v220, v220 dst_sel:WORD_0 dst_unused:UNUSED_PAD src0_sel:WORD_1
    v_fma_mix_f32 v219, v188, v219, 0 op_sel_hi:[0,1,0]
    v_fma_mix_f32 v221, v190, v221, 0 op_sel_hi:[0,1,0]
    v_fma_mix_f32 v218, v189, v218, 0 op_sel_hi:[0,1,0]
    v_mfma_f32_32x32x16_bf16 v[144:159], a[240:243], a[224:227], v[144:159]
    buffer_load_dwordx4 v240, s[12:15], s40 offen offset:0  lds
    v_fma_mix_f32 v220, v191, v220, 0 op_sel_hi:[0,1,0]
    v_cvt_pk_bf16_f32 v208, v219, v218
    v_cvt_pk_bf16_f32 v209, v221, v220
    v_cvt_pk_f16_f32 v222, v192, v193
    v_cvt_pk_f16_f32 v224, v194, v195
    v_mfma_f32_32x32x16_bf16 v[172:187], a[168:171], a[96:99], 0
    ds_read_b64_tr_b16 a[168:169], v1 offset:0
    v_pk_fma_f16 v223, v222, v222, s36
    v_pk_fma_f16 v225, v224, v224, s36
    v_pk_mul_f16 v223, v223, v222
    v_pk_mul_f16 v225, v225, v224
    v_exp_f16 v222, v223
    v_mfma_f32_32x32x16_bf16 v[172:187], a[172:175], a[100:103], v[172:187]
    ds_read_b64_tr_b16 a[170:171], v1 offset:512
    v_exp_f16 v224, v225
    v_exp_f16_sdwa v222, v223 dst_sel:WORD_1 dst_unused:UNUSED_PRESERVE src0_sel:WORD_1
    v_exp_f16_sdwa v224, v225 dst_sel:WORD_1 dst_unused:UNUSED_PRESERVE src0_sel:WORD_1
    v_mfma_f32_32x32x16_bf16 v[172:187], a[176:179], a[104:107], v[172:187]
    ds_read_b64_tr_b16 a[244:245], v3 offset:30720
    v_pk_fma_f16 v222, v222, s101, s101
    v_pk_fma_f16 v224, v224, s101, s101
    v_rcp_f16 v223, v222
    v_rcp_f16 v225, v224
    v_mfma_f32_32x32x16_bf16 v[172:187], a[180:183], a[108:111], v[172:187]
L_pg12:
    s_cbranch_execz L_wu2
    ds_read_b64_tr_b16 a[246:247], v3 offset:33792
    ds_read_b128 a[228:231], v9 offset:25600
    v_rcp_f16_sdwa v222, v222 dst_sel:WORD_0 dst_unused:UNUSED_PAD src0_sel:WORD_1
    v_rcp_f16_sdwa v224, v224 dst_sel:WORD_0 dst_unused:UNUSED_PAD src0_sel:WORD_1
    v_mfma_f32_32x32x16_bf16 v[172:187], a[184:187], a[112:115], v[172:187]
    s_nop 0
    ds_read_b64_tr_b16 a[248:249], v4 offset:30720
    ds_read_b64_tr_b16 a[250:251], v4 offset:33792
    v_fma_mix_f32 v223, v192, v223, 0 op_sel_hi:[0,1,0]
    v_fma_mix_f32 v225, v194, v225, 0 op_sel_hi:[0,1,0]
    v_fma_mix_f32 v222, v193, v222, 0 op_sel_hi:[0,1,0]
    v_fma_mix_f32 v224, v195, v224, 0 op_sel_hi:[0,1,0]
    v_mfma_f32_32x32x16_bf16 v[172:187], a[188:191], a[116:119], v[172:187]
    ds_read_b64_tr_b16 a[252:253], v5 offset:30720
    ds_read_b64_tr_b16 a[254:255], v5 offset:33792
    v_cvt_pk_bf16_f32 v210, v223, v222
    v_cvt_pk_bf16_f32 v211, v225, v224
    v_cvt_pk_f16_f32 v218, v196, v197
    v_cvt_pk_f16_f32 v220, v198, v199
    v_mfma_f32_32x32x16_bf16 v[172:187], a[192:195], a[120:123], v[172:187]
    ds_write_b128 v10, v[208:211] offset:4096
    v_pk_fma_f16 v219, v218, v218, s36
    v_mfma_f32_32x32x16_bf16 v[172:187], a[196:199], a[124:127], v[172:187]
    v_pk_fma_f16 v221, v220, v220, s36
    v_pk_mul_f16 v219, v219, v218
    v_pk_mul_f16 v221, v221, v220
    v_exp_f16_e64 v218, v219
    v_exp_f16_e64 v220, v221
    v_mfma_f32_32x32x16_bf16 v[172:187], a[200:203], a[128:131], v[172:187]
    v_exp_f16_sdwa v218, v219 dst_sel:WORD_1 dst_unused:UNUSED_PRESERVE src0_sel:WORD_1
    v_exp_f16_sdwa v220, v221 dst_sel:WORD_1 dst_unused:UNUSED_PRESERVE src0_sel:WORD_1
    v_pk_fma_f16 v218, v218, s101, s101
    v_pk_fma_f16 v220, v220, s101, s101
    v_mfma_f32_32x32x16_bf16 v[172:187], a[204:207], a[132:135], v[172:187]
    ds_read_b128 a[216:219], v9 offset:29696
    ds_read_b64_tr_b16 a[186:187], v1 offset:8704
    v_rcp_f16_e64 v219, v218
    v_rcp_f16 v221, v220
    v_mfma_f32_32x32x16_bf16 v[172:187], a[208:211], a[136:139], v[172:187]
    buffer_load_dwordx4 v240, s[12:15], s40 offen offset:3072  lds
    v_rcp_f16_sdwa v218, v218 dst_sel:WORD_0 dst_unused:UNUSED_PAD src0_sel:WORD_1
    v_rcp_f16_sdwa v220, v220 dst_sel:WORD_0 dst_unused:UNUSED_PAD src0_sel:WORD_1
    v_fma_mix_f32 v219, v196, v219, 0 op_sel_hi:[0,1,0]
    v_mfma_f32_32x32x16_bf16 v[172:187], a[212:215], a[140:143], v[172:187]
    s_waitcnt lgkmcnt(3)
    ds_read_b64_tr_b16 a[172:173], v1 offset:2048
    ds_read_b64_tr_b16 a[190:191], v1 offset:10752
    v_fma_mix_f32 v221, v198, v221, 0 op_sel_hi:[0,1,0]
    v_fma_mix_f32 v218, v197, v218, 0 op_sel_hi:[0,1,0]
    v_fma_mix_f32 v220, v199, v220, 0 op_sel_hi:[0,1,0]
    v_cvt_pk_bf16_f32 v212, v219, v218
    v_cvt_pk_bf16_f32 v213, v221, v220
    v_mfma_f32_32x32x16_bf16 v[16:31], a[244:247], a[228:231], v[16:31]
    ds_read_b128 a[220:223], v9 offset:33792
    ds_read_b64_tr_b16 a[194:195], v1 offset:12800
    v_cvt_pk_f16_f32 v222, v200, v201
    v_cvt_pk_f16_f32 v224, v202, v203
    v_pk_fma_f16 v223, v222, v222, s36
    v_pk_fma_f16 v225, v224, v224, s36
    v_mfma_f32_32x32x16_bf16 v[32:47], a[248:251], a[228:231], v[32:47]
    ds_read_b64_tr_b16 a[174:175], v1 offset:2560
    ds_read_b64_tr_b16 a[198:199], v1 offset:14848
    v_pk_mul_f16 v223, v223, v222
    v_pk_mul_f16 v225, v225, v224
    v_exp_f16 v222, v223
    v_mfma_f32_32x32x16_bf16 v[48:63], a[252:255], a[228:231], v[48:63]
    s_waitcnt lgkmcnt(7)
    ds_read_b64_tr_b16 a[232:233], v3 offset:36864
    ds_read_b64_tr_b16 a[200:201], v1 offset:16384
    v_exp_f16_e64 v224, v225
    v_exp_f16_sdwa v222, v223 dst_sel:WORD_1 dst_unused:UNUSED_PRESERVE src0_sel:WORD_1
    v_mfma_f32_32x32x16_bf16 v[96:111], a[252:255], a[216:219], v[96:111]
    ds_read_b64_tr_b16 a[234:235], v3 offset:39936
    ds_read_b128 a[224:227], v9 offset:26624
    v_exp_f16_sdwa v224, v225 dst_sel:WORD_1 dst_unused:UNUSED_PRESERVE src0_sel:WORD_1
    v_pk_fma_f16 v222, v222, s101, s101
    v_pk_fma_f16 v224, v224, s101, s101
    v_mfma_f32_32x32x16_bf16 v[80:95], a[248:251], a[216:219], v[80:95]
    ds_read_b64_tr_b16 a[236:237], v4 offset:36864
    ds_read_b64_tr_b16 a[238:239], v4 offset:39936
    v_rcp_f16 v223, v222
    v_rcp_f16_e64 v225, v224
    v_mfma_f32_32x32x16_bf16 v[64:79], a[244:247], a[216:219], v[64:79]
    s_waitcnt lgkmcnt(9)
    ds_read_b64_tr_b16 a[240:241], v5 offset:36864
    ds_read_b64_tr_b16 a[242:243], v5 offset:39936
    v_rcp_f16_sdwa v222, v222 dst_sel:WORD_0 dst_unused:UNUSED_PAD src0_sel:WORD_1
    v_rcp_f16_sdwa v224, v224 dst_sel:WORD_0 dst_unused:UNUSED_PAD src0_sel:WORD_1
    v_fma_mix_f32 v223, v200, v223, 0 op_sel_hi:[0,1,0]
    v_mfma_f32_32x32x16_bf16 v[112:127], a[244:247], a[220:223], v[112:127]
    ds_read_b128 a[228:231], v9 offset:30720
    ds_read_b128 a[216:219], v9 offset:34816
    v_fma_mix_f32 v225, v202, v225, 0 op_sel_hi:[0,1,0]
    v_fma_mix_f32 v222, v201, v222, 0 op_sel_hi:[0,1,0]
    v_fma_mix_f32 v224, v203, v224, 0 op_sel_hi:[0,1,0]
    v_cvt_pk_bf16_f32 v214, v223, v222
    v_cvt_pk_bf16_f32 v215, v225, v224
    v_mfma_f32_32x32x16_bf16 v[128:143], a[248:251], a[220:223], v[128:143]
    s_nop 0
    ds_write_b128 v10, v[212:215] offset:5120
    v_cvt_pk_f16_f32 v218, v172, v173
    v_cvt_pk_f16_f32 v220, v174, v175
    v_mfma_f32_32x32x16_bf16 v[144:159], a[252:255], a[220:223], v[144:159]
    s_waitcnt lgkmcnt(3)
    v_pk_fma_f16 v219, v218, v218, s36
    v_pk_fma_f16 v221, v220, v220, s36
    v_pk_mul_f16 v219, v219, v218
    v_pk_mul_f16 v221, v221, v220
    v_exp_f16 v218, v219
    v_mfma_f32_32x32x16_bf16 v[16:31], a[232:235], a[224:227], v[16:31]
    s_add_u32 m0, s41, 2048
    v_exp_f16 v220, v221
    v_exp_f16_sdwa v218, v219 dst_sel:WORD_1 dst_unused:UNUSED_PRESERVE src0_sel:WORD_1
    v_exp_f16_sdwa v220, v221 dst_sel:WORD_1 dst_unused:UNUSED_PRESERVE src0_sel:WORD_1
    v_pk_fma_f16 v218, v218, s101, s101
    v_mfma_f32_32x32x16_bf16 v[32:47], a[236:239], a[224:227], v[32:47]
    buffer_load_dwordx4 v241, s[12:15], s40 offen offset:0  lds
    v_pk_fma_f16 v220, v220, s101, s101
    v_rcp_f16 v219, v218
    v_rcp_f16_e64 v221, v220
    v_mfma_f32_32x32x16_bf16 v[48:63], a[240:243], a[224:227], v[48:63]
    s_waitcnt lgkmcnt(1)
    ds_read_b64_tr_b16 a[176:177], v1 offset:4096
    ds_read_b64_tr_b16 a[202:203], v1 offset:16896
    v_rcp_f16_sdwa v218, v218 dst_sel:WORD_0 dst_unused:UNUSED_PAD src0_sel:WORD_1
    v_rcp_f16_sdwa v220, v220 dst_sel:WORD_0 dst_unused:UNUSED_PAD src0_sel:WORD_1
    v_fma_mix_f32 v219, v172, v219, 0 op_sel_hi:[0,1,0]
    v_mfma_f32_32x32x16_bf16 v[96:111], a[240:243], a[228:231], v[96:111]
    ds_read_b64_tr_b16 a[178:179], v1 offset:4608
    ds_read_b64_tr_b16 a[204:205], v1 offset:18432
    v_fma_mix_f32 v221, v174, v221, 0 op_sel_hi:[0,1,0]
    v_fma_mix_f32 v218, v173, v218, 0 op_sel_hi:[0,1,0]
    v_fma_mix_f32 v220, v175, v220, 0 op_sel_hi:[0,1,0]
    v_cvt_pk_bf16_f32 v208, v219, v218
    v_mfma_f32_32x32x16_bf16 v[80:95], a[236:239], a[228:231], v[80:95]
    ds_read_b64_tr_b16 a[180:181], v1 offset:6144
    ds_read_b64_tr_b16 a[206:207], v1 offset:18944
    v_cvt_pk_bf16_f32 v209, v221, v220
    v_cvt_pk_f16_f32 v222, v176, v177
    v_cvt_pk_f16_f32 v224, v178, v179
    v_pk_fma_f16 v223, v222, v222, s36
    v_pk_fma_f16 v225, v224, v224, s36
    v_mfma_f32_32x32x16_bf16 v[64:79], a[232:235], a[228:231], v[64:79]
    ds_read_b64_tr_b16 a[182:183], v1 offset:6656
    ds_read_b64_tr_b16 a[208:209], v1 offset:20480
    v_pk_mul_f16 v223, v223, v222
    v_pk_mul_f16 v225, v225, v224
    v_exp_f16_e64 v222, v223
    v_mfma_f32_32x32x16_bf16 v[112:127], a[232:235], a[216:219], v[112:127]
    ds_read_b64_tr_b16 a[184:185], v1 offset:8192
    ds_read_b64_tr_b16 a[210:211], v1 offset:20992
    v_exp_f16_e64 v224, v225
    v_exp_f16_sdwa v222, v223 dst_sel:WORD_1 dst_unused:UNUSED_PRESERVE src0_sel:WORD_1
    v_mfma_f32_32x32x16_bf16 v[128:143], a[236:239], a[216:219], v[128:143]
    buffer_load_dword v251, v250, s[20:23], 0 offen sc1
    buffer_load_dwordx4 v241, s[12:15], s40 offen offset:3072  lds
    v_exp_f16_sdwa v224, v225 dst_sel:WORD_1 dst_unused:UNUSED_PRESERVE src0_sel:WORD_1
    v_pk_fma_f16 v222, v222, s101, s101
    v_pk_fma_f16 v224, v224, s101, s101
    v_mfma_f32_32x32x16_bf16 v[144:159], a[240:243], a[216:219], v[144:159]
    ds_read_b64_tr_b16 a[188:189], v1 offset:10240
    ds_read_b64_tr_b16 a[212:213], v1 offset:22528
    v_rcp_f16_e64 v223, v222
    v_rcp_f16 v225, v224
    v_mfma_f32_32x32x16_bf16 v[188:203], a[168:171], a[0:3], 0
    ds_read_b64_tr_b16 a[192:193], v1 offset:12288
    ds_read_b64_tr_b16 a[214:215], v1 offset:23040
    v_rcp_f16_sdwa v222, v222 dst_sel:WORD_0 dst_unused:UNUSED_PAD src0_sel:WORD_1
    v_rcp_f16_sdwa v224, v224 dst_sel:WORD_0 dst_unused:UNUSED_PAD src0_sel:WORD_1
    v_fma_mix_f32 v223, v176, v223, 0 op_sel_hi:[0,1,0]
    v_mfma_f32_32x32x16_bf16 v[188:203], a[172:175], a[4:7], v[188:203]
    s_waitcnt lgkmcnt(5)
    ds_read_b64_tr_b16 a[196:197], v1 offset:14336
    v_fma_mix_f32 v225, v178, v225, 0 op_sel_hi:[0,1,0]
    v_fma_mix_f32 v222, v177, v222, 0 op_sel_hi:[0,1,0]
    v_fma_mix_f32 v224, v179, v224, 0 op_sel_hi:[0,1,0]
    v_cvt_pk_bf16_f32 v210, v223, v222
    v_cvt_pk_bf16_f32 v211, v225, v224
    v_cvt_pk_f16_f32 v218, v180, v181
    v_mfma_f32_32x32x16_bf16 v[188:203], a[176:179], a[8:11], v[188:203]
    ds_write_b128 v10, v[208:211] offset:8192
    v_cvt_pk_f16_f32 v220, v182, v183
    v_mfma_f32_32x32x16_bf16 v[188:203], a[180:183], a[12:15], v[188:203]
    v_pk_fma_f16 v219, v218, v218, s36
    v_pk_fma_f16 v221, v220, v220, s36
    v_pk_mul_f16 v219, v219, v218
    v_pk_mul_f16 v221, v221, v220
    v_exp_f16_e64 v218, v219
    v_mfma_f32_32x32x16_bf16 v[188:203], a[184:187], a[16:19], v[188:203]
    s_waitcnt lgkmcnt(1)
    v_exp_f16 v220, v221
    v_exp_f16_sdwa v218, v219 dst_sel:WORD_1 dst_unused:UNUSED_PRESERVE src0_sel:WORD_1
    v_exp_f16_sdwa v220, v221 dst_sel:WORD_1 dst_unused:UNUSED_PRESERVE src0_sel:WORD_1
    v_pk_fma_f16 v218, v218, s101, s101
    v_mfma_f32_32x32x16_bf16 v[188:203], a[188:191], a[20:23], v[188:203]
    ds_read_b64_tr_b16 a[244:245], v3 offset:43008
    v_pk_fma_f16 v220, v220, s101, s101
    v_rcp_f16 v219, v218
    v_rcp_f16 v221, v220
    v_mfma_f32_32x32x16_bf16 v[188:203], a[192:195], a[24:27], v[188:203]
    ds_read_b64_tr_b16 a[246:247], v3 offset:46080
    ds_read_b128 a[220:223], v9 offset:27648
    v_rcp_f16_sdwa v218, v218 dst_sel:WORD_0 dst_unused:UNUSED_PAD src0_sel:WORD_1
    v_rcp_f16_sdwa v220, v220 dst_sel:WORD_0 dst_unused:UNUSED_PAD src0_sel:WORD_1
    v_fma_mix_f32 v219, v180, v219, 0 op_sel_hi:[0,1,0]
    v_mfma_f32_32x32x16_bf16 v[188:203], a[196:199], a[28:31], v[188:203]
    ds_read_b64_tr_b16 a[248:249], v4 offset:43008
    ds_read_b64_tr_b16 a[250:251], v4 offset:46080
    v_fma_mix_f32 v221, v182, v221, 0 op_sel_hi:[0,1,0]
    v_fma_mix_f32 v218, v181, v218, 0 op_sel_hi:[0,1,0]
    v_fma_mix_f32 v220, v183, v220, 0 op_sel_hi:[0,1,0]
    v_cvt_pk_bf16_f32 v212, v219, v218
    v_cvt_pk_bf16_f32 v213, v221, v220
    v_mfma_f32_32x32x16_bf16 v[188:203], a[200:203], a[32:35], v[188:203]
    ds_read_b64_tr_b16 a[252:253], v5 offset:43008
    ds_read_b64_tr_b16 a[254:255], v5 offset:46080
    v_cvt_pk_f16_f32 v222, v184, v185
    v_cvt_pk_f16_f32 v224, v186, v187
    v_pk_fma_f16 v223, v222, v222, s36
    v_pk_fma_f16 v225, v224, v224, s36
    v_mfma_f32_32x32x16_bf16 v[188:203], a[204:207], a[36:39], v[188:203]
    ds_read_b128 a[224:227], v9 offset:31744
    v_pk_mul_f16 v223, v223, v222
    v_pk_mul_f16 v225, v225, v224
    v_exp_f16 v222, v223
    v_exp_f16 v224, v225
    v_mfma_f32_32x32x16_bf16 v[188:203], a[208:211], a[40:43], v[188:203]
    v_exp_f16_sdwa v222, v223 dst_sel:WORD_1 dst_unused:UNUSED_PRESERVE src0_sel:WORD_1
    v_exp_f16_sdwa v224, v225 dst_sel:WORD_1 dst_unused:UNUSED_PRESERVE src0_sel:WORD_1
    v_pk_fma_f16 v222, v222, s101, s101
    v_pk_fma_f16 v224, v224, s101, s101
    v_mfma_f32_32x32x16_bf16 v[188:203], a[212:215], a[44:47], v[188:203]
    s_waitcnt lgkmcnt(1)
    v_rcp_f16 v223, v222
    v_rcp_f16_e64 v225, v224
    v_rcp_f16_sdwa v222, v222 dst_sel:WORD_0 dst_unused:UNUSED_PAD src0_sel:WORD_1
    v_mfma_f32_32x32x16_bf16 v[16:31], a[244:247], a[220:223], v[16:31]
    ds_read_b128 a[228:231], v9 offset:35840
    v_rcp_f16_sdwa v224, v224 dst_sel:WORD_0 dst_unused:UNUSED_PAD src0_sel:WORD_1
    v_fma_mix_f32 v223, v184, v223, 0 op_sel_hi:[0,1,0]
    v_fma_mix_f32 v225, v186, v225, 0 op_sel_hi:[0,1,0]
    v_fma_mix_f32 v222, v185, v222, 0 op_sel_hi:[0,1,0]
    v_fma_mix_f32 v224, v187, v224, 0 op_sel_hi:[0,1,0]
    v_mfma_f32_32x32x16_bf16 v[32:47], a[248:251], a[220:223], v[32:47]
    v_cvt_pk_bf16_f32 v214, v223, v222
    v_cvt_pk_bf16_f32 v215, v225, v224
    v_cvt_pk_f16_f32 v218, v188, v189
    v_cvt_pk_f16_f32 v220, v190, v191
    v_pk_fma_f16 v219, v218, v218, s36
    v_pk_fma_f16 v221, v220, v220, s36
    v_pk_mul_f16 v219, v219, v218
    v_mfma_f32_32x32x16_bf16 v[48:63], a[252:255], a[220:223], v[48:63]
    s_waitcnt lgkmcnt(1)
    ds_write_b128 v10, v[212:215] offset:9216
    v_pk_mul_f16 v221, v221, v220
    v_mfma_f32_32x32x16_bf16 v[96:111], a[252:255], a[224:227], v[96:111]
    v_exp_f16 v218, v219
    v_exp_f16 v220, v221
    v_exp_f16_sdwa v218, v219 dst_sel:WORD_1 dst_unused:UNUSED_PRESERVE src0_sel:WORD_1
    v_mfma_f32_32x32x16_bf16 v[80:95], a[248:251], a[224:227], v[80:95]
    v_exp_f16_sdwa v220, v221 dst_sel:WORD_1 dst_unused:UNUSED_PRESERVE src0_sel:WORD_1
    v_pk_fma_f16 v218, v218, s101, s101
    v_pk_fma_f16 v220, v220, s101, s101
    v_rcp_f16 v219, v218
    v_mfma_f32_32x32x16_bf16 v[64:79], a[244:247], a[224:227], v[64:79]
    s_waitcnt lgkmcnt(1)
    v_rcp_f16 v221, v220
    v_rcp_f16_sdwa v218, v218 dst_sel:WORD_0 dst_unused:UNUSED_PAD src0_sel:WORD_1
    v_rcp_f16_sdwa v220, v220 dst_sel:WORD_0 dst_unused:UNUSED_PAD src0_sel:WORD_1
    v_fma_mix_f32 v219, v188, v219, 0 op_sel_hi:[0,1,0]
    v_mfma_f32_32x32x16_bf16 v[112:127], a[244:247], a[228:231], v[112:127]
    v_fma_mix_f32 v221, v190, v221, 0 op_sel_hi:[0,1,0]
    v_fma_mix_f32 v218, v189, v218, 0 op_sel_hi:[0,1,0]
    v_fma_mix_f32 v220, v191, v220, 0 op_sel_hi:[0,1,0]
    v_cvt_pk_bf16_f32 v208, v219, v218
    v_cvt_pk_bf16_f32 v209, v221, v220
    v_cvt_pk_f16_f32 v222, v192, v193
    v_cvt_pk_f16_f32 v224, v194, v195
    v_mfma_f32_32x32x16_bf16 v[128:143], a[248:251], a[228:231], v[128:143]
    v_pk_fma_f16 v223, v222, v222, s36
    v_pk_fma_f16 v225, v224, v224, s36
    v_pk_mul_f16 v223, v223, v222
    v_pk_mul_f16 v225, v225, v224
    v_exp_f16 v222, v223
    v_mfma_f32_32x32x16_bf16 v[144:159], a[252:255], a[228:231], v[144:159]
    s_add_u32 s40, s40, 24576
    v_exp_f16_e64 v224, v225
    v_exp_f16_sdwa v222, v223 dst_sel:WORD_1 dst_unused:UNUSED_PRESERVE src0_sel:WORD_1
    v_exp_f16_sdwa v224, v225 dst_sel:WORD_1 dst_unused:UNUSED_PRESERVE src0_sel:WORD_1
    v_pk_fma_f16 v222, v222, s101, s101
    s_waitcnt vmcnt(0) lgkmcnt(0)
    v_readfirstlane_b32 s33, v251
    s_cmp_eq_u32 s28, 0
    s_cselect_b32 s97, 1028, 0
    s_cmp_ge_u32 s33, s97
    s_cbranch_scc0 L_spin2
L_back2:
    s_barrier
    v_mfma_f32_32x32x16_bf16 v[172:187], a[168:171], a[48:51], 0
    s_add_u32 m0, s41, 24576
    s_nop 0
    buffer_load_dwordx4 v15, s[12:15], s40 offen offset:0  lds
    ds_read_b64_tr_b16 a[6:7], v4 offset:3072
    ds_read_b64_tr_b16 a[8:9], v5 offset:0
    v_and_b32 v226, 63, v0
    v_cmp_gt_u32 vcc, 48, v226
    v_lshlrev_b32 v227, 3, v226
    v_mov_b32 v251, 2147418112
    v_lshlrev_b32 v226, 4, v226
    v_mfma_f32_32x32x16_bf16 v[172:187], a[172:175], a[52:55], v[172:187]
    ds_read_b64_tr_b16 a[0:1], v3 offset:0
    ds_read_b64_tr_b16 a[10:11], v5 offset:3072
    ds_read_b64_tr_b16 a[12:13], v3 offset:6144
    v_cndmask_b32 v226, v251, v226, vcc
    v_cndmask_b32 v227, v251, v227, vcc
    v_pk_fma_f16 v224, v224, s101, s101
    v_rcp_f16 v223, v222
    v_and_b32 v246, 63, v0
    v_mfma_f32_32x32x16_bf16 v[172:187], a[176:179], a[56:59], v[172:187]
    buffer_load_dwordx4 v15, s[12:15], s40 offen offset:3072  lds
    ds_read_b64_tr_b16 a[2:3], v3 offset:3072
    ds_read_b64_tr_b16 a[14:15], v3 offset:9216
    ds_read_b128 a[236:239], v9 offset:1024
    v_rcp_f16_e64 v225, v224
    v_rcp_f16_sdwa v222, v222 dst_sel:WORD_0 dst_unused:UNUSED_PAD src0_sel:WORD_1
    v_mfma_f32_32x32x16_bf16 v[172:187], a[180:183], a[60:63], v[172:187]
    s_add_u32 m0, s41, 25600
    ds_read_b128 a[232:235], v9 offset:0
    ds_read_b64_tr_b16 a[16:17], v4 offset:6144
    ds_read_b64_tr_b16 a[18:19], v4 offset:9216
    v_rcp_f16_sdwa v224, v224 dst_sel:WORD_0 dst_unused:UNUSED_PAD src0_sel:WORD_1
    v_fma_mix_f32 v223, v192, v223, 0 op_sel_hi:[0,1,0]
    v_fma_mix_f32 v225, v194, v225, 0 op_sel_hi:[0,1,0]
    v_fma_mix_f32 v222, v193, v222, 0 op_sel_hi:[0,1,0]
    v_fma_mix_f32 v224, v195, v224, 0 op_sel_hi:[0,1,0]
    v_mfma_f32_32x32x16_bf16 v[172:187], a[184:187], a[64:67], v[172:187]
    buffer_load_dwordx4 v240, s[12:15], s40 offen offset:0  lds
    ds_read_b64_tr_b16 a[4:5], v4 offset:0
    ds_read_b64_tr_b16 a[20:21], v5 offset:6144
    ds_read_b64_tr_b16 a[22:23], v5 offset:9216
    v_cvt_pk_bf16_f32 v210, v223, v222
    v_cvt_pk_bf16_f32 v211, v225, v224
    v_cvt_pk_f16_f32 v218, v196, v197
    v_cvt_pk_f16_f32 v220, v198, v199
    v_mfma_f32_32x32x16_bf16 v[172:187], a[188:191], a[68:71], v[172:187]
    ds_write_b128 v10, v[208:211] offset:24576
    v_pk_fma_f16 v219, v218, v218, s36
    v_pk_fma_f16 v221, v220, v220, s36
    v_pk_mul_f16 v219, v219, v218
    v_pk_mul_f16 v221, v221, v220
    v_mfma_f32_32x32x16_bf16 v[172:187], a[192:195], a[72:75], v[172:187]
    buffer_load_dwordx4 v240, s[12:15], s40 offen offset:3072  lds
    v_exp_f16 v218, v219
    v_exp_f16 v220, v221
    v_exp_f16_sdwa v218, v219 dst_sel:WORD_1 dst_unused:UNUSED_PRESERVE src0_sel:WORD_1
    v_and_b32_e64 v244, 31, v0
    v_mfma_f32_32x32x16_bf16 v[172:187], a[196:199], a[76:79], v[172:187]
    s_add_u32 m0, s41, 26624
    v_exp_f16_sdwa v220, v221 dst_sel:WORD_1 dst_unused:UNUSED_PRESERVE src0_sel:WORD_1
    v_pk_fma_f16 v218, v218, s101, s101
    v_pk_fma_f16 v220, v220, s101, s101
    v_rcp_f16 v219, v218
    v_rcp_f16 v221, v220
    v_mul_u32_u24 v244, 208, v244
    v_mfma_f32_32x32x16_bf16 v[172:187], a[200:203], a[80:83], v[172:187]
    buffer_load_dwordx4 v241, s[12:15], s40 offen offset:0  lds
    ds_read_b64_tr_b16 a[24:25], v3 offset:12288
    ds_read_b64_tr_b16 a[26:27], v3 offset:15360
    v_rcp_f16_sdwa v218, v218 dst_sel:WORD_0 dst_unused:UNUSED_PAD src0_sel:WORD_1
    v_rcp_f16_sdwa v220, v220 dst_sel:WORD_0 dst_unused:UNUSED_PAD src0_sel:WORD_1
    v_fma_mix_f32 v219, v196, v219, 0 op_sel_hi:[0,1,0]
    v_mfma_f32_32x32x16_bf16 v[172:187], a[204:207], a[84:87], v[172:187]
    ds_read_b128 a[240:243], v9 offset:2048
    ds_read_b64_tr_b16 a[28:29], v4 offset:12288
    v_fma_mix_f32 v221, v198, v221, 0 op_sel_hi:[0,1,0]
    v_fma_mix_f32 v218, v197, v218, 0 op_sel_hi:[0,1,0]
    v_fma_mix_f32 v220, v199, v220, 0 op_sel_hi:[0,1,0]
    v_cvt_pk_bf16_f32 v212, v219, v218
    v_cvt_pk_bf16_f32 v213, v221, v220
    v_cvt_pk_f16_f32 v222, v200, v201
    v_cvt_pk_f16_f32 v224, v202, v203
    v_mfma_f32_32x32x16_bf16 v[172:187], a[208:211], a[88:91], v[172:187]
    buffer_load_dwordx4 v241, s[12:15], s40 offen offset:3072  lds
    ds_read_b64_tr_b16 a[30:31], v4 offset:15360
    ds_read_b64_tr_b16 a[32:33], v5 offset:12288
    v_pk_fma_f16 v223, v222, v222, s36
    v_pk_fma_f16 v225, v224, v224, s36
    v_pk_mul_f16 v223, v223, v222
    v_pk_mul_f16 v225, v225, v224
    v_exp_f16_e64 v222, v223
    v_mfma_f32_32x32x16_bf16 v[172:187], a[212:215], a[92:95], v[172:187]
    s_waitcnt lgkmcnt(7)
    ds_read_b64_tr_b16 a[34:35], v5 offset:15360
    ds_read_b64_tr_b16 a[36:37], v3 offset:18432
    v_exp_f16 v224, v225
    v_exp_f16_sdwa v222, v223 dst_sel:WORD_1 dst_unused:UNUSED_PRESERVE src0_sel:WORD_1
    v_exp_f16_sdwa v224, v225 dst_sel:WORD_1 dst_unused:UNUSED_PRESERVE src0_sel:WORD_1
    v_pk_fma_f16 v222, v222, s101, s101
    v_mfma_f32_32x32x16_bf16 v[16:31], a[0:3], a[232:235], v[16:31]
    ds_read_b64_tr_b16 a[38:39], v3 offset:21504
    ds_read_b128 a[244:247], v9 offset:3072
    v_pk_fma_f16 v224, v224, s101, s101
    v_rcp_f16 v223, v222
    v_rcp_f16 v225, v224
    v_rcp_f16_sdwa v222, v222 dst_sel:WORD_0 dst_unused:UNUSED_PAD src0_sel:WORD_1
    v_mfma_f32_32x32x16_bf16 v[32:47], a[4:7], a[232:235], v[32:47]
    ds_read_b64_tr_b16 a[40:41], v4 offset:18432
    ds_read_b64_tr_b16 a[42:43], v4 offset:21504
    v_rcp_f16_sdwa v224, v224 dst_sel:WORD_0 dst_unused:UNUSED_PAD src0_sel:WORD_1
    v_fma_mix_f32 v223, v200, v223, 0 op_sel_hi:[0,1,0]
    v_fma_mix_f32 v225, v202, v225, 0 op_sel_hi:[0,1,0]
    v_fma_mix_f32 v222, v201, v222, 0 op_sel_hi:[0,1,0]
    v_fma_mix_f32 v224, v203, v224, 0 op_sel_hi:[0,1,0]
    v_cvt_pk_bf16_f32 v214, v223, v222
    v_mfma_f32_32x32x16_bf16 v[48:63], a[8:11], a[232:235], v[48:63]
    buffer_load_dwordx4 v[160:163], v226, s[24:27], s48 offen sc1
    ds_read_b64_tr_b16 a[44:45], v5 offset:18432
    ds_read_b64_tr_b16 a[46:47], v5 offset:21504
    v_cvt_pk_bf16_f32 v215, v225, v224
    v_and_b32 v245, 32, v0
    v_add3_u32 v2, v244, v245, s53
    v_add_u32 v244, 0, v246
    v_mul_u32_u24 v245, 5462, v244
    v_lshrrev_b32_e64 v245, 16, v245
    v_mfma_f32_32x32x16_bf16 v[16:31], a[12:15], a[236:239], v[16:31]
    ds_write_b128 v10, v[212:215] offset:25600
    v_mad_i32_i24 v244, v245, -12, v244
    v_lshlrev_b32 v244, 4, v244
    v_mad_u32_u24 v11, v245, s31, v244
    v_mul_u32_u24 v245, 208, v245
    v_mfma_f32_32x32x16_bf16 v[32:47], a[16:19], a[236:239], v[32:47]
    v_add3_u32 v6, v244, v245, s53
    v_add_u32 v13, 80640, v11
    v_add_u32 v244, 64, v246
    v_mul_u32_u24 v245, 5462, v244
    v_lshrrev_b32 v245, 16, v245
    v_mad_i32_i24 v244, v245, -12, v244
    v_lshlrev_b32 v244, 4, v244
    v_mad_u32_u24 v12, v245, s31, v244
    v_mul_u32_u24 v245, 208, v245
    v_mfma_f32_32x32x16_bf16 v[48:63], a[20:23], a[236:239], v[48:63]
    s_waitcnt vmcnt(1) lgkmcnt(0)
    s_barrier
    v_add3_u32 v7, v244, v245, s53
    v_add_u32 v14, 80640, v12
    v_add_u32 v244, 128, v246
    v_mul_u32_u24 v245, 5462, v244
    v_lshrrev_b32 v245, 16, v245
    v_mad_i32_i24 v244, v245, -12, v244
    v_lshlrev_b32 v244, 4, v244
    v_mad_u32_u24 v1, v245, s31, v244
    v_mfma_f32_32x32x16_bf16 v[16:31], a[24:27], a[240:243], v[16:31]
    buffer_load_dwordx4 v[164:167], v226, s[24:27], s49 offen sc1
    ds_read_b64_tr_b16 a[48:49], v3 offset:24576
    ds_read_b64_tr_b16 a[50:51], v3 offset:27648
    ds_read_b128 a[248:251], v9 offset:24576
    ds_read_b64_tr_b16 a[62:63], v3 offset:33792
    ds_read_b128 a[252:255], v9 offset:25600
    v_mul_u32_u24 v245, 208, v245
    v_add3_u32 v8, v244, v245, s53
    v_add_u32 v236, 80640, v1
    v_mfma_f32_32x32x16_bf16 v[32:47], a[28:31], a[240:243], v[32:47]
    ds_read_b64_tr_b16 a[60:61], v3 offset:30720
    ds_read_b64_tr_b16 a[72:73], v3 offset:36864
    ds_read_b64_tr_b16 a[74:75], v3 offset:39936
    v_cvt_pk_f16_f32 v218, v172, v173
    v_cvt_pk_f16_f32 v220, v174, v175
    v_pk_fma_f16 v219, v218, v218, s36
    v_pk_fma_f16 v221, v220, v220, s36
    v_pk_mul_f16 v219, v219, v218
    v_pk_mul_f16 v221, v221, v220
    v_mfma_f32_32x32x16_bf16 v[48:63], a[32:35], a[240:243], v[48:63]
    ds_read_b128 a[216:219], v9 offset:26624
    ds_read_b64_tr_b16 a[84:85], v3 offset:43008
    v_exp_f16 v218, v219
    v_exp_f16 v220, v221
    v_exp_f16_sdwa v218, v219 dst_sel:WORD_1 dst_unused:UNUSED_PRESERVE src0_sel:WORD_1
    v_mfma_f32_32x32x16_bf16 v[16:31], a[36:39], a[244:247], v[16:31]
    ds_read_b64_tr_b16 a[86:87], v3 offset:46080
    ds_read_b128 a[220:223], v9 offset:27648
    v_exp_f16_sdwa v220, v221 dst_sel:WORD_1 dst_unused:UNUSED_PRESERVE src0_sel:WORD_1
    v_pk_fma_f16 v218, v218, s101, s101
    v_pk_fma_f16 v220, v220, s101, s101
    v_rcp_f16_e64 v219, v218
    v_mfma_f32_32x32x16_bf16 v[32:47], a[40:43], a[244:247], v[32:47]
    buffer_load_dwordx4 v[168:171], v226, s[24:27], s50 offen sc1
    ds_read_b64_tr_b16 a[52:53], v4 offset:24576
    ds_read_b64_tr_b16 a[54:55], v4 offset:27648
    v_rcp_f16 v221, v220
    v_rcp_f16_sdwa v218, v218 dst_sel:WORD_0 dst_unused:UNUSED_PAD src0_sel:WORD_1
    v_rcp_f16_sdwa v220, v220 dst_sel:WORD_0 dst_unused:UNUSED_PAD src0_sel:WORD_1
    v_mfma_f32_32x32x16_bf16 v[48:63], a[44:47], a[244:247], v[48:63]
    s_waitcnt lgkmcnt(5)
    ds_read_b64_tr_b16 a[64:65], v4 offset:30720
    ds_read_b64_tr_b16 a[66:67], v4 offset:33792
    v_fma_mix_f32 v219, v172, v219, 0 op_sel_hi:[0,1,0]
    v_fma_mix_f32 v221, v174, v221, 0 op_sel_hi:[0,1,0]
    v_fma_mix_f32 v218, v173, v218, 0 op_sel_hi:[0,1,0]
    v_fma_mix_f32 v220, v175, v220, 0 op_sel_hi:[0,1,0]
    v_cvt_pk_bf16_f32 v208, v219, v218
    v_cvt_pk_bf16_f32 v209, v221, v220
    v_cvt_pk_f16_f32 v222, v176, v177
    v_mfma_f32_32x32x16_bf16 v[16:31], a[48:51], a[248:251], v[16:31]
    ds_read_b64_tr_b16 a[76:77], v4 offset:36864
    ds_read_b64_tr_b16 a[78:79], v4 offset:39936
    v_cvt_pk_f16_f32 v224, v178, v179
    v_pk_fma_f16 v223, v222, v222, s36
    v_pk_fma_f16 v225, v224, v224, s36
    v_pk_mul_f16 v223, v223, v222
    v_pk_mul_f16 v225, v225, v224
    v_exp_f16_e64 v222, v223
    v_mfma_f32_32x32x16_bf16 v[16:31], a[60:63], a[252:255], v[16:31]
    ds_read_b64_tr_b16 a[88:89], v4 offset:43008
    ds_read_b64_tr_b16 a[90:91], v4 offset:46080
    v_exp_f16 v224, v225
    v_exp_f16_sdwa v222, v223 dst_sel:WORD_1 dst_unused:UNUSED_PRESERVE src0_sel:WORD_1
    v_exp_f16_sdwa v224, v225 dst_sel:WORD_1 dst_unused:UNUSED_PRESERVE src0_sel:WORD_1
    v_pk_fma_f16 v222, v222, s101, s101
    v_mfma_f32_32x32x16_bf16 v[16:31], a[72:75], a[216:219], v[16:31]
    s_waitcnt lgkmcnt(4)
    buffer_load_dwordx4 v[204:207], v226, s[24:27], s51 offen sc1
    ds_read_b64_tr_b16 a[56:57], v5 offset:24576
    ds_read_b64_tr_b16 a[58:59], v5 offset:27648
    v_pk_fma_f16 v224, v224, s101, s101
    v_rcp_f16 v223, v222
    v_rcp_f16 v225, v224
    v_mfma_f32_32x32x16_bf16 v[16:31], a[84:87], a[220:223], v[16:31]
    ds_read_b64_tr_b16 a[68:69], v5 offset:30720
    ds_read_b64_tr_b16 a[70:71], v5 offset:33792
    v_rcp_f16_sdwa v222, v222 dst_sel:WORD_0 dst_unused:UNUSED_PAD src0_sel:WORD_1
    v_rcp_f16_sdwa v224, v224 dst_sel:WORD_0 dst_unused:UNUSED_PAD src0_sel:WORD_1
    v_fma_mix_f32 v223, v176, v223, 0 op_sel_hi:[0,1,0]
    v_fma_mix_f32 v225, v178, v225, 0 op_sel_hi:[0,1,0]
    v_fma_mix_f32 v222, v177, v222, 0 op_sel_hi:[0,1,0]
    v_mfma_f32_32x32x16_bf16 v[32:47], a[52:55], a[248:251], v[32:47]
    ds_read_b64_tr_b16 a[80:81], v5 offset:36864
    ds_read_b64_tr_b16 a[82:83], v5 offset:39936
    v_fma_mix_f32 v224, v179, v224, 0 op_sel_hi:[0,1,0]
    v_cvt_pk_bf16_f32 v210, v223, v222
    v_cvt_pk_bf16_f32 v211, v225, v224
    v_cvt_pk_f16_f32 v218, v180, v181
    v_cvt_pk_f16_f32 v220, v182, v183
    v_pk_fma_f16 v219, v218, v218, s36
    v_pk_fma_f16 v221, v220, v220, s36
    v_mfma_f32_32x32x16_bf16 v[32:47], a[64:67], a[252:255], v[32:47]
    s_waitcnt lgkmcnt(4)
    ds_read_b64_tr_b16 a[92:93], v5 offset:43008
    ds_read_b64_tr_b16 a[94:95], v5 offset:46080
    v_pk_mul_f16 v219, v219, v218
    v_pk_mul_f16 v221, v221, v220
    v_exp_f16 v218, v219
    v_exp_f16_e64 v220, v221
    v_mfma_f32_32x32x16_bf16 v[32:47], a[76:79], a[216:219], v[32:47]
L_pg13:
    s_cbranch_execz L_wu3
    buffer_load_dwordx2 v[216:217], v227, s[4:7], s52 offen
    ds_read_b128 a[224:227], v9 offset:4096
    ds_read_b128 a[228:231], v9 offset:5120
    v_exp_f16_sdwa v218, v219 dst_sel:WORD_1 dst_unused:UNUSED_PRESERVE src0_sel:WORD_1
    v_exp_f16_sdwa v220, v221 dst_sel:WORD_1 dst_unused:UNUSED_PRESERVE src0_sel:WORD_1
    v_pk_fma_f16 v218, v218, s101, s101
    v_pk_fma_f16 v220, v220, s101, s101
    v_mfma_f32_32x32x16_bf16 v[32:47], a[88:91], a[220:223], v[32:47]
    s_nop 0
    ds_write_b128 v10, v[208:211] offset:28672
    v_rcp_f16 v219, v218
    v_rcp_f16_e64 v221, v220
    v_mfma_f32_32x32x16_bf16 v[48:63], a[56:59], a[248:251], v[48:63]
    s_waitcnt lgkmcnt(3)
    v_rcp_f16_sdwa v218, v218 dst_sel:WORD_0 dst_unused:UNUSED_PAD src0_sel:WORD_1
    v_rcp_f16_sdwa v220, v220 dst_sel:WORD_0 dst_unused:UNUSED_PAD src0_sel:WORD_1
    v_fma_mix_f32 v219, v180, v219, 0 op_sel_hi:[0,1,0]
    v_fma_mix_f32 v221, v182, v221, 0 op_sel_hi:[0,1,0]
    v_fma_mix_f32 v218, v181, v218, 0 op_sel_hi:[0,1,0]
    v_fma_mix_f32 v220, v183, v220, 0 op_sel_hi:[0,1,0]
    v_cvt_pk_bf16_f32 v212, v219, v218
    v_mfma_f32_32x32x16_bf16 v[48:63], a[68:71], a[252:255], v[48:63]
    v_cvt_pk_bf16_f32 v213, v221, v220
    v_cvt_pk_f16_f32 v222, v184, v185
    v_cvt_pk_f16_f32 v224, v186, v187
    v_pk_fma_f16 v223, v222, v222, s36
    v_pk_fma_f16 v225, v224, v224, s36
    v_pk_mul_f16 v223, v223, v222
    v_pk_mul_f16 v225, v225, v224
    v_exp_f16 v222, v223
    v_mfma_f32_32x32x16_bf16 v[48:63], a[80:83], a[216:219], v[48:63]
    v_exp_f16 v224, v225
    v_exp_f16_sdwa v222, v223 dst_sel:WORD_1 dst_unused:UNUSED_PRESERVE src0_sel:WORD_1
    v_exp_f16_sdwa v224, v225 dst_sel:WORD_1 dst_unused:UNUSED_PRESERVE src0_sel:WORD_1
    v_pk_fma_f16 v222, v222, s101, s101
    v_pk_fma_f16 v224, v224, s101, s101
    v_cvt_pk_bf16_f32 v228, v16, v17
    v_mfma_f32_32x32x16_bf16 v[48:63], a[92:95], a[220:223], v[48:63]
    s_waitcnt lgkmcnt(1)
    v_rcp_f16 v223, v222
    v_rcp_f16_e64 v225, v224
    v_rcp_f16_sdwa v222, v222 dst_sel:WORD_0 dst_unused:UNUSED_PAD src0_sel:WORD_1
    v_rcp_f16_sdwa v224, v224 dst_sel:WORD_0 dst_unused:UNUSED_PAD src0_sel:WORD_1
    v_fma_mix_f32 v223, v184, v223, 0 op_sel_hi:[0,1,0]
    v_mfma_f32_32x32x16_bf16 v[64:79], a[0:3], a[224:227], v[64:79]
    ds_read_b128 a[232:235], v9 offset:6144
    ds_read_b128 a[236:239], v9 offset:7168
    v_fma_mix_f32 v225, v186, v225, 0 op_sel_hi:[0,1,0]
    v_fma_mix_f32 v222, v185, v222, 0 op_sel_hi:[0,1,0]
    v_fma_mix_f32 v224, v187, v224, 0 op_sel_hi:[0,1,0]
    v_cvt_pk_bf16_f32 v214, v223, v222
    v_cvt_pk_bf16_f32 v215, v225, v224
    v_cvt_pk_bf16_f32 v229, v18, v19
    v_cvt_pk_bf16_f32 v230, v20, v21
    v_mfma_f32_32x32x16_bf16 v[80:95], a[4:7], a[224:227], v[80:95]
    ds_write_b128 v10, v[212:215] offset:29696
    v_cvt_pk_bf16_f32 v231, v22, v23
    v_cvt_pk_bf16_f32 v232, v24, v25
    v_cvt_pk_bf16_f32 v233, v26, v27
    v_cvt_pk_bf16_f32 v234, v28, v29
    v_mfma_f32_32x32x16_bf16 v[96:111], a[8:11], a[224:227], v[96:111]
    ds_write_b128 v2, v[228:231] offset:0
    v_cvt_pk_bf16_f32 v235, v30, v31
    v_cvt_pk_bf16_f32 v228, v32, v33
    v_cvt_pk_bf16_f32 v229, v34, v35
    v_mfma_f32_32x32x16_bf16 v[64:79], a[12:15], a[228:231], v[64:79]
    ds_write_b128 v2, v[232:235] offset:16
    v_cvt_pk_bf16_f32 v230, v36, v37
    v_cvt_pk_bf16_f32 v231, v38, v39
    v_cvt_pk_bf16_f32 v232, v40, v41
    v_cvt_pk_bf16_f32 v233, v42, v43
    v_mfma_f32_32x32x16_bf16 v[80:95], a[16:19], a[228:231], v[80:95]
    ds_write_b128 v2, v[228:231] offset:64
    v_cvt_pk_bf16_f32 v234, v44, v45
    v_cvt_pk_bf16_f32 v235, v46, v47
    v_cvt_pk_bf16_f32 v228, v48, v49
    v_mfma_f32_32x32x16_bf16 v[96:111], a[20:23], a[228:231], v[96:111]
    s_waitcnt lgkmcnt(5)
    ds_write_b128 v2, v[232:235] offset:80
    v_cvt_pk_bf16_f32 v229, v50, v51
    v_cvt_pk_bf16_f32 v230, v52, v53
    v_cvt_pk_bf16_f32 v231, v54, v55
    v_cvt_pk_bf16_f32 v232, v56, v57
    v_mfma_f32_32x32x16_bf16 v[64:79], a[24:27], a[232:235], v[64:79]
    s_nop 0
    ds_write_b128 v2, v[228:231] offset:128
    v_cvt_pk_bf16_f32 v233, v58, v59
    v_cvt_pk_bf16_f32 v234, v60, v61
    v_cvt_pk_bf16_f32 v235, v62, v63
    v_mfma_f32_32x32x16_bf16 v[80:95], a[28:31], a[232:235], v[80:95]
    ds_write_b128 v2, v[232:235] offset:144
    s_add_u32 s54, s96, 0
    v_mfma_f32_32x32x16_bf16 v[96:111], a[32:35], a[232:235], v[96:111]
    s_waitcnt lgkmcnt(6)
    s_barrier
    ds_read_b128 a[240:243], v9 offset:28672
    ds_read_b128 a[244:247], v9 offset:29696
    v_mfma_f32_32x32x16_bf16 v[64:79], a[36:39], a[236:239], v[64:79]
    ds_read_b128 v[240:243], v6 offset:0
    ds_read_b128 v[244:247], v7 offset:0
    s_add_u32 s55, s96, 0
    v_mfma_f32_32x32x16_bf16 v[80:95], a[40:43], a[236:239], v[80:95]
    ds_read_b128 v[248:251], v8 offset:0
    ds_read_b128 v[252:255], v6 offset:3328
    ds_read_b128 a[248:251], v9 offset:30720
    ds_read_b128 a[252:255], v9 offset:31744
    s_mov_b32 s56, 0x0
    s_mov_b32 s57, 0xffffff00
    v_cndmask_b32 v237, v1, v236, s[56:57]
    v_mfma_f32_32x32x16_bf16 v[96:111], a[44:47], a[236:239], v[96:111]
    s_waitcnt lgkmcnt(5)
    buffer_store_dwordx4 v[240:243], v11, s[16:19], s54 offen nt
    s_add_u32 s54, s96, 0
    v_mfma_f32_32x32x16_bf16 v[64:79], a[48:51], a[240:243], v[64:79]
    v_mfma_f32_32x32x16_bf16 v[64:79], a[60:63], a[244:247], v[64:79]
    s_waitcnt lgkmcnt(0)
    buffer_store_dwordx4 v[244:247], v12, s[16:19], s55 offen nt
    s_add_u32 s55, s96, 86784
    v_mfma_f32_32x32x16_bf16 v[64:79], a[72:75], a[248:251], v[64:79]
    ds_read_b128 v[240:243], v7 offset:3328
    ds_read_b128 v[244:247], v8 offset:3328
    v_mfma_f32_32x32x16_bf16 v[64:79], a[84:87], a[252:255], v[64:79]
    buffer_store_dwordx4 v[248:251], v237, s[16:19], s54 offen nt
    s_add_u32 s54, s96, 86784
    s_mov_b32 s58, 0xffff0000
    s_mov_b32 s59, 0xffffffff
    v_cndmask_b32 v238, v1, v236, s[58:59]
    v_mfma_f32_32x32x16_bf16 v[80:95], a[52:55], a[240:243], v[80:95]
    v_mfma_f32_32x32x16_bf16 v[80:95], a[64:67], a[244:247], v[80:95]
    buffer_store_dwordx4 v[252:255], v11, s[16:19], s55 offen nt
    s_add_u32 s55, s96, 86784
    v_mfma_f32_32x32x16_bf16 v[80:95], a[76:79], a[248:251], v[80:95]
    s_nop 1
    v_cvt_pk_bf16_f32 v228, v64, v65
    v_cvt_pk_bf16_f32 v229, v66, v67
    v_cvt_pk_bf16_f32 v230, v68, v69
    v_cvt_pk_bf16_f32 v231, v70, v71
    v_cvt_pk_bf16_f32 v232, v72, v73
    v_cvt_pk_bf16_f32 v233, v74, v75
    v_cvt_pk_bf16_f32 v234, v76, v77
    v_cvt_pk_bf16_f32 v235, v78, v79
    v_mfma_f32_32x32x16_bf16 v[80:95], a[88:91], a[252:255], v[80:95]
    s_waitcnt lgkmcnt(0)
    buffer_store_dwordx4 v[240:243], v12, s[16:19], s54 offen nt
    v_mfma_f32_32x32x16_bf16 v[96:111], a[56:59], a[240:243], v[96:111]
    s_nop 0
    buffer_store_dwordx4 v[244:247], v238, s[16:19], s55 offen nt
    ds_read_b128 a[216:219], v9 offset:8192
    v_mfma_f32_32x32x16_bf16 v[96:111], a[68:71], a[244:247], v[96:111]
    ds_write_b128 v2, v[228:231] offset:6656
    v_mfma_f32_32x32x16_bf16 v[96:111], a[80:83], a[248:251], v[96:111]
    s_nop 0
    ds_write_b128 v2, v[232:235] offset:6672
    s_nop 2
    v_cvt_pk_bf16_f32 v228, v80, v81
    v_cvt_pk_bf16_f32 v229, v82, v83
    v_cvt_pk_bf16_f32 v230, v84, v85
    v_cvt_pk_bf16_f32 v231, v86, v87
    v_cvt_pk_bf16_f32 v232, v88, v89
    v_cvt_pk_bf16_f32 v233, v90, v91
    v_mfma_f32_32x32x16_bf16 v[96:111], a[92:95], a[252:255], v[96:111]
    ds_write_b128 v2, v[228:231] offset:6720
    v_cvt_pk_bf16_f32 v234, v92, v93
    v_cvt_pk_bf16_f32 v235, v94, v95
    v_mfma_f32_32x32x16_bf16 v[188:203], a[168:171], a[96:99], 0
    ds_write_b128 v2, v[232:235] offset:6736
    v_mfma_f32_32x32x16_bf16 v[188:203], a[172:175], a[100:103], v[188:203]
    s_nop 0
    v_mfma_f32_32x32x16_bf16 v[188:203], a[176:179], a[104:107], v[188:203]
    s_nop 4
    v_cvt_pk_bf16_f32 v228, v96, v97
    v_cvt_pk_bf16_f32 v229, v98, v99
    v_cvt_pk_bf16_f32 v230, v100, v101
    v_cvt_pk_bf16_f32 v231, v102, v103
    v_cvt_pk_bf16_f32 v232, v104, v105
    v_cvt_pk_bf16_f32 v233, v106, v107
    v_cvt_pk_bf16_f32 v234, v108, v109
    v_cvt_pk_bf16_f32 v235, v110, v111
    v_mfma_f32_32x32x16_bf16 v[188:203], a[180:183], a[108:111], v[188:203]
    ds_write_b128 v2, v[228:231] offset:6784
    v_mfma_f32_32x32x16_bf16 v[188:203], a[184:187], a[112:115], v[188:203]
    ds_write_b128 v2, v[232:235] offset:6800
    s_add_u32 s54, s96, 173568
    v_mfma_f32_32x32x16_bf16 v[188:203], a[188:191], a[116:119], v[188:203]
    v_mfma_f32_32x32x16_bf16 v[188:203], a[192:195], a[120:123], v[188:203]
    s_nop 0
    ds_read_b128 v[240:243], v6 offset:6656
    ds_read_b128 v[244:247], v7 offset:6656
    s_mov_b32 s58, 0x0
    s_mov_b32 s59, 0xff000000
    v_cndmask_b32 v238, v12, v14, s[58:59]
    s_add_u32 s55, s96, 173568
    v_mfma_f32_32x32x16_bf16 v[188:203], a[196:199], a[124:127], v[188:203]
    s_nop 0
    ds_read_b128 v[248:251], v8 offset:6656
    ds_read_b128 v[252:255], v6 offset:9984
    v_mfma_f32_32x32x16_bf16 v[188:203], a[200:203], a[128:131], v[188:203]
    s_waitcnt lgkmcnt(3)
    buffer_store_dwordx4 v[240:243], v11, s[16:19], s54 offen nt
    s_add_u32 s54, s96, 254208
    v_mfma_f32_32x32x16_bf16 v[188:203], a[204:207], a[132:135], v[188:203]
    s_nop 0
    ds_read_b128 a[220:223], v9 offset:9216
    v_mfma_f32_32x32x16_bf16 v[188:203], a[208:211], a[136:139], v[188:203]
    s_waitcnt lgkmcnt(1)
    buffer_store_dwordx4 v[244:247], v238, s[16:19], s55 offen nt
    s_add_u32 s55, s96, 260352
    s_mov_b32 s56, 0x0
    s_mov_b32 s57, 0xffffffff
    v_cndmask_b32 v237, v12, v14, s[56:57]
    v_mfma_f32_32x32x16_bf16 v[188:203], a[212:215], a[140:143], v[188:203]
    ds_read_b128 v[240:243], v7 offset:9984
    ds_read_b128 v[244:247], v8 offset:9984
    v_mfma_f32_32x32x16_bf16 v[112:127], a[0:3], a[216:219], v[112:127]
    buffer_store_dwordx4 v[248:251], v1, s[16:19], s54 offen nt
    ds_read_b128 a[224:227], v9 offset:10240
    s_add_u32 s54, s96, 260352
    v_mfma_f32_32x32x16_bf16 v[128:143], a[4:7], a[216:219], v[128:143]
    s_nop 4
    v_cvt_pk_f16_f32 v218, v188, v189
    v_cvt_pk_f16_f32 v220, v190, v191
    v_pk_fma_f16 v219, v218, v218, s36
    v_pk_fma_f16 v221, v220, v220, s36
    v_pk_mul_f16 v219, v219, v218
    v_pk_mul_f16 v221, v221, v220
    v_exp_f16 v218, v219
    v_exp_f16 v220, v221
    v_exp_f16_sdwa v218, v219 dst_sel:WORD_1 dst_unused:UNUSED_PRESERVE src0_sel:WORD_1
    v_exp_f16_sdwa v220, v221 dst_sel:WORD_1 dst_unused:UNUSED_PRESERVE src0_sel:WORD_1
    v_pk_fma_f16 v218, v218, s101, s101
    v_pk_fma_f16 v220, v220, s101, s101
    v_rcp_f16 v219, v218
    v_rcp_f16 v221, v220
    v_rcp_f16_sdwa v218, v218 dst_sel:WORD_0 dst_unused:UNUSED_PAD src0_sel:WORD_1
    v_rcp_f16_sdwa v220, v220 dst_sel:WORD_0 dst_unused:UNUSED_PAD src0_sel:WORD_1
    v_mfma_f32_32x32x16_bf16 v[144:159], a[8:11], a[216:219], v[144:159]
    s_waitcnt lgkmcnt(1)
    buffer_store_dwordx4 v[252:255], v11, s[16:19], s55 offen nt
    v_fma_mix_f32 v219, v188, v219, 0 op_sel_hi:[0,1,0]
    v_fma_mix_f32 v221, v190, v221, 0 op_sel_hi:[0,1,0]
    v_fma_mix_f32 v218, v189, v218, 0 op_sel_hi:[0,1,0]
    v_fma_mix_f32 v220, v191, v220, 0 op_sel_hi:[0,1,0]
    v_cvt_pk_bf16_f32 v208, v219, v218
    v_cvt_pk_bf16_f32 v209, v221, v220
    v_cvt_pk_f16_f32 v222, v192, v193
    v_cvt_pk_f16_f32 v224, v194, v195
    v_pk_fma_f16 v223, v222, v222, s36
    v_pk_fma_f16 v225, v224, v224, s36
    v_pk_mul_f16 v223, v223, v222
    v_pk_mul_f16 v225, v225, v224
    v_exp_f16 v222, v223
    v_exp_f16 v224, v225
    s_add_u32 s55, s96, 340992
    v_mfma_f32_32x32x16_bf16 v[112:127], a[12:15], a[220:223], v[112:127]
    ds_read_b128 a[228:231], v9 offset:11264
    v_exp_f16_sdwa v222, v223 dst_sel:WORD_1 dst_unused:UNUSED_PRESERVE src0_sel:WORD_1
    v_exp_f16_sdwa v224, v225 dst_sel:WORD_1 dst_unused:UNUSED_PRESERVE src0_sel:WORD_1
    v_pk_fma_f16 v222, v222, s101, s101
    v_pk_fma_f16 v224, v224, s101, s101
    v_rcp_f16 v223, v222
    v_rcp_f16 v225, v224
    v_rcp_f16_sdwa v222, v222 dst_sel:WORD_0 dst_unused:UNUSED_PAD src0_sel:WORD_1
    v_rcp_f16_sdwa v224, v224 dst_sel:WORD_0 dst_unused:UNUSED_PAD src0_sel:WORD_1
    v_fma_mix_f32 v223, v192, v223, 0 op_sel_hi:[0,1,0]
    v_fma_mix_f32 v225, v194, v225, 0 op_sel_hi:[0,1,0]
    v_fma_mix_f32 v222, v193, v222, 0 op_sel_hi:[0,1,0]
    v_fma_mix_f32 v224, v195, v224, 0 op_sel_hi:[0,1,0]
    v_cvt_pk_bf16_f32 v210, v223, v222
    v_cvt_pk_bf16_f32 v211, v225, v224
    v_cvt_pk_f16_f32 v218, v196, v197
    v_cvt_pk_f16_f32 v220, v198, v199
    v_mfma_f32_32x32x16_bf16 v[128:143], a[16:19], a[220:223], v[128:143]
    ds_write_b128 v10, v[208:211] offset:32768
    v_pk_fma_f16 v219, v218, v218, s36
    v_pk_fma_f16 v221, v220, v220, s36
    v_pk_mul_f16 v219, v219, v218
    v_pk_mul_f16 v221, v221, v220
    v_exp_f16 v218, v219
    v_exp_f16 v220, v221
    v_exp_f16_sdwa v218, v219 dst_sel:WORD_1 dst_unused:UNUSED_PRESERVE src0_sel:WORD_1
    v_exp_f16_sdwa v220, v221 dst_sel:WORD_1 dst_unused:UNUSED_PRESERVE src0_sel:WORD_1
    v_pk_fma_f16 v218, v218, s101, s101
    v_pk_fma_f16 v220, v220, s101, s101
    v_rcp_f16 v219, v218
    v_mfma_f32_32x32x16_bf16 v[144:159], a[20:23], a[220:223], v[144:159]
    s_waitcnt lgkmcnt(2)
    buffer_store_dwordx4 v[240:243], v237, s[16:19], s54 offen nt
    v_rcp_f16_e64 v221, v220
    v_rcp_f16_sdwa v218, v218 dst_sel:WORD_0 dst_unused:UNUSED_PAD src0_sel:WORD_1
    v_rcp_f16_sdwa v220, v220 dst_sel:WORD_0 dst_unused:UNUSED_PAD src0_sel:WORD_1
    v_fma_mix_f32 v219, v196, v219, 0 op_sel_hi:[0,1,0]
    v_fma_mix_f32 v221, v198, v221, 0 op_sel_hi:[0,1,0]
    v_fma_mix_f32 v218, v197, v218, 0 op_sel_hi:[0,1,0]
    v_fma_mix_f32 v220, v199, v220, 0 op_sel_hi:[0,1,0]
    v_cvt_pk_bf16_f32 v212, v219, v218
    v_cvt_pk_bf16_f32 v213, v221, v220
    v_cvt_pk_f16_f32 v222, v200, v201
    v_cvt_pk_f16_f32 v224, v202, v203
    v_pk_fma_f16 v223, v222, v222, s36
    v_pk_fma_f16 v225, v224, v224, s36
    v_pk_mul_f16 v223, v223, v222
    v_pk_mul_f16 v225, v225, v224
    v_mfma_f32_32x32x16_bf16 v[112:127], a[24:27], a[224:227], v[112:127]
    v_exp_f16 v222, v223
    v_exp_f16 v224, v225
    v_exp_f16_sdwa v222, v223 dst_sel:WORD_1 dst_unused:UNUSED_PRESERVE src0_sel:WORD_1
    v_exp_f16_sdwa v224, v225 dst_sel:WORD_1 dst_unused:UNUSED_PRESERVE src0_sel:WORD_1
    v_pk_fma_f16 v222, v222, s101, s101
    v_pk_fma_f16 v224, v224, s101, s101
    v_rcp_f16 v223, v222
    v_rcp_f16 v225, v224
    v_rcp_f16_sdwa v222, v222 dst_sel:WORD_0 dst_unused:UNUSED_PAD src0_sel:WORD_1
    v_rcp_f16_sdwa v224, v224 dst_sel:WORD_0 dst_unused:UNUSED_PAD src0_sel:WORD_1
    v_fma_mix_f32 v223, v200, v223, 0 op_sel_hi:[0,1,0]
    v_fma_mix_f32 v225, v202, v225, 0 op_sel_hi:[0,1,0]
    v_fma_mix_f32 v222, v201, v222, 0 op_sel_hi:[0,1,0]
    v_fma_mix_f32 v224, v203, v224, 0 op_sel_hi:[0,1,0]
    v_cvt_pk_bf16_f32 v214, v223, v222
    v_cvt_pk_bf16_f32 v215, v225, v224
    s_waitcnt vmcnt(14)
    v_add_f32 v160, v160, v164
    s_waitcnt vmcnt(12)
    v_add_f32 v168, v168, v204
    s_waitcnt vmcnt(11)
    v_lshlrev_b32 v164, 16, v216
    v_add_f32 v161, v161, v165
    v_add_f32 v169, v169, v205
    v_mfma_f32_32x32x16_bf16 v[128:143], a[28:31], a[224:227], v[128:143]
    ds_write_b128 v10, v[212:215] offset:33792
    buffer_store_dwordx4 v[244:247], v1, s[16:19], s55 offen nt
    v_mfma_f32_32x32x16_bf16 v[144:159], a[32:35], a[224:227], v[144:159]
    s_waitcnt lgkmcnt(2)
    v_and_b32 v165, 0xffff0000, v216
    v_add_f32 v162, v162, v166
    v_add_f32 v170, v170, v206
    v_lshlrev_b32 v166, 16, v217
    v_add_f32 v163, v163, v167
    v_add_f32 v171, v171, v207
    v_mfma_f32_32x32x16_bf16 v[112:127], a[36:39], a[228:231], v[112:127]
    s_waitcnt lgkmcnt(0)
    s_barrier
    ds_read_b128 a[232:235], v9 offset:32768
    ds_read_b128 a[236:239], v9 offset:33792
    v_and_b32 v167, 0xffff0000, v217
    v_add_f32 v160, v160, v168
    v_add_f32 v161, v161, v169
    v_mfma_f32_32x32x16_bf16 v[128:143], a[40:43], a[228:231], v[128:143]
    ds_read_b128 a[240:243], v9 offset:34816
    ds_read_b128 a[244:247], v9 offset:35840
    v_add_f32 v162, v162, v170
    v_add_f32 v163, v163, v171
    v_add_f32 v160, v160, v164
    v_add_f32_e64 v161, v161, v165
    v_mfma_f32_32x32x16_bf16 v[144:159], a[44:47], a[228:231], v[144:159]
    s_waitcnt lgkmcnt(3)
    v_add_f32_e64 v162, v162, v166
    v_add_f32_e64 v163, v163, v167
    v_cvt_pk_bf16_f32 v216, v160, v161
    v_cvt_pk_bf16_f32 v217, v162, v163
    v_mfma_f32_32x32x16_bf16 v[112:127], a[48:51], a[232:235], v[112:127]
    s_waitcnt lgkmcnt(2)
    buffer_store_dwordx2 v[216:217], v227, s[16:19], s52 offen nt
    v_mfma_f32_32x32x16_bf16 v[112:127], a[60:63], a[236:239], v[112:127]
    s_waitcnt lgkmcnt(0)
    v_mfma_f32_32x32x16_bf16 v[112:127], a[72:75], a[240:243], v[112:127]
    v_mfma_f32_32x32x16_bf16 v[112:127], a[84:87], a[244:247], v[112:127]
    v_mfma_f32_32x32x16_bf16 v[128:143], a[52:55], a[232:235], v[128:143]
    v_mfma_f32_32x32x16_bf16 v[128:143], a[64:67], a[236:239], v[128:143]
    s_nop 0
    v_mfma_f32_32x32x16_bf16 v[128:143], a[76:79], a[240:243], v[128:143]
    s_nop 8
    v_cvt_pk_bf16_f32 v228, v112, v113
    v_cvt_pk_bf16_f32 v229, v114, v115
    v_cvt_pk_bf16_f32 v230, v116, v117
    v_cvt_pk_bf16_f32 v231, v118, v119
    v_cvt_pk_bf16_f32 v232, v120, v121
    v_cvt_pk_bf16_f32 v233, v122, v123
    v_mfma_f32_32x32x16_bf16 v[128:143], a[88:91], a[244:247], v[128:143]
    ds_write_b128 v2, v[228:231] offset:0
    v_cvt_pk_bf16_f32 v234, v124, v125
    v_mfma_f32_32x32x16_bf16 v[144:159], a[56:59], a[232:235], v[144:159]
    v_cvt_pk_bf16_f32 v235, v126, v127
    v_mfma_f32_32x32x16_bf16 v[144:159], a[68:71], a[236:239], v[144:159]
    s_nop 0
    ds_write_b128 v2, v[232:235] offset:16
    v_mfma_f32_32x32x16_bf16 v[144:159], a[80:83], a[240:243], v[144:159]
    s_nop 4
    v_cvt_pk_bf16_f32 v228, v128, v129
    v_cvt_pk_bf16_f32 v229, v130, v131
    v_cvt_pk_bf16_f32 v230, v132, v133
    v_cvt_pk_bf16_f32 v231, v134, v135
    v_cvt_pk_bf16_f32 v232, v136, v137
    v_cvt_pk_bf16_f32 v233, v138, v139
    v_mfma_f32_32x32x16_bf16 v[144:159], a[92:95], a[244:247], v[144:159]
    s_nop 0
    ds_write_b128 v2, v[228:231] offset:64
    v_cvt_pk_bf16_f32 v234, v140, v141
    v_cvt_pk_bf16_f32 v235, v142, v143
    ds_write_b128 v2, v[232:235] offset:80
    s_nop 7
    v_cvt_pk_bf16_f32 v228, v144, v145
    v_cvt_pk_bf16_f32 v229, v146, v147
    v_cvt_pk_bf16_f32 v230, v148, v149
    v_cvt_pk_bf16_f32 v231, v150, v151
    ds_write_b128 v2, v[228:231] offset:128
    v_cvt_pk_bf16_f32 v232, v152, v153
    v_cvt_pk_bf16_f32 v233, v154, v155
    v_cvt_pk_bf16_f32 v234, v156, v157
    v_cvt_pk_bf16_f32 v235, v158, v159
    ds_write_b128 v2, v[232:235] offset:144
    ds_read_b128 v[240:243], v6 offset:0
    ds_read_b128 v[244:247], v7 offset:0
    ds_read_b128 v[248:251], v8 offset:0
    ds_read_b128 v[252:255], v6 offset:3328
    s_add_u32 s54, s96, 347136
    s_waitcnt lgkmcnt(3)
    buffer_store_dwordx4 v[240:243], v11, s[16:19], s54 offen nt
    s_mov_b32 s58, 0xffffff00
    s_mov_b32 s59, 0xffffffff
    v_cndmask_b32 v238, v12, v14, s[58:59]
    s_add_u32 s55, s96, 347136
    s_waitcnt lgkmcnt(2)
    buffer_store_dwordx4 v[244:247], v238, s[16:19], s55 offen nt
    ds_read_b128 v[240:243], v7 offset:3328
    s_nop 0
    ds_read_b128 v[244:247], v8 offset:3328
    s_add_u32 s54, s96, 427776
    s_waitcnt lgkmcnt(3)
    buffer_store_dwordx4 v[248:251], v1, s[16:19], s54 offen nt
    s_mov_b32 s58, 0x0
    s_mov_b32 s59, 0xffff0000
    v_cndmask_b32 v238, v11, v13, s[58:59]
    s_add_u32 s55, s96, 433920
    s_waitcnt lgkmcnt(2)
    buffer_store_dwordx4 v[252:255], v238, s[16:19], s55 offen nt
    s_add_u32 s54, s96, 514560
    s_waitcnt lgkmcnt(1)
    buffer_store_dwordx4 v[240:243], v12, s[16:19], s54 offen nt
    s_add_u32 s55, s96, 514560
    s_waitcnt lgkmcnt(0)
    buffer_store_dwordx4 v[244:247], v1, s[16:19], s55 offen nt
    s_endpgm
L_spin1:
    s_mov_b32 s34, 0x100000
L_again1:
    buffer_load_dword v251, v250, s[20:23], 0 offen sc1
    s_waitcnt vmcnt(0)
    v_readfirstlane_b32 s33, v251
    s_cmp_ge_u32 s33, s97
    s_cbranch_scc1 L_back1
    s_sub_u32 s34, s34, 1
    s_cbranch_scc0 L_again1
    s_branch L_back1
L_spin2:
    s_mov_b32 s34, 0x100000
L_again2:
    buffer_load_dword v251, v250, s[20:23], 0 offen sc1
    s_waitcnt vmcnt(0)
    v_readfirstlane_b32 s33, v251
    s_cmp_ge_u32 s33, s97
    s_cbranch_scc1 L_back2
    s_sub_u32 s34, s34, 1
    s_cbranch_scc0 L_again2
    s_branch L_back2
L_end:
    s_endpgm
.section .rodata,"a"
.p2align 6
.amdhsa_kernel standalone__modern_conv_block_replknet__vision_kernel
  .amdhsa_next_free_vgpr 512
  .amdhsa_next_free_sgpr 102
  .amdhsa_accum_offset 256
  .amdhsa_group_segment_fixed_size 0
  .amdhsa_kernarg_size 64
  .amdhsa_user_sgpr_count 2
  .amdhsa_user_sgpr_kernarg_segment_ptr 1
  .amdhsa_system_sgpr_workgroup_id_x 1
  .amdhsa_float_denorm_mode_32 3
.end_amdhsa_kernel
```
